```python
import torch

def _softmax(x, axis=-1):
    return torch.softmax(x, dim=axis)
def _gelu(x):
    return torch.nn.functional.gelu(x, approximate="tanh")
def _silu(x):
    return torch.nn.functional.silu(x)
def _sigmoid(x):
    return torch.sigmoid(x)
def _layernorm(x, axis=-1, eps=1e-5):
    m = x.mean(dim=axis, keepdim=True)
    v = x.var(dim=axis, keepdim=True, unbiased=False)
    return (x - m) / torch.sqrt(v + eps)
def _scatter_add(tgt, idx, src, axis=0):
    return tgt.clone().index_add_(axis, idx, src)
def _segment_sum(src, seg, n):
    out = torch.zeros((n,) + src.shape[1:], dtype=src.dtype)
    return out.index_add_(0, seg, src)
def _pad(x, pw):
    flat = tuple(v for pair in reversed(pw) for v in pair)
    return torch.nn.functional.pad(x, flat)

kernel_name = 'recurrent_scan__sliding_block__glu_gated_glu__prompt'

def setup_inputs():

    _w = (lambda a: (lambda t: t.to(torch.bfloat16) if t.is_floating_point() else t)(torch.as_tensor(a)))
    def _A_setup():
        B, S, D = 1, 2048, 512
        return {
            "x": _w((lambda *s: torch.randn(*s, dtype=torch.bfloat16) * 0.05)(B, S, D)),
            "wqkv": _w((lambda *s: torch.randn(*s, dtype=torch.bfloat16) * 0.05)(D, 3 * D)),
            "wo": _w((lambda *s: torch.randn(*s, dtype=torch.bfloat16) * 0.05)(D, D)),
        }
    _A_in = _A_setup()

    def _B_setup():
        B, S, D, F = 1, 2048, 512, 1792
        return {
            "x": _w((lambda *s: torch.randn(*s, dtype=torch.bfloat16) * 0.05)(B, S, D)),
            "w_gate": _w((lambda *s: torch.randn(*s, dtype=torch.bfloat16) * 0.05)(D, F)),
            "w_up": _w((lambda *s: torch.randn(*s, dtype=torch.bfloat16) * 0.05)(D, F)),
            "w_down": _w((lambda *s: torch.randn(*s, dtype=torch.bfloat16) * 0.05)(F, D)),
        }
    _B_in = _B_setup()

    return {
        "A_x": _A_in["x"],
        "A_wqkv": _A_in["wqkv"],
        "A_wo": _A_in["wo"],
        "B_x": _B_in["x"],
        "B_w_gate": _B_in["w_gate"],
        "B_w_up": _B_in["w_up"],
        "B_w_down": _B_in["w_down"],
    }

def reference(A_x, A_wqkv, A_wo, B_x, B_w_gate, B_w_up, B_w_down):
    def _A_ref(x, wqkv, wo):
        B, S, D = x.shape
        H = 32; Dh = D // H; W = 256
        qkv = (lambda x, *d: x.permute(*d))((x @ wqkv).reshape(B, S, 3, H, Dh), 2, 0, 3, 1, 4)
        q, k, v = qkv[0], qkv[1], qkv[2]
        scores = torch.einsum("bhqd,bhkd->bhqk", q, k) * (Dh ** -0.5)
        idx = torch.arange(S)
        mask = (idx[:, None] - idx[None, :] >= 0) & (idx[:, None] - idx[None, :] < W)
        scores = torch.where(mask[None, None], scores, -1e9)
        p = _softmax(scores, axis=-1)
        o = torch.einsum("bhqk,bhkd->bhqd", p, v)
        return (lambda x, *d: x.permute(*d))(o, 0, 2, 1, 3).reshape(B, S, D) @ wo

    def _B_ref(x, w_gate, w_up, w_down):
        g = torch.einsum("bsd,df->bsf", x, w_gate)
        u = torch.einsum("bsd,df->bsf", x, w_up)
        h = _sigmoid(g) * u
        return torch.einsum("bsf,fd->bsd", h, w_down)

    x = A_x
    xn = _layernorm(x, axis=-1)
    s = _A_ref(xn, A_wqkv, A_wo)
    g = _silu(_B_ref(xn, B_w_gate, B_w_up, B_w_down))
    return x + s * g
```

```asm
; @launch grid=(256,1,1) block=(512,1,1) lds=163840
.amdgcn_target "amdgcn-amd-amdhsa--gfx950"
.text
.globl recurrent_scan__sliding_block__glu_gated_glu__prompt_kernel
.p2align 8
.type recurrent_scan__sliding_block__glu_gated_glu__prompt_kernel,@function
recurrent_scan__sliding_block__glu_gated_glu__prompt_kernel:
    s_cmp_ge_u32 s2, 256
    s_cbranch_scc1 mk_end
    s_load_dwordx4 s[4:7], s[0:1], 0
    s_load_dwordx4 s[60:63], s[0:1], 32
    s_load_dwordx2 s[40:41], s[0:1], 16
    s_load_dwordx4 s[36:39], s[0:1], 48
    s_load_dwordx4 s[48:51], s[0:1], 64
    v_lshrrev_b32 v1, 6, v0
    v_and_b32 v2, 63, v0
    s_bfe_u32 s55, s2, 0x20003
    v_readfirstlane_b32 s52, v1
    s_lshr_b32 s59, s2, 5
    s_bfe_u32 s56, s2, 0x10002
    s_lshl_b32 s56, s56, 3
    s_add_u32 s56, s56, s59
    s_lshl_b32 s57, s55, 1
    s_add_u32 s57, s57, s59
    s_and_b32 s54, s2, 3

    s_and_b32 s53, s52, 3
    s_mov_b32 s10, 2097152
    s_mov_b32 s11, 0x20000
    s_cmp_lt_u32 s52, 4
    s_cbranch_scc1 mk_A
    s_setprio 3
    v_lshrrev_b32 v3, 3, v2
    v_and_b32 v4, 7, v2
    v_lshrrev_b32 v5, 4, v2
    v_xor_b32 v6, v4, v5
    v_lshlrev_b32 v7, 10, v3
    v_lshl_add_u32 v104, v6, 4, v7
    v_xor_b32 v105, 64, v104
    v_add_u32 v105, 7168, v105
    s_lshl_b32 s74, s56, 3
    s_add_u32 s74, s74, s53
    s_lshl_b32 s74, s74, 14
    s_lshl_b32 s75, s53, 11
    s_waitcnt lgkmcnt(0)
    s_mov_b32 s8, s4
    s_mov_b32 s9, s5
    s_mov_b64 s[16:17], s[60:61]
    s_mov_b64 s[20:21], s[62:63]
    s_mov_b32 s60, s75
    s_mov_b32 s61, s74
    s_getpc_b64 s[30:31]
    s_lshr_b32 s1, s2, 3
    s_lshl_b32 s1, s1, 2
    s_add_u32 s1, s1, s53
    s_lshl_b32 s1, s1, 9
    v_and_b32 v12, 7, v2
    v_lshl_add_u32 v12, v12, 6, s1
    v_min_u32 v12, mk_code_end-recurrent_scan__sliding_block__glu_gated_glu__prompt_kernel-2048, v12
    v_mov_b32 v13, s31
    v_add_co_u32 v12, vcc, s30, v12
    s_nop 1
    v_addc_co_u32 v13, vcc, 0, v13, vcc
    s_add_u32 m0, s60, 0
    s_add_u32 s69, s57, 0
    s_and_b32 s69, s69, 7
    s_lshl_b32 s0, s69, 7
    s_add_u32 s0, s0, s61
    buffer_load_dwordx4 v104, s[8:11], s0 offen lds
    buffer_load_dwordx4 v105, s[8:11], s0 offen offset:1024 lds
    global_load_dword v14, v[12:13], off
    s_add_u32 m0, s60, 8192
    s_add_u32 s0, s0, 65536
    buffer_load_dwordx4 v104, s[8:11], s0 offen lds
    buffer_load_dwordx4 v105, s[8:11], s0 offen offset:1024 lds
    s_add_u32 m0, s60, 16384
    s_add_u32 s69, s57, 1
    s_and_b32 s69, s69, 7
    s_lshl_b32 s0, s69, 7
    s_add_u32 s0, s0, s61
    buffer_load_dwordx4 v104, s[8:11], s0 offen lds
    buffer_load_dwordx4 v105, s[8:11], s0 offen offset:1024 lds
    s_add_u32 m0, s60, 24576
    s_add_u32 s0, s0, 65536
    buffer_load_dwordx4 v104, s[8:11], s0 offen lds
    buffer_load_dwordx4 v105, s[8:11], s0 offen offset:1024 lds
    s_add_u32 m0, s60, 32768
    s_add_u32 s69, s57, 2
    s_and_b32 s69, s69, 7
    s_lshl_b32 s0, s69, 7
    s_add_u32 s0, s0, s61
    buffer_load_dwordx4 v104, s[8:11], s0 offen lds
    buffer_load_dwordx4 v105, s[8:11], s0 offen offset:1024 lds
    s_add_u32 m0, s60, 40960
    s_add_u32 s0, s0, 65536
    buffer_load_dwordx4 v104, s[8:11], s0 offen lds
    buffer_load_dwordx4 v105, s[8:11], s0 offen offset:1024 lds
    s_branch mk_B1
mk_A:
    s_setprio 2
    v_and_b32 v3, 31, v2
    v_lshrrev_b32 v4, 5, v2
    v_bfe_u32 v5, v2, 1, 3
    s_lshl_b32 s74, s53, 12
    v_lshl_add_u32 v6, v3, 7, s74
    v_xor_b32 v8, v4, v5
    v_lshl_add_u32 v8, v8, 4, v6
    v_xor_b32 v9, 32, v8
    v_xor_b32 v10, 64, v8
    v_xor_b32 v11, 0x60, v8
    v_mov_b32 v16, 0
    v_mov_b32 v17, 0
    v_mov_b32 v18, 0
    v_mov_b32 v19, 0
    v_lshlrev_b32 v122, 4, v2
    v_lshlrev_b32 v20, 2, v3
    v_add_u32 v20, 156160, v20
    ds_write_b32 v20, v16
    s_mov_b32 s59, 0x3f803f80
    v_lshrrev_b32 v21, 5, v2
    v_bfe_u32 v23, v2, 2, 2
    v_lshl_add_u32 v23, v21, 3, v23
    v_lshlrev_b32 v23, 7, v23
    v_bfe_u32 v24, v2, 4, 1
    v_lshl_add_u32 v23, v24, 5, v23
    v_and_b32 v25, 3, v2
    v_lshl_add_u32 v23, v25, 3, v23
    v_bfe_u32 v25, v2, 3, 1
    v_lshl_add_u32 v120, v25, 6, v23
    v_xor_b32 v121, 64, v120
    v_and_b32 v22, 15, v2
    v_lshl_add_u32 v22, v4, 4, v22
    v_lshlrev_b32 v22, 4, v22
    v_bfe_u32 v23, v2, 4, 1
    v_lshl_add_u32 v127, v23, 16, v22
    s_waitcnt lgkmcnt(0)
    s_mov_b32 s8, s4
    s_mov_b32 s9, s5
    s_mov_b32 s44, s38
    s_mov_b32 s45, s39
    s_mov_b32 s46, 2097152
    s_mov_b32 s47, 0x20000
    s_mov_b32 s38, 1835008
    s_mov_b32 s39, 0x20000
    s_mov_b32 s32, s50
    s_mov_b32 s33, s51
    s_mov_b32 s34, 15761664
    s_mov_b32 s35, 0x20000
    s_mov_b32 s50, 256
    s_mov_b32 s51, 0x20000
    s_lshl_b32 s60, s56, 2
    s_add_u32 s60, s60, s53
    s_mul_i32 s1, s60, 147456
    s_add_u32 s1, s1, 6291456
    s_mul_i32 s5, s54, 7
    s_lshl_b32 s4, s55, 1
    s_add_u32 s61, s5, s4
    s_lshl_b32 s61, s61, 12
    s_add_u32 s61, s61, s1
    s_add_u32 s4, s4, 1
    s_min_u32 s4, s4, 6
    s_add_u32 s62, s5, s4
    s_lshl_b32 s62, s62, 12
    s_add_u32 s62, s62, s1
    s_lshl_b32 s64, s54, 9
    s_add_u32 s64, s64, s60
    s_lshl_b32 s64, s64, 10
    s_and_b32 s4, s55, 1
    s_lshl_b32 s4, s4, 18
    s_add_u32 s63, s64, s4
    s_lshr_b32 s4, s55, 1
    s_lshl_b32 s4, s4, 21
    s_add_u32 s63, s63, s4
    s_add_u32 s64, s64, 4194304
    s_cmp_lt_u32 s55, 2
    s_cselect_b32 s65, 0x3eb8aa3b, 1.0
    s_lshl_b32 s66, s54, 4
    s_add_u32 s66, s66, s56
    s_lshl_b32 s66, s66, 5
    s_add_u32 s66, s66, s55
    s_lshl_b32 s66, s66, 2
    s_add_u32 s66, s66, 15728640
    s_lshl_b32 s72, s53, 7
    s_add_u32 s72, s72, 155648
    v_lshl_add_u32 v20, v3, 2, s72
    s_and_b32 s1, s2, 7
    s_lshr_b32 s4, s2, 6
    s_lshl_b32 s67, s1, 2
    s_add_u32 s67, s67, s4
    s_bfe_u32 s68, s2, 0x30003
    s_lshl_b32 s69, s53, 13
    s_mul_i32 s71, s67, 294912
    s_mul_i32 s0, s53, 28672
    s_add_u32 s71, s71, s0
    s_add_u32 s71, s71, 6291456
    s_lshl_b32 s70, s68, 7
    s_mul_i32 s0, s53, 458752
    s_add_u32 s70, s70, s0
    s_barrier
    ds_read_b128 v[128:131], v8 offset:0
    ds_read_b128 v[132:135], v9 offset:0
    ds_read_b128 v[136:139], v10 offset:0
    ds_read_b128 v[140:143], v11 offset:0
    s_barrier
    ds_read_b128 v[144:147], v8 offset:16384
    ds_read_b128 v[148:151], v9 offset:16384
    ds_read_b128 v[152:155], v10 offset:16384
    ds_read_b128 v[156:159], v11 offset:16384
    s_waitcnt lgkmcnt(4)
    v_dot2_f32_bf16 v16, v128, s59, v16
    v_dot2_f32_bf16 v18, v128, v128, v18
    v_dot2_f32_bf16 v17, v129, s59, v17
    v_dot2_f32_bf16 v19, v129, v129, v19
    v_dot2_f32_bf16 v16, v130, s59, v16
    v_dot2_f32_bf16 v18, v130, v130, v18
    v_dot2_f32_bf16 v17, v131, s59, v17
    v_dot2_f32_bf16 v19, v131, v131, v19
    v_dot2_f32_bf16 v16, v132, s59, v16
    v_dot2_f32_bf16 v18, v132, v132, v18
    v_dot2_f32_bf16 v17, v133, s59, v17
    v_dot2_f32_bf16 v19, v133, v133, v19
    v_dot2_f32_bf16 v16, v134, s59, v16
    v_dot2_f32_bf16 v18, v134, v134, v18
    v_dot2_f32_bf16 v17, v135, s59, v17
    v_dot2_f32_bf16 v19, v135, v135, v19
    v_dot2_f32_bf16 v16, v136, s59, v16
    v_dot2_f32_bf16 v18, v136, v136, v18
    v_dot2_f32_bf16 v17, v137, s59, v17
    v_dot2_f32_bf16 v19, v137, v137, v19
    v_dot2_f32_bf16 v16, v138, s59, v16
    v_dot2_f32_bf16 v18, v138, v138, v18
    v_dot2_f32_bf16 v17, v139, s59, v17
    v_dot2_f32_bf16 v19, v139, v139, v19
    v_dot2_f32_bf16 v16, v140, s59, v16
    v_dot2_f32_bf16 v18, v140, v140, v18
    v_dot2_f32_bf16 v17, v141, s59, v17
    v_dot2_f32_bf16 v19, v141, v141, v19
    v_dot2_f32_bf16 v16, v142, s59, v16
    v_dot2_f32_bf16 v18, v142, v142, v18
    v_dot2_f32_bf16 v17, v143, s59, v17
    v_dot2_f32_bf16 v19, v143, v143, v19
    s_barrier
    ds_read_b128 v[160:163], v8 offset:32768
    ds_read_b128 v[164:167], v9 offset:32768
    ds_read_b128 v[168:171], v10 offset:32768
    ds_read_b128 v[172:175], v11 offset:32768
    s_waitcnt lgkmcnt(4)
    v_dot2_f32_bf16 v16, v144, s59, v16
    v_dot2_f32_bf16 v18, v144, v144, v18
    v_dot2_f32_bf16 v17, v145, s59, v17
    v_dot2_f32_bf16 v19, v145, v145, v19
    v_dot2_f32_bf16 v16, v146, s59, v16
    v_dot2_f32_bf16 v18, v146, v146, v18
    v_dot2_f32_bf16 v17, v147, s59, v17
    v_dot2_f32_bf16 v19, v147, v147, v19
    v_dot2_f32_bf16 v16, v148, s59, v16
    v_dot2_f32_bf16 v18, v148, v148, v18
    v_dot2_f32_bf16 v17, v149, s59, v17
    v_dot2_f32_bf16 v19, v149, v149, v19
    v_dot2_f32_bf16 v16, v150, s59, v16
    v_dot2_f32_bf16 v18, v150, v150, v18
    v_dot2_f32_bf16 v17, v151, s59, v17
    v_dot2_f32_bf16 v19, v151, v151, v19
    v_dot2_f32_bf16 v16, v152, s59, v16
    v_dot2_f32_bf16 v18, v152, v152, v18
    v_dot2_f32_bf16 v17, v153, s59, v17
    v_dot2_f32_bf16 v19, v153, v153, v19
    v_dot2_f32_bf16 v16, v154, s59, v16
    v_dot2_f32_bf16 v18, v154, v154, v18
    v_dot2_f32_bf16 v17, v155, s59, v17
    v_dot2_f32_bf16 v19, v155, v155, v19
    v_dot2_f32_bf16 v16, v156, s59, v16
    v_dot2_f32_bf16 v18, v156, v156, v18
    v_dot2_f32_bf16 v17, v157, s59, v17
    v_dot2_f32_bf16 v19, v157, v157, v19
    v_dot2_f32_bf16 v16, v158, s59, v16
    v_dot2_f32_bf16 v18, v158, v158, v18
    v_dot2_f32_bf16 v17, v159, s59, v17
    v_dot2_f32_bf16 v19, v159, v159, v19
    s_barrier
    ds_read_b128 v[176:179], v8 offset:49152
    ds_read_b128 v[180:183], v9 offset:49152
    ds_read_b128 v[184:187], v10 offset:49152
    ds_read_b128 v[188:191], v11 offset:49152
    s_waitcnt lgkmcnt(4)
    v_dot2_f32_bf16 v16, v160, s59, v16
    v_dot2_f32_bf16 v18, v160, v160, v18
    v_dot2_f32_bf16 v17, v161, s59, v17
    v_dot2_f32_bf16 v19, v161, v161, v19
    v_dot2_f32_bf16 v16, v162, s59, v16
    v_dot2_f32_bf16 v18, v162, v162, v18
    v_dot2_f32_bf16 v17, v163, s59, v17
    v_dot2_f32_bf16 v19, v163, v163, v19
    v_dot2_f32_bf16 v16, v164, s59, v16
    v_dot2_f32_bf16 v18, v164, v164, v18
    v_dot2_f32_bf16 v17, v165, s59, v17
    v_dot2_f32_bf16 v19, v165, v165, v19
    v_dot2_f32_bf16 v16, v166, s59, v16
    v_dot2_f32_bf16 v18, v166, v166, v18
    v_dot2_f32_bf16 v17, v167, s59, v17
    v_dot2_f32_bf16 v19, v167, v167, v19
    v_dot2_f32_bf16 v16, v168, s59, v16
    v_dot2_f32_bf16 v18, v168, v168, v18
    v_dot2_f32_bf16 v17, v169, s59, v17
    v_dot2_f32_bf16 v19, v169, v169, v19
    v_dot2_f32_bf16 v16, v170, s59, v16
    v_dot2_f32_bf16 v18, v170, v170, v18
    v_dot2_f32_bf16 v17, v171, s59, v17
    v_dot2_f32_bf16 v19, v171, v171, v19
    v_dot2_f32_bf16 v16, v172, s59, v16
    v_dot2_f32_bf16 v18, v172, v172, v18
    v_dot2_f32_bf16 v17, v173, s59, v17
    v_dot2_f32_bf16 v19, v173, v173, v19
    v_dot2_f32_bf16 v16, v174, s59, v16
    v_dot2_f32_bf16 v18, v174, v174, v18
    v_dot2_f32_bf16 v17, v175, s59, v17
    v_dot2_f32_bf16 v19, v175, v175, v19
    s_barrier
    v_add_u32 v8, 0x10000, v8
    v_add_u32 v9, 0x10000, v9
    v_add_u32 v10, 0x10000, v10
    v_add_u32 v11, 0x10000, v11
    ds_read_b128 v[192:195], v8 offset:0
    ds_read_b128 v[196:199], v9 offset:0
    ds_read_b128 v[200:203], v10 offset:0
    ds_read_b128 v[204:207], v11 offset:0
    s_waitcnt lgkmcnt(4)
    v_dot2_f32_bf16 v16, v176, s59, v16
    v_dot2_f32_bf16 v18, v176, v176, v18
    v_dot2_f32_bf16 v17, v177, s59, v17
    v_dot2_f32_bf16 v19, v177, v177, v19
    v_dot2_f32_bf16 v16, v178, s59, v16
    v_dot2_f32_bf16 v18, v178, v178, v18
    v_dot2_f32_bf16 v17, v179, s59, v17
    v_dot2_f32_bf16 v19, v179, v179, v19
    v_dot2_f32_bf16 v16, v180, s59, v16
    v_dot2_f32_bf16 v18, v180, v180, v18
    v_dot2_f32_bf16 v17, v181, s59, v17
    v_dot2_f32_bf16 v19, v181, v181, v19
    v_dot2_f32_bf16 v16, v182, s59, v16
    v_dot2_f32_bf16 v18, v182, v182, v18
    v_dot2_f32_bf16 v17, v183, s59, v17
    v_dot2_f32_bf16 v19, v183, v183, v19
    v_dot2_f32_bf16 v16, v184, s59, v16
    v_dot2_f32_bf16 v18, v184, v184, v18
    v_dot2_f32_bf16 v17, v185, s59, v17
    v_dot2_f32_bf16 v19, v185, v185, v19
    v_dot2_f32_bf16 v16, v186, s59, v16
    v_dot2_f32_bf16 v18, v186, v186, v18
    v_dot2_f32_bf16 v17, v187, s59, v17
    v_dot2_f32_bf16 v19, v187, v187, v19
    v_dot2_f32_bf16 v16, v188, s59, v16
    v_dot2_f32_bf16 v18, v188, v188, v18
    v_dot2_f32_bf16 v17, v189, s59, v17
    v_dot2_f32_bf16 v19, v189, v189, v19
    v_dot2_f32_bf16 v16, v190, s59, v16
    v_dot2_f32_bf16 v18, v190, v190, v18
    v_dot2_f32_bf16 v17, v191, s59, v17
    v_dot2_f32_bf16 v19, v191, v191, v19
    s_barrier
    ds_read_b128 v[208:211], v8 offset:16384
    ds_read_b128 v[212:215], v9 offset:16384
    ds_read_b128 v[216:219], v10 offset:16384
    ds_read_b128 v[220:223], v11 offset:16384
    s_waitcnt lgkmcnt(4)
    v_dot2_f32_bf16 v16, v192, s59, v16
    v_dot2_f32_bf16 v18, v192, v192, v18
    v_dot2_f32_bf16 v17, v193, s59, v17
    v_dot2_f32_bf16 v19, v193, v193, v19
    v_dot2_f32_bf16 v16, v194, s59, v16
    v_dot2_f32_bf16 v18, v194, v194, v18
    v_dot2_f32_bf16 v17, v195, s59, v17
    v_dot2_f32_bf16 v19, v195, v195, v19
    v_dot2_f32_bf16 v16, v196, s59, v16
    v_dot2_f32_bf16 v18, v196, v196, v18
    v_dot2_f32_bf16 v17, v197, s59, v17
    v_dot2_f32_bf16 v19, v197, v197, v19
    v_dot2_f32_bf16 v16, v198, s59, v16
    v_dot2_f32_bf16 v18, v198, v198, v18
    v_dot2_f32_bf16 v17, v199, s59, v17
    v_dot2_f32_bf16 v19, v199, v199, v19
    v_dot2_f32_bf16 v16, v200, s59, v16
    v_dot2_f32_bf16 v18, v200, v200, v18
    v_dot2_f32_bf16 v17, v201, s59, v17
    v_dot2_f32_bf16 v19, v201, v201, v19
    v_dot2_f32_bf16 v16, v202, s59, v16
    v_dot2_f32_bf16 v18, v202, v202, v18
    v_dot2_f32_bf16 v17, v203, s59, v17
    v_dot2_f32_bf16 v19, v203, v203, v19
    v_dot2_f32_bf16 v16, v204, s59, v16
    v_dot2_f32_bf16 v18, v204, v204, v18
    v_dot2_f32_bf16 v17, v205, s59, v17
    v_dot2_f32_bf16 v19, v205, v205, v19
    v_dot2_f32_bf16 v16, v206, s59, v16
    v_dot2_f32_bf16 v18, v206, v206, v18
    v_dot2_f32_bf16 v17, v207, s59, v17
    v_dot2_f32_bf16 v19, v207, v207, v19
    s_barrier
    ds_read_b128 v[224:227], v8 offset:32768
    ds_read_b128 v[228:231], v9 offset:32768
    ds_read_b128 v[232:235], v10 offset:32768
    ds_read_b128 v[236:239], v11 offset:32768
    s_waitcnt lgkmcnt(4)
    v_dot2_f32_bf16 v16, v208, s59, v16
    v_dot2_f32_bf16 v18, v208, v208, v18
    v_dot2_f32_bf16 v17, v209, s59, v17
    v_dot2_f32_bf16 v19, v209, v209, v19
    v_dot2_f32_bf16 v16, v210, s59, v16
    v_dot2_f32_bf16 v18, v210, v210, v18
    v_dot2_f32_bf16 v17, v211, s59, v17
    v_dot2_f32_bf16 v19, v211, v211, v19
    v_dot2_f32_bf16 v16, v212, s59, v16
    v_dot2_f32_bf16 v18, v212, v212, v18
    v_dot2_f32_bf16 v17, v213, s59, v17
    v_dot2_f32_bf16 v19, v213, v213, v19
    v_dot2_f32_bf16 v16, v214, s59, v16
    v_dot2_f32_bf16 v18, v214, v214, v18
    v_dot2_f32_bf16 v17, v215, s59, v17
    v_dot2_f32_bf16 v19, v215, v215, v19
    v_dot2_f32_bf16 v16, v216, s59, v16
    v_dot2_f32_bf16 v18, v216, v216, v18
    v_dot2_f32_bf16 v17, v217, s59, v17
    v_dot2_f32_bf16 v19, v217, v217, v19
    v_dot2_f32_bf16 v16, v218, s59, v16
    v_dot2_f32_bf16 v18, v218, v218, v18
    v_dot2_f32_bf16 v17, v219, s59, v17
    v_dot2_f32_bf16 v19, v219, v219, v19
    v_dot2_f32_bf16 v16, v220, s59, v16
    v_dot2_f32_bf16 v18, v220, v220, v18
    v_dot2_f32_bf16 v17, v221, s59, v17
    v_dot2_f32_bf16 v19, v221, v221, v19
    v_dot2_f32_bf16 v16, v222, s59, v16
    v_dot2_f32_bf16 v18, v222, v222, v18
    v_dot2_f32_bf16 v17, v223, s59, v17
    v_dot2_f32_bf16 v19, v223, v223, v19
    s_barrier
    ds_read_b128 v[240:243], v8 offset:49152
    ds_read_b128 v[244:247], v9 offset:49152
    ds_read_b128 v[248:251], v10 offset:49152
    ds_read_b128 v[252:255], v11 offset:49152
    s_waitcnt lgkmcnt(4)
    v_dot2_f32_bf16 v16, v224, s59, v16
    v_dot2_f32_bf16 v18, v224, v224, v18
    v_dot2_f32_bf16 v17, v225, s59, v17
    v_dot2_f32_bf16 v19, v225, v225, v19
    v_dot2_f32_bf16 v16, v226, s59, v16
    v_dot2_f32_bf16 v18, v226, v226, v18
    v_dot2_f32_bf16 v17, v227, s59, v17
    v_dot2_f32_bf16 v19, v227, v227, v19
    v_dot2_f32_bf16 v16, v228, s59, v16
    v_dot2_f32_bf16 v18, v228, v228, v18
    v_dot2_f32_bf16 v17, v229, s59, v17
    v_dot2_f32_bf16 v19, v229, v229, v19
    v_dot2_f32_bf16 v16, v230, s59, v16
    v_dot2_f32_bf16 v18, v230, v230, v18
    v_dot2_f32_bf16 v17, v231, s59, v17
    v_dot2_f32_bf16 v19, v231, v231, v19
    v_dot2_f32_bf16 v16, v232, s59, v16
    v_dot2_f32_bf16 v18, v232, v232, v18
    v_dot2_f32_bf16 v17, v233, s59, v17
    v_dot2_f32_bf16 v19, v233, v233, v19
    v_dot2_f32_bf16 v16, v234, s59, v16
    v_dot2_f32_bf16 v18, v234, v234, v18
    v_dot2_f32_bf16 v17, v235, s59, v17
    v_dot2_f32_bf16 v19, v235, v235, v19
    v_dot2_f32_bf16 v16, v236, s59, v16
    v_dot2_f32_bf16 v18, v236, v236, v18
    v_dot2_f32_bf16 v17, v237, s59, v17
    v_dot2_f32_bf16 v19, v237, v237, v19
    v_dot2_f32_bf16 v16, v238, s59, v16
    v_dot2_f32_bf16 v18, v238, v238, v18
    v_dot2_f32_bf16 v17, v239, s59, v17
    v_dot2_f32_bf16 v19, v239, v239, v19
    s_waitcnt lgkmcnt(0)
    v_dot2_f32_bf16 v16, v240, s59, v16
    v_dot2_f32_bf16 v18, v240, v240, v18
    v_dot2_f32_bf16 v17, v241, s59, v17
    v_dot2_f32_bf16 v19, v241, v241, v19
    v_dot2_f32_bf16 v16, v242, s59, v16
    v_dot2_f32_bf16 v18, v242, v242, v18
    v_dot2_f32_bf16 v17, v243, s59, v17
    v_dot2_f32_bf16 v19, v243, v243, v19
    v_dot2_f32_bf16 v16, v244, s59, v16
    v_dot2_f32_bf16 v18, v244, v244, v18
    v_dot2_f32_bf16 v17, v245, s59, v17
    v_dot2_f32_bf16 v19, v245, v245, v19
    v_dot2_f32_bf16 v16, v246, s59, v16
    v_dot2_f32_bf16 v18, v246, v246, v18
    v_dot2_f32_bf16 v17, v247, s59, v17
    v_dot2_f32_bf16 v19, v247, v247, v19
    v_dot2_f32_bf16 v16, v248, s59, v16
    v_dot2_f32_bf16 v18, v248, v248, v18
    v_dot2_f32_bf16 v17, v249, s59, v17
    v_dot2_f32_bf16 v19, v249, v249, v19
    v_dot2_f32_bf16 v16, v250, s59, v16
    v_dot2_f32_bf16 v18, v250, v250, v18
    v_dot2_f32_bf16 v17, v251, s59, v17
    v_dot2_f32_bf16 v19, v251, v251, v19
    v_dot2_f32_bf16 v16, v252, s59, v16
    v_dot2_f32_bf16 v18, v252, v252, v18
    v_dot2_f32_bf16 v17, v253, s59, v17
    v_dot2_f32_bf16 v19, v253, v253, v19
    v_dot2_f32_bf16 v16, v254, s59, v16
    v_dot2_f32_bf16 v18, v254, v254, v18
    v_dot2_f32_bf16 v17, v255, s59, v17
    v_dot2_f32_bf16 v19, v255, v255, v19
    s_nop 2
    v_add_f32 v16, v16, v17
    v_add_f32 v18, v18, v19
    v_mov_b32 v17, v16
    v_mov_b32 v19, v18
    s_nop 1
    v_permlane32_swap_b32 v16, v17
    v_permlane32_swap_b32 v18, v19
    v_add_f32 v16, v16, v17
    v_add_f32 v18, v18, v19
    v_mul_f32 v16, 0x3b000000, v16
    v_mul_f32 v18, 0x3b000000, v18
    v_fma_f32 v18, -v16, v16, v18
    v_max_f32 v18, 0, v18
    v_cvt_pk_bf16_f32 v16, v16, v18
    v_and_b32 v18, 0xffff0000, v16
    v_lshlrev_b32 v16, 16, v16
    v_sub_f32 v123, 0, v16
    v_add_f32 v116, 0x3727c5ac, v18
    v_cvt_pk_bf16_f32 v116, v116, v116
    v_and_b32 v116, 0xffff0000, v116
    v_sqrt_f32 v116, v116
    v_mov_b32 v117, v20
    v_cvt_pk_bf16_f32 v116, v116, v116
    v_and_b32 v124, 0xffff0000, v116
    v_rcp_f32 v116, v124
    s_nop 0
    v_mul_f32 v125, 0xbfb8aa3b, v116
    v_mul_f32 v126, s65, v116
    ds_write_b32 v117, v116
    v_lshlrev_b32 v64, 16, v128
    v_and_b32 v65, 0xffff0000, v128
    v_add_f32 v64, v64, v123
    v_add_f32 v65, v65, v123
    v_cvt_pk_bf16_f32 v128, v64, v65
    v_lshlrev_b32 v66, 16, v129
    v_and_b32 v67, 0xffff0000, v129
    v_add_f32 v66, v66, v123
    v_add_f32 v67, v67, v123
    v_cvt_pk_bf16_f32 v129, v66, v67
    v_lshlrev_b32 v64, 16, v130
    v_and_b32 v65, 0xffff0000, v130
    v_add_f32 v64, v64, v123
    v_add_f32 v65, v65, v123
    v_cvt_pk_bf16_f32 v130, v64, v65
    v_lshlrev_b32 v66, 16, v131
    v_and_b32 v67, 0xffff0000, v131
    v_add_f32 v66, v66, v123
    v_add_f32 v67, v67, v123
    v_cvt_pk_bf16_f32 v131, v66, v67
    s_cmp_eq_u32 s55, 3
    s_cbranch_scc1 mk_typeB
    s_barrier
    v_add_u32 v120, 131072, v120
    v_add_u32 v121, 131072, v121
    ds_read_b64_tr_b16 v[96:97], v120 offset:0
    ds_read_b64_tr_b16 v[98:99], v120 offset:512
    ds_read_b64_tr_b16 v[100:101], v121 offset:0
    ds_read_b64_tr_b16 v[102:103], v121 offset:512
    ds_read_b64_tr_b16 v[104:105], v120 offset:8192
    ds_read_b64_tr_b16 v[106:107], v120 offset:8704
    ds_read_b64_tr_b16 v[108:109], v121 offset:8192
    ds_read_b64_tr_b16 v[110:111], v121 offset:8704
    ds_read_b64_tr_b16 v[112:113], v120 offset:2048
    ds_read_b64_tr_b16 v[114:115], v120 offset:2560
    s_waitcnt lgkmcnt(6)
    v_mfma_f32_32x32x16_bf16 v[0:15], v[96:99], v[128:131], 0
    ds_read_b64_tr_b16 v[96:97], v121 offset:2048
    ds_read_b64_tr_b16 v[98:99], v121 offset:2560
    v_lshlrev_b32 v64, 16, v132
    v_and_b32 v65, 0xffff0000, v132
    v_add_f32 v64, v64, v123
    v_add_f32 v65, v65, v123
    v_cvt_pk_bf16_f32 v132, v64, v65
    v_lshlrev_b32 v66, 16, v133
    v_and_b32 v67, 0xffff0000, v133
    v_mfma_f32_32x32x16_bf16 v[16:31], v[100:103], v[128:131], 0
    ds_read_b64_tr_b16 v[100:101], v120 offset:10240
    ds_read_b64_tr_b16 v[102:103], v120 offset:10752
    v_add_f32 v66, v66, v123
    v_add_f32 v67, v67, v123
    v_cvt_pk_bf16_f32 v133, v66, v67
    v_lshlrev_b32 v64, 16, v134
    v_and_b32 v65, 0xffff0000, v134
    v_add_f32 v64, v64, v123
    s_waitcnt lgkmcnt(6)
    v_mfma_f32_32x32x16_bf16 v[32:47], v[104:107], v[128:131], 0
    ds_read_b64_tr_b16 v[104:105], v121 offset:10240
    ds_read_b64_tr_b16 v[106:107], v121 offset:10752
    v_add_f32 v65, v65, v123
    v_cvt_pk_bf16_f32 v134, v64, v65
    v_lshlrev_b32 v66, 16, v135
    v_and_b32 v67, 0xffff0000, v135
    v_add_f32 v66, v66, v123
    v_add_f32 v67, v67, v123
    v_cvt_pk_bf16_f32 v135, v66, v67
    v_mfma_f32_32x32x16_bf16 v[48:63], v[108:111], v[128:131], 0
    ds_read_b64_tr_b16 v[108:109], v120 offset:4096
    ds_read_b64_tr_b16 v[110:111], v120 offset:4608
    v_lshlrev_b32 v64, 16, v136
    v_and_b32 v65, 0xffff0000, v136
    v_add_f32 v64, v64, v123
    v_add_f32 v65, v65, v123
    v_cvt_pk_bf16_f32 v136, v64, v65
    s_waitcnt lgkmcnt(6)
    v_mfma_f32_32x32x16_bf16 v[0:15], v[112:115], v[132:135], v[0:15]
    ds_read_b64_tr_b16 v[112:113], v121 offset:4096
    ds_read_b64_tr_b16 v[114:115], v121 offset:4608
    v_lshlrev_b32 v66, 16, v137
    v_and_b32 v67, 0xffff0000, v137
    v_add_f32 v66, v66, v123
    v_add_f32 v67, v67, v123
    v_cvt_pk_bf16_f32 v137, v66, v67
    v_mfma_f32_32x32x16_bf16 v[16:31], v[96:99], v[132:135], v[16:31]
    ds_read_b64_tr_b16 v[96:97], v120 offset:12288
    ds_read_b64_tr_b16 v[98:99], v120 offset:12800
    v_lshlrev_b32 v64, 16, v138
    v_and_b32 v65, 0xffff0000, v138
    v_add_f32 v64, v64, v123
    v_add_f32 v65, v65, v123
    v_cvt_pk_bf16_f32 v138, v64, v65
    s_waitcnt lgkmcnt(6)
    v_mfma_f32_32x32x16_bf16 v[32:47], v[100:103], v[132:135], v[32:47]
    ds_read_b64_tr_b16 v[100:101], v121 offset:12288
    ds_read_b64_tr_b16 v[102:103], v121 offset:12800
    v_lshlrev_b32 v66, 16, v139
    v_and_b32 v67, 0xffff0000, v139
    v_add_f32 v66, v66, v123
    v_add_f32 v67, v67, v123
    v_cvt_pk_bf16_f32 v139, v66, v67
    v_mfma_f32_32x32x16_bf16 v[48:63], v[104:107], v[132:135], v[48:63]
    ds_read_b64_tr_b16 v[104:105], v120 offset:6144
    ds_read_b64_tr_b16 v[106:107], v120 offset:6656
    v_lshlrev_b32 v64, 16, v140
    v_and_b32 v65, 0xffff0000, v140
    v_add_f32 v64, v64, v123
    v_add_f32 v65, v65, v123
    v_cvt_pk_bf16_f32 v140, v64, v65
    s_waitcnt lgkmcnt(6)
    v_mfma_f32_32x32x16_bf16 v[0:15], v[108:111], v[136:139], v[0:15]
    ds_read_b64_tr_b16 v[108:109], v121 offset:6144
    ds_read_b64_tr_b16 v[110:111], v121 offset:6656
    v_lshlrev_b32 v66, 16, v141
    v_and_b32 v67, 0xffff0000, v141
    v_add_f32 v66, v66, v123
    v_add_f32 v67, v67, v123
    v_cvt_pk_bf16_f32 v141, v66, v67
    v_mfma_f32_32x32x16_bf16 v[16:31], v[112:115], v[136:139], v[16:31]
    ds_read_b64_tr_b16 v[112:113], v120 offset:14336
    ds_read_b64_tr_b16 v[114:115], v120 offset:14848
    v_lshlrev_b32 v64, 16, v142
    v_and_b32 v65, 0xffff0000, v142
    v_add_f32 v64, v64, v123
    v_add_f32 v65, v65, v123
    v_cvt_pk_bf16_f32 v142, v64, v65
    s_waitcnt lgkmcnt(6)
    v_mfma_f32_32x32x16_bf16 v[32:47], v[96:99], v[136:139], v[32:47]
    ds_read_b64_tr_b16 v[96:97], v121 offset:14336
    ds_read_b64_tr_b16 v[98:99], v121 offset:14848
    v_lshlrev_b32 v66, 16, v143
    v_and_b32 v67, 0xffff0000, v143
    v_add_f32 v66, v66, v123
    v_add_f32 v67, v67, v123
    v_cvt_pk_bf16_f32 v143, v66, v67
    v_mfma_f32_32x32x16_bf16 v[48:63], v[100:103], v[136:139], v[48:63]
    s_barrier
    v_add_u32 v120, 4294836224, v120
    v_add_u32 v121, 4294836224, v121
    ds_read_b64_tr_b16 v[100:101], v120 offset:0
    ds_read_b64_tr_b16 v[102:103], v120 offset:512
    v_lshlrev_b32 v64, 16, v144
    v_and_b32 v65, 0xffff0000, v144
    v_add_f32 v64, v64, v123
    v_add_f32 v65, v65, v123
    v_cvt_pk_bf16_f32 v144, v64, v65
    s_waitcnt lgkmcnt(6)
    v_mfma_f32_32x32x16_bf16 v[0:15], v[104:107], v[140:143], v[0:15]
    ds_read_b64_tr_b16 v[104:105], v121 offset:0
    ds_read_b64_tr_b16 v[106:107], v121 offset:512
    v_lshlrev_b32 v66, 16, v145
    v_and_b32 v67, 0xffff0000, v145
    v_add_f32 v66, v66, v123
    v_add_f32 v67, v67, v123
    v_cvt_pk_bf16_f32 v145, v66, v67
    v_mfma_f32_32x32x16_bf16 v[16:31], v[108:111], v[140:143], v[16:31]
    ds_read_b64_tr_b16 v[108:109], v120 offset:8192
    ds_read_b64_tr_b16 v[110:111], v120 offset:8704
    v_lshlrev_b32 v64, 16, v146
    v_and_b32 v65, 0xffff0000, v146
    v_add_f32 v64, v64, v123
    v_add_f32 v65, v65, v123
    v_cvt_pk_bf16_f32 v146, v64, v65
    s_waitcnt lgkmcnt(6)
    v_mfma_f32_32x32x16_bf16 v[32:47], v[112:115], v[140:143], v[32:47]
    ds_read_b64_tr_b16 v[112:113], v121 offset:8192
    ds_read_b64_tr_b16 v[114:115], v121 offset:8704
    v_lshlrev_b32 v66, 16, v147
    v_and_b32 v67, 0xffff0000, v147
    v_add_f32 v66, v66, v123
    v_add_f32 v67, v67, v123
    v_cvt_pk_bf16_f32 v147, v66, v67
    v_mfma_f32_32x32x16_bf16 v[48:63], v[96:99], v[140:143], v[48:63]
    ds_read_b64_tr_b16 v[96:97], v120 offset:2048
    ds_read_b64_tr_b16 v[98:99], v120 offset:2560
    v_lshlrev_b32 v64, 16, v148
    v_and_b32 v65, 0xffff0000, v148
    v_add_f32 v64, v64, v123
    v_add_f32 v65, v65, v123
    v_cvt_pk_bf16_f32 v148, v64, v65
    s_waitcnt lgkmcnt(6)
    v_mfma_f32_32x32x16_bf16 v[0:15], v[100:103], v[144:147], v[0:15]
    ds_read_b64_tr_b16 v[100:101], v121 offset:2048
    ds_read_b64_tr_b16 v[102:103], v121 offset:2560
    v_lshlrev_b32 v66, 16, v149
    v_and_b32 v67, 0xffff0000, v149
    v_add_f32 v66, v66, v123
    v_add_f32 v67, v67, v123
    v_cvt_pk_bf16_f32 v149, v66, v67
    v_mfma_f32_32x32x16_bf16 v[16:31], v[104:107], v[144:147], v[16:31]
    ds_read_b64_tr_b16 v[104:105], v120 offset:10240
    ds_read_b64_tr_b16 v[106:107], v120 offset:10752
    v_lshlrev_b32 v64, 16, v150
    v_and_b32 v65, 0xffff0000, v150
    v_add_f32 v64, v64, v123
    v_add_f32 v65, v65, v123
    v_cvt_pk_bf16_f32 v150, v64, v65
    s_waitcnt lgkmcnt(6)
    v_mfma_f32_32x32x16_bf16 v[32:47], v[108:111], v[144:147], v[32:47]
    ds_read_b64_tr_b16 v[108:109], v121 offset:10240
    ds_read_b64_tr_b16 v[110:111], v121 offset:10752
    v_lshlrev_b32 v66, 16, v151
    v_and_b32 v67, 0xffff0000, v151
    v_add_f32 v66, v66, v123
    v_add_f32 v67, v67, v123
    v_cvt_pk_bf16_f32 v151, v66, v67
    v_mfma_f32_32x32x16_bf16 v[48:63], v[112:115], v[144:147], v[48:63]
    ds_read_b64_tr_b16 v[112:113], v120 offset:4096
    ds_read_b64_tr_b16 v[114:115], v120 offset:4608
    v_lshlrev_b32 v64, 16, v152
    v_and_b32 v65, 0xffff0000, v152
    v_add_f32 v64, v64, v123
    v_add_f32 v65, v65, v123
    v_cvt_pk_bf16_f32 v152, v64, v65
    s_waitcnt lgkmcnt(6)
    v_mfma_f32_32x32x16_bf16 v[0:15], v[96:99], v[148:151], v[0:15]
    ds_read_b64_tr_b16 v[96:97], v121 offset:4096
    ds_read_b64_tr_b16 v[98:99], v121 offset:4608
    v_lshlrev_b32 v66, 16, v153
    v_and_b32 v67, 0xffff0000, v153
    v_add_f32 v66, v66, v123
    v_add_f32 v67, v67, v123
    v_cvt_pk_bf16_f32 v153, v66, v67
    v_mfma_f32_32x32x16_bf16 v[16:31], v[100:103], v[148:151], v[16:31]
    ds_read_b64_tr_b16 v[100:101], v120 offset:12288
    ds_read_b64_tr_b16 v[102:103], v120 offset:12800
    v_lshlrev_b32 v64, 16, v154
    v_and_b32 v65, 0xffff0000, v154
    v_add_f32 v64, v64, v123
    v_add_f32 v65, v65, v123
    v_cvt_pk_bf16_f32 v154, v64, v65
    s_waitcnt lgkmcnt(6)
    v_mfma_f32_32x32x16_bf16 v[32:47], v[104:107], v[148:151], v[32:47]
    ds_read_b64_tr_b16 v[104:105], v121 offset:12288
    ds_read_b64_tr_b16 v[106:107], v121 offset:12800
    v_lshlrev_b32 v66, 16, v155
    v_and_b32 v67, 0xffff0000, v155
    v_add_f32 v66, v66, v123
    v_add_f32 v67, v67, v123
    v_cvt_pk_bf16_f32 v155, v66, v67
    v_mfma_f32_32x32x16_bf16 v[48:63], v[108:111], v[148:151], v[48:63]
    ds_read_b64_tr_b16 v[108:109], v120 offset:6144
    ds_read_b64_tr_b16 v[110:111], v120 offset:6656
    v_lshlrev_b32 v64, 16, v156
    v_and_b32 v65, 0xffff0000, v156
    v_add_f32 v64, v64, v123
    v_add_f32 v65, v65, v123
    v_cvt_pk_bf16_f32 v156, v64, v65
    s_waitcnt lgkmcnt(6)
    v_mfma_f32_32x32x16_bf16 v[0:15], v[112:115], v[152:155], v[0:15]
    ds_read_b64_tr_b16 v[112:113], v121 offset:6144
    ds_read_b64_tr_b16 v[114:115], v121 offset:6656
    v_lshlrev_b32 v66, 16, v157
    v_and_b32 v67, 0xffff0000, v157
    v_add_f32 v66, v66, v123
    v_add_f32 v67, v67, v123
    v_cvt_pk_bf16_f32 v157, v66, v67
    v_mfma_f32_32x32x16_bf16 v[16:31], v[96:99], v[152:155], v[16:31]
    ds_read_b64_tr_b16 v[96:97], v120 offset:14336
    ds_read_b64_tr_b16 v[98:99], v120 offset:14848
    v_lshlrev_b32 v64, 16, v158
    v_and_b32 v65, 0xffff0000, v158
    v_add_f32 v64, v64, v123
    v_add_f32 v65, v65, v123
    v_cvt_pk_bf16_f32 v158, v64, v65
    s_waitcnt lgkmcnt(6)
    v_mfma_f32_32x32x16_bf16 v[32:47], v[100:103], v[152:155], v[32:47]
    ds_read_b64_tr_b16 v[100:101], v121 offset:14336
    ds_read_b64_tr_b16 v[102:103], v121 offset:14848
    v_lshlrev_b32 v66, 16, v159
    v_and_b32 v67, 0xffff0000, v159
    v_add_f32 v66, v66, v123
    v_add_f32 v67, v67, v123
    v_cvt_pk_bf16_f32 v159, v66, v67
    v_mfma_f32_32x32x16_bf16 v[48:63], v[104:107], v[152:155], v[48:63]
    s_barrier
    ds_read_b64_tr_b16 v[104:105], v120 offset:49152
    ds_read_b64_tr_b16 v[106:107], v120 offset:49664
    v_lshlrev_b32 v64, 16, v160
    v_and_b32 v65, 0xffff0000, v160
    v_add_f32 v64, v64, v123
    v_add_f32 v65, v65, v123
    v_cvt_pk_bf16_f32 v160, v64, v65
    s_waitcnt lgkmcnt(6)
    v_mfma_f32_32x32x16_bf16 v[0:15], v[108:111], v[156:159], v[0:15]
    ds_read_b64_tr_b16 v[108:109], v121 offset:49152
    ds_read_b64_tr_b16 v[110:111], v121 offset:49664
    v_lshlrev_b32 v66, 16, v161
    v_and_b32 v67, 0xffff0000, v161
    v_add_f32 v66, v66, v123
    v_add_f32 v67, v67, v123
    v_cvt_pk_bf16_f32 v161, v66, v67
    v_mfma_f32_32x32x16_bf16 v[16:31], v[112:115], v[156:159], v[16:31]
    ds_read_b64_tr_b16 v[112:113], v120 offset:57344
    ds_read_b64_tr_b16 v[114:115], v120 offset:57856
    v_lshlrev_b32 v64, 16, v162
    v_and_b32 v65, 0xffff0000, v162
    v_add_f32 v64, v64, v123
    v_add_f32 v65, v65, v123
    v_cvt_pk_bf16_f32 v162, v64, v65
    s_waitcnt lgkmcnt(6)
    v_mfma_f32_32x32x16_bf16 v[32:47], v[96:99], v[156:159], v[32:47]
    ds_read_b64_tr_b16 v[96:97], v121 offset:57344
    ds_read_b64_tr_b16 v[98:99], v121 offset:57856
    v_lshlrev_b32 v66, 16, v163
    v_and_b32 v67, 0xffff0000, v163
    v_add_f32 v66, v66, v123
    v_add_f32 v67, v67, v123
    v_cvt_pk_bf16_f32 v163, v66, v67
    v_mfma_f32_32x32x16_bf16 v[48:63], v[100:103], v[156:159], v[48:63]
    ds_read_b64_tr_b16 v[100:101], v120 offset:51200
    ds_read_b64_tr_b16 v[102:103], v120 offset:51712
    v_lshlrev_b32 v64, 16, v164
    v_and_b32 v65, 0xffff0000, v164
    v_add_f32 v64, v64, v123
    v_add_f32 v65, v65, v123
    v_cvt_pk_bf16_f32 v164, v64, v65
    s_waitcnt lgkmcnt(6)
    v_mfma_f32_32x32x16_bf16 v[0:15], v[104:107], v[160:163], v[0:15]
    ds_read_b64_tr_b16 v[104:105], v121 offset:51200
    ds_read_b64_tr_b16 v[106:107], v121 offset:51712
    v_lshlrev_b32 v66, 16, v165
    v_and_b32 v67, 0xffff0000, v165
    v_add_f32 v66, v66, v123
    v_add_f32 v67, v67, v123
    v_cvt_pk_bf16_f32 v165, v66, v67
    v_mfma_f32_32x32x16_bf16 v[16:31], v[108:111], v[160:163], v[16:31]
    ds_read_b64_tr_b16 v[108:109], v120 offset:59392
    ds_read_b64_tr_b16 v[110:111], v120 offset:59904
    v_lshlrev_b32 v64, 16, v166
    v_and_b32 v65, 0xffff0000, v166
    v_add_f32 v64, v64, v123
    v_add_f32 v65, v65, v123
    v_cvt_pk_bf16_f32 v166, v64, v65
    s_waitcnt lgkmcnt(6)
    v_mfma_f32_32x32x16_bf16 v[32:47], v[112:115], v[160:163], v[32:47]
    ds_read_b64_tr_b16 v[112:113], v121 offset:59392
    ds_read_b64_tr_b16 v[114:115], v121 offset:59904
    v_lshlrev_b32 v66, 16, v167
    v_and_b32 v67, 0xffff0000, v167
    v_add_f32 v66, v66, v123
    v_add_f32 v67, v67, v123
    v_cvt_pk_bf16_f32 v167, v66, v67
    v_mfma_f32_32x32x16_bf16 v[48:63], v[96:99], v[160:163], v[48:63]
    ds_read_b64_tr_b16 v[96:97], v120 offset:53248
    ds_read_b64_tr_b16 v[98:99], v120 offset:53760
    v_lshlrev_b32 v64, 16, v168
    v_and_b32 v65, 0xffff0000, v168
    v_add_f32 v64, v64, v123
    v_add_f32 v65, v65, v123
    v_cvt_pk_bf16_f32 v168, v64, v65
    s_waitcnt lgkmcnt(6)
    v_mfma_f32_32x32x16_bf16 v[0:15], v[100:103], v[164:167], v[0:15]
    ds_read_b64_tr_b16 v[100:101], v121 offset:53248
    ds_read_b64_tr_b16 v[102:103], v121 offset:53760
    v_lshlrev_b32 v66, 16, v169
    v_and_b32 v67, 0xffff0000, v169
    v_add_f32 v66, v66, v123
    v_add_f32 v67, v67, v123
    v_cvt_pk_bf16_f32 v169, v66, v67
    v_mfma_f32_32x32x16_bf16 v[16:31], v[104:107], v[164:167], v[16:31]
    ds_read_b64_tr_b16 v[104:105], v120 offset:61440
    ds_read_b64_tr_b16 v[106:107], v120 offset:61952
    v_lshlrev_b32 v64, 16, v170
    v_and_b32 v65, 0xffff0000, v170
    v_add_f32 v64, v64, v123
    v_add_f32 v65, v65, v123
    v_cvt_pk_bf16_f32 v170, v64, v65
    s_waitcnt lgkmcnt(6)
    v_mfma_f32_32x32x16_bf16 v[32:47], v[108:111], v[164:167], v[32:47]
    ds_read_b64_tr_b16 v[108:109], v121 offset:61440
    ds_read_b64_tr_b16 v[110:111], v121 offset:61952
    v_lshlrev_b32 v66, 16, v171
    v_and_b32 v67, 0xffff0000, v171
    v_add_f32 v66, v66, v123
    v_add_f32 v67, v67, v123
    v_cvt_pk_bf16_f32 v171, v66, v67
    v_mfma_f32_32x32x16_bf16 v[48:63], v[112:115], v[164:167], v[48:63]
    ds_read_b64_tr_b16 v[112:113], v120 offset:55296
    ds_read_b64_tr_b16 v[114:115], v120 offset:55808
    v_lshlrev_b32 v64, 16, v172
    v_and_b32 v65, 0xffff0000, v172
    v_add_f32 v64, v64, v123
    v_add_f32 v65, v65, v123
    v_cvt_pk_bf16_f32 v172, v64, v65
    s_waitcnt lgkmcnt(6)
    v_mfma_f32_32x32x16_bf16 v[0:15], v[96:99], v[168:171], v[0:15]
    ds_read_b64_tr_b16 v[96:97], v121 offset:55296
    ds_read_b64_tr_b16 v[98:99], v121 offset:55808
    v_lshlrev_b32 v66, 16, v173
    v_and_b32 v67, 0xffff0000, v173
    v_add_f32 v66, v66, v123
    v_add_f32 v67, v67, v123
    v_cvt_pk_bf16_f32 v173, v66, v67
    v_mfma_f32_32x32x16_bf16 v[16:31], v[100:103], v[168:171], v[16:31]
    ds_read_b64_tr_b16 v[100:101], v120 offset:63488
    ds_read_b64_tr_b16 v[102:103], v120 offset:64000
    v_lshlrev_b32 v64, 16, v174
    v_and_b32 v65, 0xffff0000, v174
    v_add_f32 v64, v64, v123
    v_add_f32 v65, v65, v123
    v_cvt_pk_bf16_f32 v174, v64, v65
    s_waitcnt lgkmcnt(6)
    v_mfma_f32_32x32x16_bf16 v[32:47], v[104:107], v[168:171], v[32:47]
    ds_read_b64_tr_b16 v[104:105], v121 offset:63488
    ds_read_b64_tr_b16 v[106:107], v121 offset:64000
    v_lshlrev_b32 v66, 16, v175
    v_and_b32 v67, 0xffff0000, v175
    v_add_f32 v66, v66, v123
    v_add_f32 v67, v67, v123
    v_cvt_pk_bf16_f32 v175, v66, v67
    v_mfma_f32_32x32x16_bf16 v[48:63], v[108:111], v[168:171], v[48:63]
    s_barrier
    v_add_u32 v120, 65536, v120
    v_add_u32 v121, 65536, v121
    ds_read_b64_tr_b16 v[108:109], v120 offset:0
    ds_read_b64_tr_b16 v[110:111], v120 offset:512
    v_lshlrev_b32 v64, 16, v176
    v_and_b32 v65, 0xffff0000, v176
    v_add_f32 v64, v64, v123
    v_add_f32 v65, v65, v123
    v_cvt_pk_bf16_f32 v176, v64, v65
    s_waitcnt lgkmcnt(6)
    v_mfma_f32_32x32x16_bf16 v[0:15], v[112:115], v[172:175], v[0:15]
    ds_read_b64_tr_b16 v[112:113], v121 offset:0
    ds_read_b64_tr_b16 v[114:115], v121 offset:512
    v_lshlrev_b32 v66, 16, v177
    v_and_b32 v67, 0xffff0000, v177
    v_add_f32 v66, v66, v123
    v_add_f32 v67, v67, v123
    v_cvt_pk_bf16_f32 v177, v66, v67
    v_mfma_f32_32x32x16_bf16 v[16:31], v[96:99], v[172:175], v[16:31]
    ds_read_b64_tr_b16 v[96:97], v120 offset:8192
    ds_read_b64_tr_b16 v[98:99], v120 offset:8704
    v_lshlrev_b32 v64, 16, v178
    v_and_b32 v65, 0xffff0000, v178
    v_add_f32 v64, v64, v123
    v_add_f32 v65, v65, v123
    v_cvt_pk_bf16_f32 v178, v64, v65
    s_waitcnt lgkmcnt(6)
    v_mfma_f32_32x32x16_bf16 v[32:47], v[100:103], v[172:175], v[32:47]
    ds_read_b64_tr_b16 v[100:101], v121 offset:8192
    ds_read_b64_tr_b16 v[102:103], v121 offset:8704
    v_lshlrev_b32 v66, 16, v179
    v_and_b32 v67, 0xffff0000, v179
    v_add_f32 v66, v66, v123
    v_add_f32 v67, v67, v123
    v_cvt_pk_bf16_f32 v179, v66, v67
    v_mfma_f32_32x32x16_bf16 v[48:63], v[104:107], v[172:175], v[48:63]
    ds_read_b64_tr_b16 v[104:105], v120 offset:2048
    ds_read_b64_tr_b16 v[106:107], v120 offset:2560
    v_lshlrev_b32 v64, 16, v180
    v_and_b32 v65, 0xffff0000, v180
    v_add_f32 v64, v64, v123
    v_add_f32 v65, v65, v123
    v_cvt_pk_bf16_f32 v180, v64, v65
    s_waitcnt lgkmcnt(6)
    v_mfma_f32_32x32x16_bf16 v[0:15], v[108:111], v[176:179], v[0:15]
    ds_read_b64_tr_b16 v[108:109], v121 offset:2048
    ds_read_b64_tr_b16 v[110:111], v121 offset:2560
    v_lshlrev_b32 v66, 16, v181
    v_and_b32 v67, 0xffff0000, v181
    v_add_f32 v66, v66, v123
    v_add_f32 v67, v67, v123
    v_cvt_pk_bf16_f32 v181, v66, v67
    v_mfma_f32_32x32x16_bf16 v[16:31], v[112:115], v[176:179], v[16:31]
    ds_read_b64_tr_b16 v[112:113], v120 offset:10240
    ds_read_b64_tr_b16 v[114:115], v120 offset:10752
    v_lshlrev_b32 v64, 16, v182
    v_and_b32 v65, 0xffff0000, v182
    v_add_f32 v64, v64, v123
    v_add_f32 v65, v65, v123
    v_cvt_pk_bf16_f32 v182, v64, v65
    s_waitcnt lgkmcnt(6)
    v_mfma_f32_32x32x16_bf16 v[32:47], v[96:99], v[176:179], v[32:47]
    ds_read_b64_tr_b16 v[96:97], v121 offset:10240
    ds_read_b64_tr_b16 v[98:99], v121 offset:10752
    v_lshlrev_b32 v66, 16, v183
    v_and_b32 v67, 0xffff0000, v183
    v_add_f32 v66, v66, v123
    v_add_f32 v67, v67, v123
    v_cvt_pk_bf16_f32 v183, v66, v67
    v_mfma_f32_32x32x16_bf16 v[48:63], v[100:103], v[176:179], v[48:63]
    ds_read_b64_tr_b16 v[100:101], v120 offset:4096
    ds_read_b64_tr_b16 v[102:103], v120 offset:4608
    v_lshlrev_b32 v64, 16, v184
    v_and_b32 v65, 0xffff0000, v184
    v_add_f32 v64, v64, v123
    v_add_f32 v65, v65, v123
    v_cvt_pk_bf16_f32 v184, v64, v65
    s_waitcnt lgkmcnt(6)
    v_mfma_f32_32x32x16_bf16 v[0:15], v[104:107], v[180:183], v[0:15]
    ds_read_b64_tr_b16 v[104:105], v121 offset:4096
    ds_read_b64_tr_b16 v[106:107], v121 offset:4608
    v_lshlrev_b32 v66, 16, v185
    v_and_b32 v67, 0xffff0000, v185
    v_add_f32 v66, v66, v123
    v_add_f32 v67, v67, v123
    v_cvt_pk_bf16_f32 v185, v66, v67
    v_mfma_f32_32x32x16_bf16 v[16:31], v[108:111], v[180:183], v[16:31]
    ds_read_b64_tr_b16 v[108:109], v120 offset:12288
    ds_read_b64_tr_b16 v[110:111], v120 offset:12800
    v_lshlrev_b32 v64, 16, v186
    v_and_b32 v65, 0xffff0000, v186
    v_add_f32 v64, v64, v123
    v_add_f32 v65, v65, v123
    v_cvt_pk_bf16_f32 v186, v64, v65
    s_waitcnt lgkmcnt(6)
    v_mfma_f32_32x32x16_bf16 v[32:47], v[112:115], v[180:183], v[32:47]
    ds_read_b64_tr_b16 v[112:113], v121 offset:12288
    ds_read_b64_tr_b16 v[114:115], v121 offset:12800
    v_lshlrev_b32 v66, 16, v187
    v_and_b32 v67, 0xffff0000, v187
    v_add_f32 v66, v66, v123
    v_add_f32 v67, v67, v123
    v_cvt_pk_bf16_f32 v187, v66, v67
    v_mfma_f32_32x32x16_bf16 v[48:63], v[96:99], v[180:183], v[48:63]
    ds_read_b64_tr_b16 v[96:97], v120 offset:6144
    ds_read_b64_tr_b16 v[98:99], v120 offset:6656
    v_lshlrev_b32 v64, 16, v188
    v_and_b32 v65, 0xffff0000, v188
    v_add_f32 v64, v64, v123
    v_add_f32 v65, v65, v123
    v_cvt_pk_bf16_f32 v188, v64, v65
    s_waitcnt lgkmcnt(6)
    v_mfma_f32_32x32x16_bf16 v[0:15], v[100:103], v[184:187], v[0:15]
    ds_read_b64_tr_b16 v[100:101], v121 offset:6144
    ds_read_b64_tr_b16 v[102:103], v121 offset:6656
    v_lshlrev_b32 v66, 16, v189
    v_and_b32 v67, 0xffff0000, v189
    v_add_f32 v66, v66, v123
    v_add_f32 v67, v67, v123
    v_cvt_pk_bf16_f32 v189, v66, v67
    v_mfma_f32_32x32x16_bf16 v[16:31], v[104:107], v[184:187], v[16:31]
    ds_read_b64_tr_b16 v[104:105], v120 offset:14336
    ds_read_b64_tr_b16 v[106:107], v120 offset:14848
    v_lshlrev_b32 v64, 16, v190
    v_and_b32 v65, 0xffff0000, v190
    v_add_f32 v64, v64, v123
    v_add_f32 v65, v65, v123
    v_cvt_pk_bf16_f32 v190, v64, v65
    s_waitcnt lgkmcnt(6)
    v_mfma_f32_32x32x16_bf16 v[32:47], v[108:111], v[184:187], v[32:47]
    ds_read_b64_tr_b16 v[108:109], v121 offset:14336
    ds_read_b64_tr_b16 v[110:111], v121 offset:14848
    v_lshlrev_b32 v66, 16, v191
    v_and_b32 v67, 0xffff0000, v191
    v_add_f32 v66, v66, v123
    v_add_f32 v67, v67, v123
    v_cvt_pk_bf16_f32 v191, v66, v67
    v_mfma_f32_32x32x16_bf16 v[48:63], v[112:115], v[184:187], v[48:63]
    s_barrier
    ds_read_b64_tr_b16 v[112:113], v120 offset:16384
    ds_read_b64_tr_b16 v[114:115], v120 offset:16896
    v_lshlrev_b32 v64, 16, v192
    v_and_b32 v65, 0xffff0000, v192
    v_add_f32 v64, v64, v123
    v_add_f32 v65, v65, v123
    v_cvt_pk_bf16_f32 v192, v64, v65
    s_waitcnt lgkmcnt(6)
    v_mfma_f32_32x32x16_bf16 v[0:15], v[96:99], v[188:191], v[0:15]
    ds_read_b64_tr_b16 v[96:97], v121 offset:16384
    ds_read_b64_tr_b16 v[98:99], v121 offset:16896
    v_lshlrev_b32 v66, 16, v193
    v_and_b32 v67, 0xffff0000, v193
    v_add_f32 v66, v66, v123
    v_add_f32 v67, v67, v123
    v_cvt_pk_bf16_f32 v193, v66, v67
    v_mfma_f32_32x32x16_bf16 v[16:31], v[100:103], v[188:191], v[16:31]
    ds_read_b64_tr_b16 v[100:101], v120 offset:24576
    ds_read_b64_tr_b16 v[102:103], v120 offset:25088
    v_lshlrev_b32 v64, 16, v194
    v_and_b32 v65, 0xffff0000, v194
    v_add_f32 v64, v64, v123
    v_add_f32 v65, v65, v123
    v_cvt_pk_bf16_f32 v194, v64, v65
    s_waitcnt lgkmcnt(6)
    v_mfma_f32_32x32x16_bf16 v[32:47], v[104:107], v[188:191], v[32:47]
    ds_read_b64_tr_b16 v[104:105], v121 offset:24576
    ds_read_b64_tr_b16 v[106:107], v121 offset:25088
    v_lshlrev_b32 v66, 16, v195
    v_and_b32 v67, 0xffff0000, v195
    v_add_f32 v66, v66, v123
    v_add_f32 v67, v67, v123
    v_cvt_pk_bf16_f32 v195, v66, v67
    v_mfma_f32_32x32x16_bf16 v[48:63], v[108:111], v[188:191], v[48:63]
    ds_read_b64_tr_b16 v[108:109], v120 offset:18432
    ds_read_b64_tr_b16 v[110:111], v120 offset:18944
    v_lshlrev_b32 v64, 16, v196
    v_and_b32 v65, 0xffff0000, v196
    v_add_f32 v64, v64, v123
    v_add_f32 v65, v65, v123
    v_cvt_pk_bf16_f32 v196, v64, v65
    s_waitcnt lgkmcnt(6)
    v_mfma_f32_32x32x16_bf16 v[0:15], v[112:115], v[192:195], v[0:15]
    ds_read_b64_tr_b16 v[112:113], v121 offset:18432
    ds_read_b64_tr_b16 v[114:115], v121 offset:18944
    v_lshlrev_b32 v66, 16, v197
    v_and_b32 v67, 0xffff0000, v197
    v_add_f32 v66, v66, v123
    v_add_f32 v67, v67, v123
    v_cvt_pk_bf16_f32 v197, v66, v67
    v_mfma_f32_32x32x16_bf16 v[16:31], v[96:99], v[192:195], v[16:31]
    ds_read_b64_tr_b16 v[96:97], v120 offset:26624
    ds_read_b64_tr_b16 v[98:99], v120 offset:27136
    v_lshlrev_b32 v64, 16, v198
    v_and_b32 v65, 0xffff0000, v198
    v_add_f32 v64, v64, v123
    v_add_f32 v65, v65, v123
    v_cvt_pk_bf16_f32 v198, v64, v65
    s_waitcnt lgkmcnt(6)
    v_mfma_f32_32x32x16_bf16 v[32:47], v[100:103], v[192:195], v[32:47]
    ds_read_b64_tr_b16 v[100:101], v121 offset:26624
    ds_read_b64_tr_b16 v[102:103], v121 offset:27136
    v_lshlrev_b32 v66, 16, v199
    v_and_b32 v67, 0xffff0000, v199
    v_add_f32 v66, v66, v123
    v_add_f32 v67, v67, v123
    v_cvt_pk_bf16_f32 v199, v66, v67
    v_mfma_f32_32x32x16_bf16 v[48:63], v[104:107], v[192:195], v[48:63]
    ds_read_b64_tr_b16 v[104:105], v120 offset:20480
    ds_read_b64_tr_b16 v[106:107], v120 offset:20992
    v_lshlrev_b32 v64, 16, v200
    v_and_b32 v65, 0xffff0000, v200
    v_add_f32 v64, v64, v123
    v_add_f32 v65, v65, v123
    v_cvt_pk_bf16_f32 v200, v64, v65
    s_waitcnt lgkmcnt(6)
    v_mfma_f32_32x32x16_bf16 v[0:15], v[108:111], v[196:199], v[0:15]
    ds_read_b64_tr_b16 v[108:109], v121 offset:20480
    ds_read_b64_tr_b16 v[110:111], v121 offset:20992
    v_lshlrev_b32 v66, 16, v201
    v_and_b32 v67, 0xffff0000, v201
    v_add_f32 v66, v66, v123
    v_add_f32 v67, v67, v123
    v_cvt_pk_bf16_f32 v201, v66, v67
    v_mfma_f32_32x32x16_bf16 v[16:31], v[112:115], v[196:199], v[16:31]
    ds_read_b64_tr_b16 v[112:113], v120 offset:28672
    ds_read_b64_tr_b16 v[114:115], v120 offset:29184
    v_lshlrev_b32 v64, 16, v202
    v_and_b32 v65, 0xffff0000, v202
    v_add_f32 v64, v64, v123
    v_add_f32 v65, v65, v123
    v_cvt_pk_bf16_f32 v202, v64, v65
    s_waitcnt lgkmcnt(6)
    v_mfma_f32_32x32x16_bf16 v[32:47], v[96:99], v[196:199], v[32:47]
    ds_read_b64_tr_b16 v[96:97], v121 offset:28672
    ds_read_b64_tr_b16 v[98:99], v121 offset:29184
    v_lshlrev_b32 v66, 16, v203
    v_and_b32 v67, 0xffff0000, v203
    v_add_f32 v66, v66, v123
    v_add_f32 v67, v67, v123
    v_cvt_pk_bf16_f32 v203, v66, v67
    v_mfma_f32_32x32x16_bf16 v[48:63], v[100:103], v[196:199], v[48:63]
    ds_read_b64_tr_b16 v[100:101], v120 offset:22528
    ds_read_b64_tr_b16 v[102:103], v120 offset:23040
    v_lshlrev_b32 v64, 16, v204
    v_and_b32 v65, 0xffff0000, v204
    v_add_f32 v64, v64, v123
    v_add_f32 v65, v65, v123
    v_cvt_pk_bf16_f32 v204, v64, v65
    s_waitcnt lgkmcnt(6)
    v_mfma_f32_32x32x16_bf16 v[0:15], v[104:107], v[200:203], v[0:15]
    ds_read_b64_tr_b16 v[104:105], v121 offset:22528
    ds_read_b64_tr_b16 v[106:107], v121 offset:23040
    v_lshlrev_b32 v66, 16, v205
    v_and_b32 v67, 0xffff0000, v205
    v_add_f32 v66, v66, v123
    v_add_f32 v67, v67, v123
    v_cvt_pk_bf16_f32 v205, v66, v67
    v_mfma_f32_32x32x16_bf16 v[16:31], v[108:111], v[200:203], v[16:31]
    ds_read_b64_tr_b16 v[108:109], v120 offset:30720
    ds_read_b64_tr_b16 v[110:111], v120 offset:31232
    v_lshlrev_b32 v64, 16, v206
    v_and_b32 v65, 0xffff0000, v206
    v_add_f32 v64, v64, v123
    v_add_f32 v65, v65, v123
    v_cvt_pk_bf16_f32 v206, v64, v65
    s_waitcnt lgkmcnt(6)
    v_mfma_f32_32x32x16_bf16 v[32:47], v[112:115], v[200:203], v[32:47]
    ds_read_b64_tr_b16 v[112:113], v121 offset:30720
    ds_read_b64_tr_b16 v[114:115], v121 offset:31232
    v_lshlrev_b32 v66, 16, v207
    v_and_b32 v67, 0xffff0000, v207
    v_add_f32 v66, v66, v123
    v_add_f32 v67, v67, v123
    v_cvt_pk_bf16_f32 v207, v66, v67
    v_mfma_f32_32x32x16_bf16 v[48:63], v[96:99], v[200:203], v[48:63]
    s_barrier
    ds_read_b64_tr_b16 v[96:97], v120 offset:32768
    ds_read_b64_tr_b16 v[98:99], v120 offset:33280
    v_lshlrev_b32 v64, 16, v208
    v_and_b32 v65, 0xffff0000, v208
    v_add_f32 v64, v64, v123
    v_add_f32 v65, v65, v123
    v_cvt_pk_bf16_f32 v208, v64, v65
    s_waitcnt lgkmcnt(6)
    v_mfma_f32_32x32x16_bf16 v[0:15], v[100:103], v[204:207], v[0:15]
    ds_read_b64_tr_b16 v[100:101], v121 offset:32768
    ds_read_b64_tr_b16 v[102:103], v121 offset:33280
    v_lshlrev_b32 v66, 16, v209
    v_and_b32 v67, 0xffff0000, v209
    v_add_f32 v66, v66, v123
    v_add_f32 v67, v67, v123
    v_cvt_pk_bf16_f32 v209, v66, v67
    v_mfma_f32_32x32x16_bf16 v[16:31], v[104:107], v[204:207], v[16:31]
    ds_read_b64_tr_b16 v[104:105], v120 offset:40960
    ds_read_b64_tr_b16 v[106:107], v120 offset:41472
    v_lshlrev_b32 v64, 16, v210
    v_and_b32 v65, 0xffff0000, v210
    v_add_f32 v64, v64, v123
    v_add_f32 v65, v65, v123
    v_cvt_pk_bf16_f32 v210, v64, v65
    s_waitcnt lgkmcnt(6)
    v_mfma_f32_32x32x16_bf16 v[32:47], v[108:111], v[204:207], v[32:47]
    ds_read_b64_tr_b16 v[108:109], v121 offset:40960
    ds_read_b64_tr_b16 v[110:111], v121 offset:41472
    v_lshlrev_b32 v66, 16, v211
    v_and_b32 v67, 0xffff0000, v211
    v_add_f32 v66, v66, v123
    v_add_f32 v67, v67, v123
    v_cvt_pk_bf16_f32 v211, v66, v67
    v_mfma_f32_32x32x16_bf16 v[48:63], v[112:115], v[204:207], v[48:63]
    ds_read_b64_tr_b16 v[112:113], v120 offset:34816
    ds_read_b64_tr_b16 v[114:115], v120 offset:35328
    v_lshlrev_b32 v64, 16, v212
    v_and_b32 v65, 0xffff0000, v212
    v_add_f32 v64, v64, v123
    v_add_f32 v65, v65, v123
    v_cvt_pk_bf16_f32 v212, v64, v65
    s_waitcnt lgkmcnt(6)
    v_mfma_f32_32x32x16_bf16 v[0:15], v[96:99], v[208:211], v[0:15]
    ds_read_b64_tr_b16 v[96:97], v121 offset:34816
    ds_read_b64_tr_b16 v[98:99], v121 offset:35328
    v_lshlrev_b32 v66, 16, v213
    v_and_b32 v67, 0xffff0000, v213
    v_add_f32 v66, v66, v123
    v_add_f32 v67, v67, v123
    v_cvt_pk_bf16_f32 v213, v66, v67
    v_mfma_f32_32x32x16_bf16 v[16:31], v[100:103], v[208:211], v[16:31]
    ds_read_b64_tr_b16 v[100:101], v120 offset:43008
    ds_read_b64_tr_b16 v[102:103], v120 offset:43520
    v_lshlrev_b32 v64, 16, v214
    v_and_b32 v65, 0xffff0000, v214
    v_add_f32 v64, v64, v123
    v_add_f32 v65, v65, v123
    v_cvt_pk_bf16_f32 v214, v64, v65
    s_waitcnt lgkmcnt(6)
    v_mfma_f32_32x32x16_bf16 v[32:47], v[104:107], v[208:211], v[32:47]
    ds_read_b64_tr_b16 v[104:105], v121 offset:43008
    ds_read_b64_tr_b16 v[106:107], v121 offset:43520
    v_lshlrev_b32 v66, 16, v215
    v_and_b32 v67, 0xffff0000, v215
    v_add_f32 v66, v66, v123
    v_add_f32 v67, v67, v123
    v_cvt_pk_bf16_f32 v215, v66, v67
    v_mfma_f32_32x32x16_bf16 v[48:63], v[108:111], v[208:211], v[48:63]
    ds_read_b64_tr_b16 v[108:109], v120 offset:36864
    ds_read_b64_tr_b16 v[110:111], v120 offset:37376
    v_lshlrev_b32 v64, 16, v216
    v_and_b32 v65, 0xffff0000, v216
    v_add_f32 v64, v64, v123
    v_add_f32 v65, v65, v123
    v_cvt_pk_bf16_f32 v216, v64, v65
    s_waitcnt lgkmcnt(6)
    v_mfma_f32_32x32x16_bf16 v[0:15], v[112:115], v[212:215], v[0:15]
    ds_read_b64_tr_b16 v[112:113], v121 offset:36864
    ds_read_b64_tr_b16 v[114:115], v121 offset:37376
    v_lshlrev_b32 v66, 16, v217
    v_and_b32 v67, 0xffff0000, v217
    v_add_f32 v66, v66, v123
    v_add_f32 v67, v67, v123
    v_cvt_pk_bf16_f32 v217, v66, v67
    v_mfma_f32_32x32x16_bf16 v[16:31], v[96:99], v[212:215], v[16:31]
    ds_read_b64_tr_b16 v[96:97], v120 offset:45056
    ds_read_b64_tr_b16 v[98:99], v120 offset:45568
    v_lshlrev_b32 v64, 16, v218
    v_and_b32 v65, 0xffff0000, v218
    v_add_f32 v64, v64, v123
    v_add_f32 v65, v65, v123
    v_cvt_pk_bf16_f32 v218, v64, v65
    s_waitcnt lgkmcnt(6)
    v_mfma_f32_32x32x16_bf16 v[32:47], v[100:103], v[212:215], v[32:47]
    ds_read_b64_tr_b16 v[100:101], v121 offset:45056
    ds_read_b64_tr_b16 v[102:103], v121 offset:45568
    v_lshlrev_b32 v66, 16, v219
    v_and_b32 v67, 0xffff0000, v219
    v_add_f32 v66, v66, v123
    v_add_f32 v67, v67, v123
    v_cvt_pk_bf16_f32 v219, v66, v67
    v_mfma_f32_32x32x16_bf16 v[48:63], v[104:107], v[212:215], v[48:63]
    ds_read_b64_tr_b16 v[104:105], v120 offset:38912
    ds_read_b64_tr_b16 v[106:107], v120 offset:39424
    v_lshlrev_b32 v64, 16, v220
    v_and_b32 v65, 0xffff0000, v220
    v_add_f32 v64, v64, v123
    v_add_f32 v65, v65, v123
    v_cvt_pk_bf16_f32 v220, v64, v65
    s_waitcnt lgkmcnt(6)
    v_mfma_f32_32x32x16_bf16 v[0:15], v[108:111], v[216:219], v[0:15]
    ds_read_b64_tr_b16 v[108:109], v121 offset:38912
    ds_read_b64_tr_b16 v[110:111], v121 offset:39424
    v_lshlrev_b32 v66, 16, v221
    v_and_b32 v67, 0xffff0000, v221
    v_add_f32 v66, v66, v123
    v_add_f32 v67, v67, v123
    v_cvt_pk_bf16_f32 v221, v66, v67
    v_mfma_f32_32x32x16_bf16 v[16:31], v[112:115], v[216:219], v[16:31]
    ds_read_b64_tr_b16 v[112:113], v120 offset:47104
    ds_read_b64_tr_b16 v[114:115], v120 offset:47616
    v_lshlrev_b32 v64, 16, v222
    v_and_b32 v65, 0xffff0000, v222
    v_add_f32 v64, v64, v123
    v_add_f32 v65, v65, v123
    v_cvt_pk_bf16_f32 v222, v64, v65
    s_waitcnt lgkmcnt(6)
    v_mfma_f32_32x32x16_bf16 v[32:47], v[96:99], v[216:219], v[32:47]
    ds_read_b64_tr_b16 v[96:97], v121 offset:47104
    ds_read_b64_tr_b16 v[98:99], v121 offset:47616
    v_lshlrev_b32 v66, 16, v223
    v_and_b32 v67, 0xffff0000, v223
    v_add_f32 v66, v66, v123
    v_add_f32 v67, v67, v123
    v_cvt_pk_bf16_f32 v223, v66, v67
    v_mfma_f32_32x32x16_bf16 v[48:63], v[100:103], v[216:219], v[48:63]
    s_barrier
    v_add_u32 v120, 4294901760, v120
    v_add_u32 v121, 4294901760, v121
    ds_read_b64_tr_b16 v[100:101], v120 offset:16384
    ds_read_b64_tr_b16 v[102:103], v120 offset:16896
    v_lshlrev_b32 v64, 16, v224
    v_and_b32 v65, 0xffff0000, v224
    v_add_f32 v64, v64, v123
    v_add_f32 v65, v65, v123
    v_cvt_pk_bf16_f32 v224, v64, v65
    s_waitcnt lgkmcnt(6)
    v_mfma_f32_32x32x16_bf16 v[0:15], v[104:107], v[220:223], v[0:15]
    ds_read_b64_tr_b16 v[104:105], v121 offset:16384
    ds_read_b64_tr_b16 v[106:107], v121 offset:16896
    v_lshlrev_b32 v66, 16, v225
    v_and_b32 v67, 0xffff0000, v225
    v_add_f32 v66, v66, v123
    v_add_f32 v67, v67, v123
    v_cvt_pk_bf16_f32 v225, v66, v67
    v_mfma_f32_32x32x16_bf16 v[16:31], v[108:111], v[220:223], v[16:31]
    ds_read_b64_tr_b16 v[108:109], v120 offset:24576
    ds_read_b64_tr_b16 v[110:111], v120 offset:25088
    v_lshlrev_b32 v64, 16, v226
    v_and_b32 v65, 0xffff0000, v226
    v_add_f32 v64, v64, v123
    v_add_f32 v65, v65, v123
    v_cvt_pk_bf16_f32 v226, v64, v65
    s_waitcnt lgkmcnt(6)
    v_mfma_f32_32x32x16_bf16 v[32:47], v[112:115], v[220:223], v[32:47]
    ds_read_b64_tr_b16 v[112:113], v121 offset:24576
    ds_read_b64_tr_b16 v[114:115], v121 offset:25088
    v_lshlrev_b32 v66, 16, v227
    v_and_b32 v67, 0xffff0000, v227
    v_add_f32 v66, v66, v123
    v_add_f32 v67, v67, v123
    v_cvt_pk_bf16_f32 v227, v66, v67
    v_mfma_f32_32x32x16_bf16 v[48:63], v[96:99], v[220:223], v[48:63]
    ds_read_b64_tr_b16 v[96:97], v120 offset:18432
    ds_read_b64_tr_b16 v[98:99], v120 offset:18944
    v_lshlrev_b32 v64, 16, v228
    v_and_b32 v65, 0xffff0000, v228
    v_add_f32 v64, v64, v123
    v_add_f32 v65, v65, v123
    v_cvt_pk_bf16_f32 v228, v64, v65
    s_waitcnt lgkmcnt(6)
    v_mfma_f32_32x32x16_bf16 v[0:15], v[100:103], v[224:227], v[0:15]
    ds_read_b64_tr_b16 v[100:101], v121 offset:18432
    ds_read_b64_tr_b16 v[102:103], v121 offset:18944
    v_lshlrev_b32 v66, 16, v229
    v_and_b32 v67, 0xffff0000, v229
    v_add_f32 v66, v66, v123
    v_add_f32 v67, v67, v123
    v_cvt_pk_bf16_f32 v229, v66, v67
    v_mfma_f32_32x32x16_bf16 v[16:31], v[104:107], v[224:227], v[16:31]
    ds_read_b64_tr_b16 v[104:105], v120 offset:26624
    ds_read_b64_tr_b16 v[106:107], v120 offset:27136
    v_lshlrev_b32 v64, 16, v230
    v_and_b32 v65, 0xffff0000, v230
    v_add_f32 v64, v64, v123
    v_add_f32 v65, v65, v123
    v_cvt_pk_bf16_f32 v230, v64, v65
    s_waitcnt lgkmcnt(6)
    v_mfma_f32_32x32x16_bf16 v[32:47], v[108:111], v[224:227], v[32:47]
    ds_read_b64_tr_b16 v[108:109], v121 offset:26624
    ds_read_b64_tr_b16 v[110:111], v121 offset:27136
    v_lshlrev_b32 v66, 16, v231
    v_and_b32 v67, 0xffff0000, v231
    v_add_f32 v66, v66, v123
    v_add_f32 v67, v67, v123
    v_cvt_pk_bf16_f32 v231, v66, v67
    v_mfma_f32_32x32x16_bf16 v[48:63], v[112:115], v[224:227], v[48:63]
    ds_read_b64_tr_b16 v[112:113], v120 offset:20480
    ds_read_b64_tr_b16 v[114:115], v120 offset:20992
    v_lshlrev_b32 v64, 16, v232
    v_and_b32 v65, 0xffff0000, v232
    v_add_f32 v64, v64, v123
    v_add_f32 v65, v65, v123
    v_cvt_pk_bf16_f32 v232, v64, v65
    s_waitcnt lgkmcnt(6)
    v_mfma_f32_32x32x16_bf16 v[0:15], v[96:99], v[228:231], v[0:15]
    ds_read_b64_tr_b16 v[96:97], v121 offset:20480
    ds_read_b64_tr_b16 v[98:99], v121 offset:20992
    v_lshlrev_b32 v66, 16, v233
    v_and_b32 v67, 0xffff0000, v233
    v_add_f32 v66, v66, v123
    v_add_f32 v67, v67, v123
    v_cvt_pk_bf16_f32 v233, v66, v67
    v_mfma_f32_32x32x16_bf16 v[16:31], v[100:103], v[228:231], v[16:31]
    ds_read_b64_tr_b16 v[100:101], v120 offset:28672
    ds_read_b64_tr_b16 v[102:103], v120 offset:29184
    v_lshlrev_b32 v64, 16, v234
    v_and_b32 v65, 0xffff0000, v234
    v_add_f32 v64, v64, v123
    v_add_f32 v65, v65, v123
    v_cvt_pk_bf16_f32 v234, v64, v65
    s_waitcnt lgkmcnt(6)
    v_mfma_f32_32x32x16_bf16 v[32:47], v[104:107], v[228:231], v[32:47]
    ds_read_b64_tr_b16 v[104:105], v121 offset:28672
    ds_read_b64_tr_b16 v[106:107], v121 offset:29184
    v_lshlrev_b32 v66, 16, v235
    v_and_b32 v67, 0xffff0000, v235
    v_add_f32 v66, v66, v123
    v_add_f32 v67, v67, v123
    v_cvt_pk_bf16_f32 v235, v66, v67
    v_mfma_f32_32x32x16_bf16 v[48:63], v[108:111], v[228:231], v[48:63]
    ds_read_b64_tr_b16 v[108:109], v120 offset:22528
    ds_read_b64_tr_b16 v[110:111], v120 offset:23040
    v_lshlrev_b32 v64, 16, v236
    v_and_b32 v65, 0xffff0000, v236
    v_add_f32 v64, v64, v123
    v_add_f32 v65, v65, v123
    v_cvt_pk_bf16_f32 v236, v64, v65
    s_waitcnt lgkmcnt(6)
    v_mfma_f32_32x32x16_bf16 v[0:15], v[112:115], v[232:235], v[0:15]
    ds_read_b64_tr_b16 v[112:113], v121 offset:22528
    ds_read_b64_tr_b16 v[114:115], v121 offset:23040
    v_lshlrev_b32 v66, 16, v237
    v_and_b32 v67, 0xffff0000, v237
    v_add_f32 v66, v66, v123
    v_add_f32 v67, v67, v123
    v_cvt_pk_bf16_f32 v237, v66, v67
    v_mfma_f32_32x32x16_bf16 v[16:31], v[96:99], v[232:235], v[16:31]
    ds_read_b64_tr_b16 v[96:97], v120 offset:30720
    ds_read_b64_tr_b16 v[98:99], v120 offset:31232
    v_lshlrev_b32 v64, 16, v238
    v_and_b32 v65, 0xffff0000, v238
    v_add_f32 v64, v64, v123
    v_add_f32 v65, v65, v123
    v_cvt_pk_bf16_f32 v238, v64, v65
    s_waitcnt lgkmcnt(6)
    v_mfma_f32_32x32x16_bf16 v[32:47], v[100:103], v[232:235], v[32:47]
    ds_read_b64_tr_b16 v[100:101], v121 offset:30720
    ds_read_b64_tr_b16 v[102:103], v121 offset:31232
    v_lshlrev_b32 v66, 16, v239
    v_and_b32 v67, 0xffff0000, v239
    v_add_f32 v66, v66, v123
    v_add_f32 v67, v67, v123
    v_cvt_pk_bf16_f32 v239, v66, v67
    v_mfma_f32_32x32x16_bf16 v[48:63], v[104:107], v[232:235], v[48:63]
    s_barrier
    ds_read_b64_tr_b16 v[104:105], v120 offset:32768
    ds_read_b64_tr_b16 v[106:107], v120 offset:33280
    v_lshlrev_b32 v64, 16, v240
    v_and_b32 v65, 0xffff0000, v240
    v_add_f32 v64, v64, v123
    v_add_f32 v65, v65, v123
    v_cvt_pk_bf16_f32 v240, v64, v65
    s_waitcnt lgkmcnt(6)
    v_mfma_f32_32x32x16_bf16 v[0:15], v[108:111], v[236:239], v[0:15]
    ds_read_b64_tr_b16 v[108:109], v121 offset:32768
    ds_read_b64_tr_b16 v[110:111], v121 offset:33280
    v_lshlrev_b32 v66, 16, v241
    v_and_b32 v67, 0xffff0000, v241
    v_add_f32 v66, v66, v123
    v_add_f32 v67, v67, v123
    v_cvt_pk_bf16_f32 v241, v66, v67
    v_mfma_f32_32x32x16_bf16 v[16:31], v[112:115], v[236:239], v[16:31]
    ds_read_b64_tr_b16 v[112:113], v120 offset:40960
    ds_read_b64_tr_b16 v[114:115], v120 offset:41472
    v_lshlrev_b32 v64, 16, v242
    v_and_b32 v65, 0xffff0000, v242
    v_add_f32 v64, v64, v123
    v_add_f32 v65, v65, v123
    v_cvt_pk_bf16_f32 v242, v64, v65
    s_waitcnt lgkmcnt(6)
    v_mfma_f32_32x32x16_bf16 v[32:47], v[96:99], v[236:239], v[32:47]
    ds_read_b64_tr_b16 v[96:97], v121 offset:40960
    ds_read_b64_tr_b16 v[98:99], v121 offset:41472
    v_lshlrev_b32 v66, 16, v243
    v_and_b32 v67, 0xffff0000, v243
    v_add_f32 v66, v66, v123
    v_add_f32 v67, v67, v123
    v_cvt_pk_bf16_f32 v243, v66, v67
    v_mfma_f32_32x32x16_bf16 v[48:63], v[100:103], v[236:239], v[48:63]
    ds_read_b64_tr_b16 v[100:101], v120 offset:34816
    ds_read_b64_tr_b16 v[102:103], v120 offset:35328
    v_lshlrev_b32 v64, 16, v244
    v_and_b32 v65, 0xffff0000, v244
    v_add_f32 v64, v64, v123
    v_add_f32 v65, v65, v123
    v_cvt_pk_bf16_f32 v244, v64, v65
    s_waitcnt lgkmcnt(6)
    v_mfma_f32_32x32x16_bf16 v[0:15], v[104:107], v[240:243], v[0:15]
    ds_read_b64_tr_b16 v[104:105], v121 offset:34816
    ds_read_b64_tr_b16 v[106:107], v121 offset:35328
    v_lshlrev_b32 v66, 16, v245
    v_and_b32 v67, 0xffff0000, v245
    v_add_f32 v66, v66, v123
    v_add_f32 v67, v67, v123
    v_cvt_pk_bf16_f32 v245, v66, v67
    v_mfma_f32_32x32x16_bf16 v[16:31], v[108:111], v[240:243], v[16:31]
    ds_read_b64_tr_b16 v[108:109], v120 offset:43008
    ds_read_b64_tr_b16 v[110:111], v120 offset:43520
    v_lshlrev_b32 v64, 16, v246
    v_and_b32 v65, 0xffff0000, v246
    v_add_f32 v64, v64, v123
    v_add_f32 v65, v65, v123
    v_cvt_pk_bf16_f32 v246, v64, v65
    s_waitcnt lgkmcnt(6)
    v_mfma_f32_32x32x16_bf16 v[32:47], v[112:115], v[240:243], v[32:47]
    ds_read_b64_tr_b16 v[112:113], v121 offset:43008
    ds_read_b64_tr_b16 v[114:115], v121 offset:43520
    v_lshlrev_b32 v66, 16, v247
    v_and_b32 v67, 0xffff0000, v247
    v_add_f32 v66, v66, v123
    v_add_f32 v67, v67, v123
    v_cvt_pk_bf16_f32 v247, v66, v67
    v_mfma_f32_32x32x16_bf16 v[48:63], v[96:99], v[240:243], v[48:63]
    ds_read_b64_tr_b16 v[96:97], v120 offset:36864
    ds_read_b64_tr_b16 v[98:99], v120 offset:37376
    v_lshlrev_b32 v64, 16, v248
    v_and_b32 v65, 0xffff0000, v248
    v_add_f32 v64, v64, v123
    v_add_f32 v65, v65, v123
    v_cvt_pk_bf16_f32 v248, v64, v65
    s_waitcnt lgkmcnt(6)
    v_mfma_f32_32x32x16_bf16 v[0:15], v[100:103], v[244:247], v[0:15]
    ds_read_b64_tr_b16 v[100:101], v121 offset:36864
    ds_read_b64_tr_b16 v[102:103], v121 offset:37376
    v_lshlrev_b32 v66, 16, v249
    v_and_b32 v67, 0xffff0000, v249
    v_add_f32 v66, v66, v123
    v_add_f32 v67, v67, v123
    v_cvt_pk_bf16_f32 v249, v66, v67
    v_mfma_f32_32x32x16_bf16 v[16:31], v[104:107], v[244:247], v[16:31]
    ds_read_b64_tr_b16 v[104:105], v120 offset:45056
    ds_read_b64_tr_b16 v[106:107], v120 offset:45568
    v_lshlrev_b32 v64, 16, v250
    v_and_b32 v65, 0xffff0000, v250
    v_add_f32 v64, v64, v123
    v_add_f32 v65, v65, v123
    v_cvt_pk_bf16_f32 v250, v64, v65
    s_waitcnt lgkmcnt(6)
    v_mfma_f32_32x32x16_bf16 v[32:47], v[108:111], v[244:247], v[32:47]
    ds_read_b64_tr_b16 v[108:109], v121 offset:45056
    ds_read_b64_tr_b16 v[110:111], v121 offset:45568
    v_lshlrev_b32 v66, 16, v251
    v_and_b32 v67, 0xffff0000, v251
    v_add_f32 v66, v66, v123
    v_add_f32 v67, v67, v123
    v_cvt_pk_bf16_f32 v251, v66, v67
    v_mfma_f32_32x32x16_bf16 v[48:63], v[112:115], v[244:247], v[48:63]
    ds_read_b64_tr_b16 v[112:113], v120 offset:38912
    ds_read_b64_tr_b16 v[114:115], v120 offset:39424
    v_lshlrev_b32 v64, 16, v252
    v_and_b32 v65, 0xffff0000, v252
    v_add_f32 v64, v64, v123
    v_add_f32 v65, v65, v123
    v_cvt_pk_bf16_f32 v252, v64, v65
    s_waitcnt lgkmcnt(6)
    v_mfma_f32_32x32x16_bf16 v[0:15], v[96:99], v[248:251], v[0:15]
    ds_read_b64_tr_b16 v[96:97], v121 offset:38912
    ds_read_b64_tr_b16 v[98:99], v121 offset:39424
    v_lshlrev_b32 v66, 16, v253
    v_and_b32 v67, 0xffff0000, v253
    v_add_f32 v66, v66, v123
    v_add_f32 v67, v67, v123
    v_cvt_pk_bf16_f32 v253, v66, v67
    v_mfma_f32_32x32x16_bf16 v[16:31], v[100:103], v[248:251], v[16:31]
    ds_read_b64_tr_b16 v[100:101], v120 offset:47104
    ds_read_b64_tr_b16 v[102:103], v120 offset:47616
    v_lshlrev_b32 v64, 16, v254
    v_and_b32 v65, 0xffff0000, v254
    v_add_f32 v64, v64, v123
    v_add_f32 v65, v65, v123
    v_cvt_pk_bf16_f32 v254, v64, v65
    s_waitcnt lgkmcnt(6)
    v_mfma_f32_32x32x16_bf16 v[32:47], v[104:107], v[248:251], v[32:47]
    ds_read_b64_tr_b16 v[104:105], v121 offset:47104
    ds_read_b64_tr_b16 v[106:107], v121 offset:47616
    v_lshlrev_b32 v66, 16, v255
    v_and_b32 v67, 0xffff0000, v255
    v_add_f32 v66, v66, v123
    v_add_f32 v67, v67, v123
    v_cvt_pk_bf16_f32 v255, v66, v67
    v_mfma_f32_32x32x16_bf16 v[48:63], v[108:111], v[248:251], v[48:63]
    s_barrier
    ds_read_b64_tr_b16 v[108:109], v120 offset:49152
    ds_read_b64_tr_b16 v[110:111], v120 offset:49664
    s_waitcnt lgkmcnt(6)
    v_mfma_f32_32x32x16_bf16 v[0:15], v[112:115], v[252:255], v[0:15]
    ds_read_b64_tr_b16 v[112:113], v121 offset:49152
    ds_read_b64_tr_b16 v[114:115], v121 offset:49664
    v_mfma_f32_32x32x16_bf16 v[16:31], v[96:99], v[252:255], v[16:31]
    ds_read_b64_tr_b16 v[96:97], v120 offset:51200
    ds_read_b64_tr_b16 v[98:99], v120 offset:51712
    s_waitcnt lgkmcnt(6)
    v_mfma_f32_32x32x16_bf16 v[32:47], v[100:103], v[252:255], v[32:47]
    ds_read_b64_tr_b16 v[100:101], v121 offset:51200
    ds_read_b64_tr_b16 v[102:103], v121 offset:51712
    v_mfma_f32_32x32x16_bf16 v[48:63], v[104:107], v[252:255], v[48:63]
    ds_read_b64_tr_b16 v[104:105], v120 offset:53248
    ds_read_b64_tr_b16 v[106:107], v120 offset:53760
    s_waitcnt lgkmcnt(6)
    v_mfma_f32_32x32x16_bf16 v[64:79], v[108:111], v[128:131], 0
    ds_read_b64_tr_b16 v[108:109], v121 offset:53248
    ds_read_b64_tr_b16 v[110:111], v121 offset:53760
    v_mfma_f32_32x32x16_bf16 v[80:95], v[112:115], v[128:131], 0
    ds_read_b64_tr_b16 v[112:113], v120 offset:55296
    ds_read_b64_tr_b16 v[114:115], v120 offset:55808
    v_mul_f32 v0, v125, v0
    v_mul_f32 v1, v125, v1
    v_mul_f32 v2, v125, v2
    v_mul_f32 v3, v125, v3
    s_waitcnt lgkmcnt(6)
    v_mfma_f32_32x32x16_bf16 v[64:79], v[96:99], v[132:135], v[64:79]
    ds_read_b64_tr_b16 v[96:97], v121 offset:55296
    ds_read_b64_tr_b16 v[98:99], v121 offset:55808
    v_exp_f32 v0, v0
    v_exp_f32 v1, v1
    v_mfma_f32_32x32x16_bf16 v[80:95], v[100:103], v[132:135], v[80:95]
    ds_read_b64_tr_b16 v[100:101], v120 offset:57344
    ds_read_b64_tr_b16 v[102:103], v120 offset:57856
    v_exp_f32 v2, v2
    v_exp_f32 v3, v3
    v_fma_f32 v0, v0, v124, v124
    s_waitcnt lgkmcnt(6)
    v_mfma_f32_32x32x16_bf16 v[64:79], v[104:107], v[136:139], v[64:79]
    ds_read_b64_tr_b16 v[104:105], v121 offset:57344
    ds_read_b64_tr_b16 v[106:107], v121 offset:57856
    v_fma_f32 v1, v1, v124, v124
    v_fma_f32 v2, v2, v124, v124
    v_fma_f32 v3, v3, v124, v124
    v_mfma_f32_32x32x16_bf16 v[80:95], v[108:111], v[136:139], v[80:95]
    ds_read_b64_tr_b16 v[108:109], v120 offset:59392
    ds_read_b64_tr_b16 v[110:111], v120 offset:59904
    v_rcp_f32 v0, v0
    v_rcp_f32 v1, v1
    v_rcp_f32 v2, v2
    s_waitcnt lgkmcnt(6)
    v_mfma_f32_32x32x16_bf16 v[64:79], v[112:115], v[140:143], v[64:79]
    ds_read_b64_tr_b16 v[112:113], v121 offset:59392
    ds_read_b64_tr_b16 v[114:115], v121 offset:59904
    v_rcp_f32 v3, v3
    v_mul_f32 v32, v0, v32
    v_mfma_f32_32x32x16_bf16 v[80:95], v[96:99], v[140:143], v[80:95]
    ds_read_b64_tr_b16 v[96:97], v120 offset:61440
    ds_read_b64_tr_b16 v[98:99], v120 offset:61952
    v_mul_f32 v33, v1, v33
    v_mul_f32 v34, v2, v34
    v_mul_f32 v35, v3, v35
    v_mul_f32 v4, v125, v4
    s_waitcnt lgkmcnt(6)
    v_mfma_f32_32x32x16_bf16 v[64:79], v[100:103], v[144:147], v[64:79]
    ds_read_b64_tr_b16 v[100:101], v121 offset:61440
    ds_read_b64_tr_b16 v[102:103], v121 offset:61952
    v_mul_f32 v5, v125, v5
    v_mul_f32 v6, v125, v6
    v_mul_f32 v7, v125, v7
    v_exp_f32 v4, v4
    v_mfma_f32_32x32x16_bf16 v[80:95], v[104:107], v[144:147], v[80:95]
    ds_read_b64_tr_b16 v[104:105], v120 offset:63488
    ds_read_b64_tr_b16 v[106:107], v120 offset:64000
    v_exp_f32 v5, v5
    v_exp_f32 v6, v6
    s_waitcnt lgkmcnt(6)
    v_mfma_f32_32x32x16_bf16 v[64:79], v[108:111], v[148:151], v[64:79]
    ds_read_b64_tr_b16 v[108:109], v121 offset:63488
    ds_read_b64_tr_b16 v[110:111], v121 offset:64000
    v_exp_f32 v7, v7
    v_fma_f32 v4, v4, v124, v124
    v_fma_f32 v5, v5, v124, v124
    v_mfma_f32_32x32x16_bf16 v[80:95], v[112:115], v[148:151], v[80:95]
    s_barrier
    v_add_u32 v120, 65536, v120
    v_add_u32 v121, 65536, v121
    ds_read_b64_tr_b16 v[112:113], v120 offset:0
    ds_read_b64_tr_b16 v[114:115], v120 offset:512
    v_fma_f32 v6, v6, v124, v124
    v_fma_f32 v7, v7, v124, v124
    v_rcp_f32 v4, v4
    s_waitcnt lgkmcnt(6)
    v_mfma_f32_32x32x16_bf16 v[64:79], v[96:99], v[152:155], v[64:79]
    ds_read_b64_tr_b16 v[96:97], v121 offset:0
    ds_read_b64_tr_b16 v[98:99], v121 offset:512
    v_rcp_f32 v5, v5
    v_rcp_f32 v6, v6
    v_mfma_f32_32x32x16_bf16 v[80:95], v[100:103], v[152:155], v[80:95]
    ds_read_b64_tr_b16 v[100:101], v120 offset:2048
    ds_read_b64_tr_b16 v[102:103], v120 offset:2560
    v_rcp_f32 v7, v7
    v_mul_f32 v36, v4, v36
    v_mul_f32 v37, v5, v37
    v_mul_f32 v38, v6, v38
    s_waitcnt lgkmcnt(6)
    v_mfma_f32_32x32x16_bf16 v[64:79], v[104:107], v[156:159], v[64:79]
    ds_read_b64_tr_b16 v[104:105], v121 offset:2048
    ds_read_b64_tr_b16 v[106:107], v121 offset:2560
    v_mul_f32 v39, v7, v39
    v_cvt_pk_bf16_f32 v0, v32, v33
    v_cvt_pk_bf16_f32 v1, v34, v35
    v_cvt_pk_bf16_f32 v2, v36, v37
    v_mfma_f32_32x32x16_bf16 v[80:95], v[108:111], v[156:159], v[80:95]
    ds_read_b64_tr_b16 v[108:109], v120 offset:4096
    ds_read_b64_tr_b16 v[110:111], v120 offset:4608
    v_cvt_pk_bf16_f32 v3, v38, v39
    v_mul_f32 v8, v125, v8
    v_mul_f32 v9, v125, v9
    s_waitcnt lgkmcnt(6)
    v_mfma_f32_32x32x16_bf16 v[64:79], v[112:115], v[160:163], v[64:79]
    ds_read_b64_tr_b16 v[112:113], v121 offset:4096
    ds_read_b64_tr_b16 v[114:115], v121 offset:4608
    v_mul_f32 v10, v125, v10
    v_mul_f32 v11, v125, v11
    v_exp_f32 v8, v8
    v_mfma_f32_32x32x16_bf16 v[80:95], v[96:99], v[160:163], v[80:95]
    ds_read_b64_tr_b16 v[96:97], v120 offset:6144
    ds_read_b64_tr_b16 v[98:99], v120 offset:6656
    v_exp_f32 v9, v9
    v_exp_f32 v10, v10
    s_waitcnt lgkmcnt(6)
    v_mfma_f32_32x32x16_bf16 v[64:79], v[100:103], v[164:167], v[64:79]
    ds_read_b64_tr_b16 v[100:101], v121 offset:6144
    ds_read_b64_tr_b16 v[102:103], v121 offset:6656
    v_exp_f32 v11, v11
    v_fma_f32 v8, v8, v124, v124
    v_fma_f32 v9, v9, v124, v124
    v_fma_f32 v10, v10, v124, v124
    v_mfma_f32_32x32x16_bf16 v[80:95], v[104:107], v[164:167], v[80:95]
    ds_read_b64_tr_b16 v[104:105], v120 offset:8192
    ds_read_b64_tr_b16 v[106:107], v120 offset:8704
    v_fma_f32 v11, v11, v124, v124
    v_rcp_f32 v8, v8
    s_waitcnt lgkmcnt(6)
    v_mfma_f32_32x32x16_bf16 v[64:79], v[108:111], v[168:171], v[64:79]
    ds_read_b64_tr_b16 v[108:109], v121 offset:8192
    ds_read_b64_tr_b16 v[110:111], v121 offset:8704
    v_rcp_f32 v9, v9
    v_rcp_f32 v10, v10
    v_rcp_f32 v11, v11
    v_mfma_f32_32x32x16_bf16 v[80:95], v[112:115], v[168:171], v[80:95]
    ds_read_b64_tr_b16 v[112:113], v120 offset:10240
    ds_read_b64_tr_b16 v[114:115], v120 offset:10752
    v_mul_f32 v40, v8, v40
    v_mul_f32 v41, v9, v41
    v_mul_f32 v42, v10, v42
    s_waitcnt lgkmcnt(6)
    v_mfma_f32_32x32x16_bf16 v[64:79], v[96:99], v[172:175], v[64:79]
    ds_read_b64_tr_b16 v[96:97], v121 offset:10240
    ds_read_b64_tr_b16 v[98:99], v121 offset:10752
    v_mul_f32 v43, v11, v43
    v_mul_f32 v12, v125, v12
    v_mul_f32 v13, v125, v13
    v_mul_f32 v14, v125, v14
    v_mul_f32 v15, v125, v15
    v_mfma_f32_32x32x16_bf16 v[80:95], v[100:103], v[172:175], v[80:95]
    ds_read_b64_tr_b16 v[100:101], v120 offset:12288
    ds_read_b64_tr_b16 v[102:103], v120 offset:12800
    v_exp_f32 v12, v12
    v_exp_f32 v13, v13
    s_waitcnt lgkmcnt(6)
    v_mfma_f32_32x32x16_bf16 v[64:79], v[104:107], v[176:179], v[64:79]
    ds_read_b64_tr_b16 v[104:105], v121 offset:12288
    ds_read_b64_tr_b16 v[106:107], v121 offset:12800
    v_exp_f32 v14, v14
    v_exp_f32 v15, v15
    v_mfma_f32_32x32x16_bf16 v[80:95], v[108:111], v[176:179], v[80:95]
    ds_read_b64_tr_b16 v[108:109], v120 offset:14336
    ds_read_b64_tr_b16 v[110:111], v120 offset:14848
    v_fma_f32 v12, v12, v124, v124
    v_fma_f32 v13, v13, v124, v124
    v_fma_f32 v14, v14, v124, v124
    v_fma_f32 v15, v15, v124, v124
    s_waitcnt lgkmcnt(6)
    v_mfma_f32_32x32x16_bf16 v[64:79], v[112:115], v[180:183], v[64:79]
    ds_read_b64_tr_b16 v[112:113], v121 offset:14336
    ds_read_b64_tr_b16 v[114:115], v121 offset:14848
    v_rcp_f32 v12, v12
    v_rcp_f32 v13, v13
    buffer_store_dwordx4 v[0:3], v122, s[32:35], s61 offen offset:0 sc1
    v_mfma_f32_32x32x16_bf16 v[80:95], v[96:99], v[180:183], v[80:95]
    s_barrier
    v_add_u32 v120, 4294901760, v120
    v_add_u32 v121, 4294901760, v121
    ds_read_b64_tr_b16 v[96:97], v120 offset:0
    ds_read_b64_tr_b16 v[98:99], v120 offset:512
    v_rcp_f32 v14, v14
    v_rcp_f32 v15, v15
    v_mul_f32 v44, v12, v44
    s_waitcnt lgkmcnt(6)
    v_mfma_f32_32x32x16_bf16 v[64:79], v[100:103], v[184:187], v[64:79]
    ds_read_b64_tr_b16 v[100:101], v121 offset:0
    ds_read_b64_tr_b16 v[102:103], v121 offset:512
    v_mul_f32 v45, v13, v45
    v_mul_f32 v46, v14, v46
    v_mul_f32 v47, v15, v47
    v_cvt_pk_bf16_f32 v8, v40, v41
    v_mfma_f32_32x32x16_bf16 v[80:95], v[104:107], v[184:187], v[80:95]
    ds_read_b64_tr_b16 v[104:105], v120 offset:2048
    ds_read_b64_tr_b16 v[106:107], v120 offset:2560
    v_cvt_pk_bf16_f32 v9, v42, v43
    v_cvt_pk_bf16_f32 v10, v44, v45
    v_cvt_pk_bf16_f32 v11, v46, v47
    s_waitcnt lgkmcnt(6)
    v_mfma_f32_32x32x16_bf16 v[64:79], v[108:111], v[188:191], v[64:79]
    ds_read_b64_tr_b16 v[108:109], v121 offset:2048
    ds_read_b64_tr_b16 v[110:111], v121 offset:2560
    v_mul_f32 v16, v125, v16
    v_mul_f32 v17, v125, v17
    v_mul_f32 v18, v125, v18
    v_mul_f32 v19, v125, v19
    v_mfma_f32_32x32x16_bf16 v[80:95], v[112:115], v[188:191], v[80:95]
    ds_read_b64_tr_b16 v[112:113], v120 offset:4096
    ds_read_b64_tr_b16 v[114:115], v120 offset:4608
    v_exp_f32 v16, v16
    v_exp_f32 v17, v17
    s_waitcnt lgkmcnt(6)
    v_mfma_f32_32x32x16_bf16 v[64:79], v[96:99], v[192:195], v[64:79]
    ds_read_b64_tr_b16 v[96:97], v121 offset:4096
    ds_read_b64_tr_b16 v[98:99], v121 offset:4608
    v_exp_f32 v18, v18
    v_exp_f32 v19, v19
    v_fma_f32 v16, v16, v124, v124
    v_mfma_f32_32x32x16_bf16 v[80:95], v[100:103], v[192:195], v[80:95]
    ds_read_b64_tr_b16 v[100:101], v120 offset:6144
    ds_read_b64_tr_b16 v[102:103], v120 offset:6656
    v_fma_f32 v17, v17, v124, v124
    v_fma_f32 v18, v18, v124, v124
    v_fma_f32 v19, v19, v124, v124
    s_waitcnt lgkmcnt(6)
    v_mfma_f32_32x32x16_bf16 v[64:79], v[104:107], v[196:199], v[64:79]
    ds_read_b64_tr_b16 v[104:105], v121 offset:6144
    ds_read_b64_tr_b16 v[106:107], v121 offset:6656
    v_rcp_f32 v16, v16
    v_rcp_f32 v17, v17
    v_rcp_f32 v18, v18
    v_mfma_f32_32x32x16_bf16 v[80:95], v[108:111], v[196:199], v[80:95]
    ds_read_b64_tr_b16 v[108:109], v120 offset:8192
    ds_read_b64_tr_b16 v[110:111], v120 offset:8704
    v_rcp_f32 v19, v19
    v_mul_f32 v48, v16, v48
    s_waitcnt lgkmcnt(6)
    v_mfma_f32_32x32x16_bf16 v[64:79], v[112:115], v[200:203], v[64:79]
    ds_read_b64_tr_b16 v[112:113], v121 offset:8192
    ds_read_b64_tr_b16 v[114:115], v121 offset:8704
    v_mul_f32 v49, v17, v49
    v_mul_f32 v50, v18, v50
    v_mul_f32 v51, v19, v51
    v_mul_f32 v20, v125, v20
    v_mfma_f32_32x32x16_bf16 v[80:95], v[96:99], v[200:203], v[80:95]
    ds_read_b64_tr_b16 v[96:97], v120 offset:10240
    ds_read_b64_tr_b16 v[98:99], v120 offset:10752
    v_mul_f32 v21, v125, v21
    v_mul_f32 v22, v125, v22
    v_mul_f32 v23, v125, v23
    v_exp_f32 v20, v20
    s_waitcnt lgkmcnt(6)
    v_mfma_f32_32x32x16_bf16 v[64:79], v[100:103], v[204:207], v[64:79]
    ds_read_b64_tr_b16 v[100:101], v121 offset:10240
    ds_read_b64_tr_b16 v[102:103], v121 offset:10752
    v_exp_f32 v21, v21
    v_exp_f32 v22, v22
    v_mfma_f32_32x32x16_bf16 v[80:95], v[104:107], v[204:207], v[80:95]
    ds_read_b64_tr_b16 v[104:105], v120 offset:12288
    ds_read_b64_tr_b16 v[106:107], v120 offset:12800
    v_exp_f32 v23, v23
    v_fma_f32 v20, v20, v124, v124
    v_fma_f32 v21, v21, v124, v124
    s_waitcnt lgkmcnt(6)
    v_mfma_f32_32x32x16_bf16 v[64:79], v[108:111], v[208:211], v[64:79]
    ds_read_b64_tr_b16 v[108:109], v121 offset:12288
    ds_read_b64_tr_b16 v[110:111], v121 offset:12800
    v_fma_f32 v22, v22, v124, v124
    v_fma_f32 v23, v23, v124, v124
    v_rcp_f32 v20, v20
    v_mfma_f32_32x32x16_bf16 v[80:95], v[112:115], v[208:211], v[80:95]
    ds_read_b64_tr_b16 v[112:113], v120 offset:14336
    ds_read_b64_tr_b16 v[114:115], v120 offset:14848
    v_rcp_f32 v21, v21
    v_rcp_f32 v22, v22
    s_waitcnt lgkmcnt(6)
    v_mfma_f32_32x32x16_bf16 v[64:79], v[96:99], v[212:215], v[64:79]
    ds_read_b64_tr_b16 v[96:97], v121 offset:14336
    ds_read_b64_tr_b16 v[98:99], v121 offset:14848
    v_rcp_f32 v23, v23
    v_mul_f32 v52, v20, v52
    v_mul_f32 v53, v21, v53
    v_mul_f32 v54, v22, v54
    buffer_store_dwordx4 v[8:11], v122, s[32:35], s61 offen offset:1024 sc1
    v_mfma_f32_32x32x16_bf16 v[80:95], v[100:103], v[212:215], v[80:95]
    s_barrier
    ds_read_b64_tr_b16 v[100:101], v120 offset:16384
    ds_read_b64_tr_b16 v[102:103], v120 offset:16896
    v_mul_f32 v55, v23, v55
    v_cvt_pk_bf16_f32 v16, v48, v49
    v_cvt_pk_bf16_f32 v17, v50, v51
    v_cvt_pk_bf16_f32 v18, v52, v53
    s_waitcnt lgkmcnt(6)
    v_mfma_f32_32x32x16_bf16 v[64:79], v[104:107], v[216:219], v[64:79]
    ds_read_b64_tr_b16 v[104:105], v121 offset:16384
    ds_read_b64_tr_b16 v[106:107], v121 offset:16896
    v_cvt_pk_bf16_f32 v19, v54, v55
    v_mul_f32 v24, v125, v24
    v_mul_f32 v25, v125, v25
    v_mfma_f32_32x32x16_bf16 v[80:95], v[108:111], v[216:219], v[80:95]
    ds_read_b64_tr_b16 v[108:109], v120 offset:18432
    ds_read_b64_tr_b16 v[110:111], v120 offset:18944
    v_mul_f32 v26, v125, v26
    v_mul_f32 v27, v125, v27
    v_exp_f32 v24, v24
    s_waitcnt lgkmcnt(6)
    v_mfma_f32_32x32x16_bf16 v[64:79], v[112:115], v[220:223], v[64:79]
    ds_read_b64_tr_b16 v[112:113], v121 offset:18432
    ds_read_b64_tr_b16 v[114:115], v121 offset:18944
    v_exp_f32 v25, v25
    v_exp_f32 v26, v26
    v_mfma_f32_32x32x16_bf16 v[80:95], v[96:99], v[220:223], v[80:95]
    ds_read_b64_tr_b16 v[96:97], v120 offset:20480
    ds_read_b64_tr_b16 v[98:99], v120 offset:20992
    v_exp_f32 v27, v27
    v_fma_f32 v24, v24, v124, v124
    v_fma_f32 v25, v25, v124, v124
    v_fma_f32 v26, v26, v124, v124
    s_waitcnt lgkmcnt(6)
    v_mfma_f32_32x32x16_bf16 v[64:79], v[100:103], v[224:227], v[64:79]
    ds_read_b64_tr_b16 v[100:101], v121 offset:20480
    ds_read_b64_tr_b16 v[102:103], v121 offset:20992
    v_fma_f32 v27, v27, v124, v124
    v_rcp_f32 v24, v24
    v_mfma_f32_32x32x16_bf16 v[80:95], v[104:107], v[224:227], v[80:95]
    ds_read_b64_tr_b16 v[104:105], v120 offset:22528
    ds_read_b64_tr_b16 v[106:107], v120 offset:23040
    v_rcp_f32 v25, v25
    v_rcp_f32 v26, v26
    v_rcp_f32 v27, v27
    s_waitcnt lgkmcnt(6)
    v_mfma_f32_32x32x16_bf16 v[64:79], v[108:111], v[228:231], v[64:79]
    ds_read_b64_tr_b16 v[108:109], v121 offset:22528
    ds_read_b64_tr_b16 v[110:111], v121 offset:23040
    v_mul_f32 v56, v24, v56
    v_mul_f32 v57, v25, v57
    v_mul_f32 v58, v26, v58
    v_mfma_f32_32x32x16_bf16 v[80:95], v[112:115], v[228:231], v[80:95]
    ds_read_b64_tr_b16 v[112:113], v120 offset:24576
    ds_read_b64_tr_b16 v[114:115], v120 offset:25088
    v_mul_f32 v59, v27, v59
    v_mul_f32 v28, v125, v28
    v_mul_f32 v29, v125, v29
    v_mul_f32 v30, v125, v30
    v_mul_f32 v31, v125, v31
    s_waitcnt lgkmcnt(6)
    v_mfma_f32_32x32x16_bf16 v[64:79], v[96:99], v[232:235], v[64:79]
    ds_read_b64_tr_b16 v[96:97], v121 offset:24576
    ds_read_b64_tr_b16 v[98:99], v121 offset:25088
    v_exp_f32 v28, v28
    v_exp_f32 v29, v29
    v_mfma_f32_32x32x16_bf16 v[80:95], v[100:103], v[232:235], v[80:95]
    ds_read_b64_tr_b16 v[100:101], v120 offset:26624
    ds_read_b64_tr_b16 v[102:103], v120 offset:27136
    v_exp_f32 v30, v30
    v_exp_f32 v31, v31
    s_waitcnt lgkmcnt(6)
    v_mfma_f32_32x32x16_bf16 v[64:79], v[104:107], v[236:239], v[64:79]
    ds_read_b64_tr_b16 v[104:105], v121 offset:26624
    ds_read_b64_tr_b16 v[106:107], v121 offset:27136
    v_fma_f32 v28, v28, v124, v124
    v_fma_f32 v29, v29, v124, v124
    v_fma_f32 v30, v30, v124, v124
    v_fma_f32 v31, v31, v124, v124
    v_mfma_f32_32x32x16_bf16 v[80:95], v[108:111], v[236:239], v[80:95]
    ds_read_b64_tr_b16 v[108:109], v120 offset:28672
    ds_read_b64_tr_b16 v[110:111], v120 offset:29184
    v_rcp_f32 v28, v28
    v_rcp_f32 v29, v29
    s_waitcnt lgkmcnt(6)
    v_mfma_f32_32x32x16_bf16 v[64:79], v[112:115], v[240:243], v[64:79]
    ds_read_b64_tr_b16 v[112:113], v121 offset:28672
    ds_read_b64_tr_b16 v[114:115], v121 offset:29184
    v_rcp_f32 v30, v30
    v_rcp_f32 v31, v31
    v_mul_f32 v60, v28, v60
    v_mfma_f32_32x32x16_bf16 v[80:95], v[96:99], v[240:243], v[80:95]
    ds_read_b64_tr_b16 v[96:97], v120 offset:30720
    ds_read_b64_tr_b16 v[98:99], v120 offset:31232
    v_mul_f32 v61, v29, v61
    v_mul_f32 v62, v30, v62
    v_mul_f32 v63, v31, v63
    v_cvt_pk_bf16_f32 v24, v56, v57
    s_waitcnt lgkmcnt(6)
    v_mfma_f32_32x32x16_bf16 v[64:79], v[100:103], v[244:247], v[64:79]
    ds_read_b64_tr_b16 v[100:101], v121 offset:30720
    ds_read_b64_tr_b16 v[102:103], v121 offset:31232
    v_cvt_pk_bf16_f32 v25, v58, v59
    v_cvt_pk_bf16_f32 v26, v60, v61
    v_cvt_pk_bf16_f32 v27, v62, v63
    buffer_store_dwordx4 v[24:27], v122, s[32:35], s61 offen offset:3072 sc1
    buffer_store_dwordx4 v[16:19], v122, s[32:35], s61 offen offset:2048 sc1
    v_mfma_f32_32x32x16_bf16 v[80:95], v[104:107], v[244:247], v[80:95]
    s_barrier
    ds_read_b64_tr_b16 v[104:105], v120 offset:32768
    ds_read_b64_tr_b16 v[106:107], v120 offset:33280
    s_waitcnt lgkmcnt(6)
    v_mfma_f32_32x32x16_bf16 v[64:79], v[108:111], v[248:251], v[64:79]
    ds_read_b64_tr_b16 v[108:109], v121 offset:32768
    ds_read_b64_tr_b16 v[110:111], v121 offset:33280
    v_mfma_f32_32x32x16_bf16 v[80:95], v[112:115], v[248:251], v[80:95]
    ds_read_b64_tr_b16 v[112:113], v120 offset:40960
    ds_read_b64_tr_b16 v[114:115], v120 offset:41472
    s_waitcnt lgkmcnt(6)
    v_mfma_f32_32x32x16_bf16 v[64:79], v[96:99], v[252:255], v[64:79]
    ds_read_b64_tr_b16 v[96:97], v121 offset:40960
    ds_read_b64_tr_b16 v[98:99], v121 offset:41472
    v_mfma_f32_32x32x16_bf16 v[80:95], v[100:103], v[252:255], v[80:95]
    ds_read_b64_tr_b16 v[100:101], v120 offset:34816
    ds_read_b64_tr_b16 v[102:103], v120 offset:35328
    s_branch mk_join
mk_typeB:
    s_barrier
    v_add_u32 v120, 131072, v120
    v_add_u32 v121, 131072, v121
    ds_read_b64_tr_b16 v[96:97], v120 offset:0
    ds_read_b64_tr_b16 v[98:99], v120 offset:512
    ds_read_b64_tr_b16 v[100:101], v121 offset:0
    ds_read_b64_tr_b16 v[102:103], v121 offset:512
    ds_read_b64_tr_b16 v[104:105], v120 offset:8192
    ds_read_b64_tr_b16 v[106:107], v120 offset:8704
    ds_read_b64_tr_b16 v[108:109], v121 offset:8192
    ds_read_b64_tr_b16 v[110:111], v121 offset:8704
    ds_read_b64_tr_b16 v[112:113], v120 offset:2048
    ds_read_b64_tr_b16 v[114:115], v120 offset:2560
    s_waitcnt lgkmcnt(6)
    v_mfma_f32_32x32x16_bf16 v[0:15], v[128:131], v[96:99], 0
    ds_read_b64_tr_b16 v[96:97], v121 offset:2048
    ds_read_b64_tr_b16 v[98:99], v121 offset:2560
    v_lshlrev_b32 v64, 16, v132
    v_and_b32 v65, 0xffff0000, v132
    v_add_f32 v64, v64, v123
    v_add_f32 v65, v65, v123
    v_cvt_pk_bf16_f32 v132, v64, v65
    v_lshlrev_b32 v66, 16, v133
    v_and_b32 v67, 0xffff0000, v133
    v_mfma_f32_32x32x16_bf16 v[16:31], v[128:131], v[100:103], 0
    ds_read_b64_tr_b16 v[100:101], v120 offset:10240
    ds_read_b64_tr_b16 v[102:103], v120 offset:10752
    v_add_f32 v66, v66, v123
    v_add_f32 v67, v67, v123
    v_cvt_pk_bf16_f32 v133, v66, v67
    v_lshlrev_b32 v64, 16, v134
    v_and_b32 v65, 0xffff0000, v134
    v_add_f32 v64, v64, v123
    s_waitcnt lgkmcnt(6)
    v_mfma_f32_32x32x16_bf16 v[32:47], v[128:131], v[104:107], 0
    ds_read_b64_tr_b16 v[104:105], v121 offset:10240
    ds_read_b64_tr_b16 v[106:107], v121 offset:10752
    v_add_f32 v65, v65, v123
    v_cvt_pk_bf16_f32 v134, v64, v65
    v_lshlrev_b32 v66, 16, v135
    v_and_b32 v67, 0xffff0000, v135
    v_add_f32 v66, v66, v123
    v_add_f32 v67, v67, v123
    v_cvt_pk_bf16_f32 v135, v66, v67
    v_mfma_f32_32x32x16_bf16 v[48:63], v[128:131], v[108:111], 0
    ds_read_b64_tr_b16 v[108:109], v120 offset:4096
    ds_read_b64_tr_b16 v[110:111], v120 offset:4608
    v_lshlrev_b32 v64, 16, v136
    v_and_b32 v65, 0xffff0000, v136
    v_add_f32 v64, v64, v123
    v_add_f32 v65, v65, v123
    v_cvt_pk_bf16_f32 v136, v64, v65
    s_waitcnt lgkmcnt(6)
    v_mfma_f32_32x32x16_bf16 v[0:15], v[132:135], v[112:115], v[0:15]
    ds_read_b64_tr_b16 v[112:113], v121 offset:4096
    ds_read_b64_tr_b16 v[114:115], v121 offset:4608
    v_lshlrev_b32 v66, 16, v137
    v_and_b32 v67, 0xffff0000, v137
    v_add_f32 v66, v66, v123
    v_add_f32 v67, v67, v123
    v_cvt_pk_bf16_f32 v137, v66, v67
    v_mfma_f32_32x32x16_bf16 v[16:31], v[132:135], v[96:99], v[16:31]
    ds_read_b64_tr_b16 v[96:97], v120 offset:12288
    ds_read_b64_tr_b16 v[98:99], v120 offset:12800
    v_lshlrev_b32 v64, 16, v138
    v_and_b32 v65, 0xffff0000, v138
    v_add_f32 v64, v64, v123
    v_add_f32 v65, v65, v123
    v_cvt_pk_bf16_f32 v138, v64, v65
    s_waitcnt lgkmcnt(6)
    v_mfma_f32_32x32x16_bf16 v[32:47], v[132:135], v[100:103], v[32:47]
    ds_read_b64_tr_b16 v[100:101], v121 offset:12288
    ds_read_b64_tr_b16 v[102:103], v121 offset:12800
    v_lshlrev_b32 v66, 16, v139
    v_and_b32 v67, 0xffff0000, v139
    v_add_f32 v66, v66, v123
    v_add_f32 v67, v67, v123
    v_cvt_pk_bf16_f32 v139, v66, v67
    v_mfma_f32_32x32x16_bf16 v[48:63], v[132:135], v[104:107], v[48:63]
    ds_read_b64_tr_b16 v[104:105], v120 offset:6144
    ds_read_b64_tr_b16 v[106:107], v120 offset:6656
    v_lshlrev_b32 v64, 16, v140
    v_and_b32 v65, 0xffff0000, v140
    v_add_f32 v64, v64, v123
    v_add_f32 v65, v65, v123
    v_cvt_pk_bf16_f32 v140, v64, v65
    s_waitcnt lgkmcnt(6)
    v_mfma_f32_32x32x16_bf16 v[0:15], v[136:139], v[108:111], v[0:15]
    ds_read_b64_tr_b16 v[108:109], v121 offset:6144
    ds_read_b64_tr_b16 v[110:111], v121 offset:6656
    v_lshlrev_b32 v66, 16, v141
    v_and_b32 v67, 0xffff0000, v141
    v_add_f32 v66, v66, v123
    v_add_f32 v67, v67, v123
    v_cvt_pk_bf16_f32 v141, v66, v67
    v_mfma_f32_32x32x16_bf16 v[16:31], v[136:139], v[112:115], v[16:31]
    ds_read_b64_tr_b16 v[112:113], v120 offset:14336
    ds_read_b64_tr_b16 v[114:115], v120 offset:14848
    v_lshlrev_b32 v64, 16, v142
    v_and_b32 v65, 0xffff0000, v142
    v_add_f32 v64, v64, v123
    v_add_f32 v65, v65, v123
    v_cvt_pk_bf16_f32 v142, v64, v65
    s_waitcnt lgkmcnt(6)
    v_mfma_f32_32x32x16_bf16 v[32:47], v[136:139], v[96:99], v[32:47]
    ds_read_b64_tr_b16 v[96:97], v121 offset:14336
    ds_read_b64_tr_b16 v[98:99], v121 offset:14848
    v_lshlrev_b32 v66, 16, v143
    v_and_b32 v67, 0xffff0000, v143
    v_add_f32 v66, v66, v123
    v_add_f32 v67, v67, v123
    v_cvt_pk_bf16_f32 v143, v66, v67
    v_mfma_f32_32x32x16_bf16 v[48:63], v[136:139], v[100:103], v[48:63]
    s_barrier
    v_add_u32 v120, 4294836224, v120
    v_add_u32 v121, 4294836224, v121
    ds_read_b64_tr_b16 v[100:101], v120 offset:0
    ds_read_b64_tr_b16 v[102:103], v120 offset:512
    v_lshlrev_b32 v64, 16, v144
    v_and_b32 v65, 0xffff0000, v144
    v_add_f32 v64, v64, v123
    v_add_f32 v65, v65, v123
    v_cvt_pk_bf16_f32 v144, v64, v65
    s_waitcnt lgkmcnt(6)
    v_mfma_f32_32x32x16_bf16 v[0:15], v[140:143], v[104:107], v[0:15]
    ds_read_b64_tr_b16 v[104:105], v121 offset:0
    ds_read_b64_tr_b16 v[106:107], v121 offset:512
    v_lshlrev_b32 v66, 16, v145
    v_and_b32 v67, 0xffff0000, v145
    v_add_f32 v66, v66, v123
    v_add_f32 v67, v67, v123
    v_cvt_pk_bf16_f32 v145, v66, v67
    v_mfma_f32_32x32x16_bf16 v[16:31], v[140:143], v[108:111], v[16:31]
    ds_read_b64_tr_b16 v[108:109], v120 offset:8192
    ds_read_b64_tr_b16 v[110:111], v120 offset:8704
    v_lshlrev_b32 v64, 16, v146
    v_and_b32 v65, 0xffff0000, v146
    v_add_f32 v64, v64, v123
    v_add_f32 v65, v65, v123
    v_cvt_pk_bf16_f32 v146, v64, v65
    s_waitcnt lgkmcnt(6)
    v_mfma_f32_32x32x16_bf16 v[32:47], v[140:143], v[112:115], v[32:47]
    ds_read_b64_tr_b16 v[112:113], v121 offset:8192
    ds_read_b64_tr_b16 v[114:115], v121 offset:8704
    v_lshlrev_b32 v66, 16, v147
    v_and_b32 v67, 0xffff0000, v147
    v_add_f32 v66, v66, v123
    v_add_f32 v67, v67, v123
    v_cvt_pk_bf16_f32 v147, v66, v67
    v_mfma_f32_32x32x16_bf16 v[48:63], v[140:143], v[96:99], v[48:63]
    ds_read_b64_tr_b16 v[96:97], v120 offset:2048
    ds_read_b64_tr_b16 v[98:99], v120 offset:2560
    v_lshlrev_b32 v64, 16, v148
    v_and_b32 v65, 0xffff0000, v148
    v_add_f32 v64, v64, v123
    v_add_f32 v65, v65, v123
    v_cvt_pk_bf16_f32 v148, v64, v65
    s_waitcnt lgkmcnt(6)
    v_mfma_f32_32x32x16_bf16 v[0:15], v[144:147], v[100:103], v[0:15]
    ds_read_b64_tr_b16 v[100:101], v121 offset:2048
    ds_read_b64_tr_b16 v[102:103], v121 offset:2560
    v_lshlrev_b32 v66, 16, v149
    v_and_b32 v67, 0xffff0000, v149
    v_add_f32 v66, v66, v123
    v_add_f32 v67, v67, v123
    v_cvt_pk_bf16_f32 v149, v66, v67
    v_mfma_f32_32x32x16_bf16 v[16:31], v[144:147], v[104:107], v[16:31]
    ds_read_b64_tr_b16 v[104:105], v120 offset:10240
    ds_read_b64_tr_b16 v[106:107], v120 offset:10752
    v_lshlrev_b32 v64, 16, v150
    v_and_b32 v65, 0xffff0000, v150
    v_add_f32 v64, v64, v123
    v_add_f32 v65, v65, v123
    v_cvt_pk_bf16_f32 v150, v64, v65
    s_waitcnt lgkmcnt(6)
    v_mfma_f32_32x32x16_bf16 v[32:47], v[144:147], v[108:111], v[32:47]
    ds_read_b64_tr_b16 v[108:109], v121 offset:10240
    ds_read_b64_tr_b16 v[110:111], v121 offset:10752
    v_lshlrev_b32 v66, 16, v151
    v_and_b32 v67, 0xffff0000, v151
    v_add_f32 v66, v66, v123
    v_add_f32 v67, v67, v123
    v_cvt_pk_bf16_f32 v151, v66, v67
    v_mfma_f32_32x32x16_bf16 v[48:63], v[144:147], v[112:115], v[48:63]
    ds_read_b64_tr_b16 v[112:113], v120 offset:4096
    ds_read_b64_tr_b16 v[114:115], v120 offset:4608
    v_lshlrev_b32 v64, 16, v152
    v_and_b32 v65, 0xffff0000, v152
    v_add_f32 v64, v64, v123
    v_add_f32 v65, v65, v123
    v_cvt_pk_bf16_f32 v152, v64, v65
    s_waitcnt lgkmcnt(6)
    v_mfma_f32_32x32x16_bf16 v[0:15], v[148:151], v[96:99], v[0:15]
    ds_read_b64_tr_b16 v[96:97], v121 offset:4096
    ds_read_b64_tr_b16 v[98:99], v121 offset:4608
    v_lshlrev_b32 v66, 16, v153
    v_and_b32 v67, 0xffff0000, v153
    v_add_f32 v66, v66, v123
    v_add_f32 v67, v67, v123
    v_cvt_pk_bf16_f32 v153, v66, v67
    v_mfma_f32_32x32x16_bf16 v[16:31], v[148:151], v[100:103], v[16:31]
    ds_read_b64_tr_b16 v[100:101], v120 offset:12288
    ds_read_b64_tr_b16 v[102:103], v120 offset:12800
    v_lshlrev_b32 v64, 16, v154
    v_and_b32 v65, 0xffff0000, v154
    v_add_f32 v64, v64, v123
    v_add_f32 v65, v65, v123
    v_cvt_pk_bf16_f32 v154, v64, v65
    s_waitcnt lgkmcnt(6)
    v_mfma_f32_32x32x16_bf16 v[32:47], v[148:151], v[104:107], v[32:47]
    ds_read_b64_tr_b16 v[104:105], v121 offset:12288
    ds_read_b64_tr_b16 v[106:107], v121 offset:12800
    v_lshlrev_b32 v66, 16, v155
    v_and_b32 v67, 0xffff0000, v155
    v_add_f32 v66, v66, v123
    v_add_f32 v67, v67, v123
    v_cvt_pk_bf16_f32 v155, v66, v67
    v_mfma_f32_32x32x16_bf16 v[48:63], v[148:151], v[108:111], v[48:63]
    ds_read_b64_tr_b16 v[108:109], v120 offset:6144
    ds_read_b64_tr_b16 v[110:111], v120 offset:6656
    v_lshlrev_b32 v64, 16, v156
    v_and_b32 v65, 0xffff0000, v156
    v_add_f32 v64, v64, v123
    v_add_f32 v65, v65, v123
    v_cvt_pk_bf16_f32 v156, v64, v65
    s_waitcnt lgkmcnt(6)
    v_mfma_f32_32x32x16_bf16 v[0:15], v[152:155], v[112:115], v[0:15]
    ds_read_b64_tr_b16 v[112:113], v121 offset:6144
    ds_read_b64_tr_b16 v[114:115], v121 offset:6656
    v_lshlrev_b32 v66, 16, v157
    v_and_b32 v67, 0xffff0000, v157
    v_add_f32 v66, v66, v123
    v_add_f32 v67, v67, v123
    v_cvt_pk_bf16_f32 v157, v66, v67
    v_mfma_f32_32x32x16_bf16 v[16:31], v[152:155], v[96:99], v[16:31]
    ds_read_b64_tr_b16 v[96:97], v120 offset:14336
    ds_read_b64_tr_b16 v[98:99], v120 offset:14848
    v_lshlrev_b32 v64, 16, v158
    v_and_b32 v65, 0xffff0000, v158
    v_add_f32 v64, v64, v123
    v_add_f32 v65, v65, v123
    v_cvt_pk_bf16_f32 v158, v64, v65
    s_waitcnt lgkmcnt(6)
    v_mfma_f32_32x32x16_bf16 v[32:47], v[152:155], v[100:103], v[32:47]
    ds_read_b64_tr_b16 v[100:101], v121 offset:14336
    ds_read_b64_tr_b16 v[102:103], v121 offset:14848
    v_lshlrev_b32 v66, 16, v159
    v_and_b32 v67, 0xffff0000, v159
    v_add_f32 v66, v66, v123
    v_add_f32 v67, v67, v123
    v_cvt_pk_bf16_f32 v159, v66, v67
    v_mfma_f32_32x32x16_bf16 v[48:63], v[152:155], v[104:107], v[48:63]
    s_barrier
    ds_read_b64_tr_b16 v[104:105], v120 offset:49152
    ds_read_b64_tr_b16 v[106:107], v120 offset:49664
    v_lshlrev_b32 v64, 16, v160
    v_and_b32 v65, 0xffff0000, v160
    v_add_f32 v64, v64, v123
    v_add_f32 v65, v65, v123
    v_cvt_pk_bf16_f32 v160, v64, v65
    s_waitcnt lgkmcnt(6)
    v_mfma_f32_32x32x16_bf16 v[0:15], v[156:159], v[108:111], v[0:15]
    ds_read_b64_tr_b16 v[108:109], v121 offset:49152
    ds_read_b64_tr_b16 v[110:111], v121 offset:49664
    v_lshlrev_b32 v66, 16, v161
    v_and_b32 v67, 0xffff0000, v161
    v_add_f32 v66, v66, v123
    v_add_f32 v67, v67, v123
    v_cvt_pk_bf16_f32 v161, v66, v67
    v_mfma_f32_32x32x16_bf16 v[16:31], v[156:159], v[112:115], v[16:31]
    ds_read_b64_tr_b16 v[112:113], v120 offset:57344
    ds_read_b64_tr_b16 v[114:115], v120 offset:57856
    v_lshlrev_b32 v64, 16, v162
    v_and_b32 v65, 0xffff0000, v162
    v_add_f32 v64, v64, v123
    v_add_f32 v65, v65, v123
    v_cvt_pk_bf16_f32 v162, v64, v65
    s_waitcnt lgkmcnt(6)
    v_mfma_f32_32x32x16_bf16 v[32:47], v[156:159], v[96:99], v[32:47]
    ds_read_b64_tr_b16 v[96:97], v121 offset:57344
    ds_read_b64_tr_b16 v[98:99], v121 offset:57856
    v_lshlrev_b32 v66, 16, v163
    v_and_b32 v67, 0xffff0000, v163
    v_add_f32 v66, v66, v123
    v_add_f32 v67, v67, v123
    v_cvt_pk_bf16_f32 v163, v66, v67
    v_mfma_f32_32x32x16_bf16 v[48:63], v[156:159], v[100:103], v[48:63]
    ds_read_b64_tr_b16 v[100:101], v120 offset:51200
    ds_read_b64_tr_b16 v[102:103], v120 offset:51712
    v_lshlrev_b32 v64, 16, v164
    v_and_b32 v65, 0xffff0000, v164
    v_add_f32 v64, v64, v123
    v_add_f32 v65, v65, v123
    v_cvt_pk_bf16_f32 v164, v64, v65
    s_waitcnt lgkmcnt(6)
    v_mfma_f32_32x32x16_bf16 v[0:15], v[160:163], v[104:107], v[0:15]
    ds_read_b64_tr_b16 v[104:105], v121 offset:51200
    ds_read_b64_tr_b16 v[106:107], v121 offset:51712
    v_lshlrev_b32 v66, 16, v165
    v_and_b32 v67, 0xffff0000, v165
    v_add_f32 v66, v66, v123
    v_add_f32 v67, v67, v123
    v_cvt_pk_bf16_f32 v165, v66, v67
    v_mfma_f32_32x32x16_bf16 v[16:31], v[160:163], v[108:111], v[16:31]
    ds_read_b64_tr_b16 v[108:109], v120 offset:59392
    ds_read_b64_tr_b16 v[110:111], v120 offset:59904
    v_lshlrev_b32 v64, 16, v166
    v_and_b32 v65, 0xffff0000, v166
    v_add_f32 v64, v64, v123
    v_add_f32 v65, v65, v123
    v_cvt_pk_bf16_f32 v166, v64, v65
    s_waitcnt lgkmcnt(6)
    v_mfma_f32_32x32x16_bf16 v[32:47], v[160:163], v[112:115], v[32:47]
    ds_read_b64_tr_b16 v[112:113], v121 offset:59392
    ds_read_b64_tr_b16 v[114:115], v121 offset:59904
    v_lshlrev_b32 v66, 16, v167
    v_and_b32 v67, 0xffff0000, v167
    v_add_f32 v66, v66, v123
    v_add_f32 v67, v67, v123
    v_cvt_pk_bf16_f32 v167, v66, v67
    v_mfma_f32_32x32x16_bf16 v[48:63], v[160:163], v[96:99], v[48:63]
    ds_read_b64_tr_b16 v[96:97], v120 offset:53248
    ds_read_b64_tr_b16 v[98:99], v120 offset:53760
    v_lshlrev_b32 v64, 16, v168
    v_and_b32 v65, 0xffff0000, v168
    v_add_f32 v64, v64, v123
    v_add_f32 v65, v65, v123
    v_cvt_pk_bf16_f32 v168, v64, v65
    s_waitcnt lgkmcnt(6)
    v_mfma_f32_32x32x16_bf16 v[0:15], v[164:167], v[100:103], v[0:15]
    ds_read_b64_tr_b16 v[100:101], v121 offset:53248
    ds_read_b64_tr_b16 v[102:103], v121 offset:53760
    v_lshlrev_b32 v66, 16, v169
    v_and_b32 v67, 0xffff0000, v169
    v_add_f32 v66, v66, v123
    v_add_f32 v67, v67, v123
    v_cvt_pk_bf16_f32 v169, v66, v67
    v_mfma_f32_32x32x16_bf16 v[16:31], v[164:167], v[104:107], v[16:31]
    ds_read_b64_tr_b16 v[104:105], v120 offset:61440
    ds_read_b64_tr_b16 v[106:107], v120 offset:61952
    v_lshlrev_b32 v64, 16, v170
    v_and_b32 v65, 0xffff0000, v170
    v_add_f32 v64, v64, v123
    v_add_f32 v65, v65, v123
    v_cvt_pk_bf16_f32 v170, v64, v65
    s_waitcnt lgkmcnt(6)
    v_mfma_f32_32x32x16_bf16 v[32:47], v[164:167], v[108:111], v[32:47]
    ds_read_b64_tr_b16 v[108:109], v121 offset:61440
    ds_read_b64_tr_b16 v[110:111], v121 offset:61952
    v_lshlrev_b32 v66, 16, v171
    v_and_b32 v67, 0xffff0000, v171
    v_add_f32 v66, v66, v123
    v_add_f32 v67, v67, v123
    v_cvt_pk_bf16_f32 v171, v66, v67
    v_mfma_f32_32x32x16_bf16 v[48:63], v[164:167], v[112:115], v[48:63]
    ds_read_b64_tr_b16 v[112:113], v120 offset:55296
    ds_read_b64_tr_b16 v[114:115], v120 offset:55808
    v_lshlrev_b32 v64, 16, v172
    v_and_b32 v65, 0xffff0000, v172
    v_add_f32 v64, v64, v123
    v_add_f32 v65, v65, v123
    v_cvt_pk_bf16_f32 v172, v64, v65
    s_waitcnt lgkmcnt(6)
    v_mfma_f32_32x32x16_bf16 v[0:15], v[168:171], v[96:99], v[0:15]
    ds_read_b64_tr_b16 v[96:97], v121 offset:55296
    ds_read_b64_tr_b16 v[98:99], v121 offset:55808
    v_lshlrev_b32 v66, 16, v173
    v_and_b32 v67, 0xffff0000, v173
    v_add_f32 v66, v66, v123
    v_add_f32 v67, v67, v123
    v_cvt_pk_bf16_f32 v173, v66, v67
    v_mfma_f32_32x32x16_bf16 v[16:31], v[168:171], v[100:103], v[16:31]
    ds_read_b64_tr_b16 v[100:101], v120 offset:63488
    ds_read_b64_tr_b16 v[102:103], v120 offset:64000
    v_lshlrev_b32 v64, 16, v174
    v_and_b32 v65, 0xffff0000, v174
    v_add_f32 v64, v64, v123
    v_add_f32 v65, v65, v123
    v_cvt_pk_bf16_f32 v174, v64, v65
    s_waitcnt lgkmcnt(6)
    v_mfma_f32_32x32x16_bf16 v[32:47], v[168:171], v[104:107], v[32:47]
    ds_read_b64_tr_b16 v[104:105], v121 offset:63488
    ds_read_b64_tr_b16 v[106:107], v121 offset:64000
    v_lshlrev_b32 v66, 16, v175
    v_and_b32 v67, 0xffff0000, v175
    v_add_f32 v66, v66, v123
    v_add_f32 v67, v67, v123
    v_cvt_pk_bf16_f32 v175, v66, v67
    v_mfma_f32_32x32x16_bf16 v[48:63], v[168:171], v[108:111], v[48:63]
    s_barrier
    v_add_u32 v120, 65536, v120
    v_add_u32 v121, 65536, v121
    ds_read_b64_tr_b16 v[108:109], v120 offset:0
    ds_read_b64_tr_b16 v[110:111], v120 offset:512
    v_lshlrev_b32 v64, 16, v176
    v_and_b32 v65, 0xffff0000, v176
    v_add_f32 v64, v64, v123
    v_add_f32 v65, v65, v123
    v_cvt_pk_bf16_f32 v176, v64, v65
    s_waitcnt lgkmcnt(6)
    v_mfma_f32_32x32x16_bf16 v[0:15], v[172:175], v[112:115], v[0:15]
    ds_read_b64_tr_b16 v[112:113], v121 offset:0
    ds_read_b64_tr_b16 v[114:115], v121 offset:512
    v_lshlrev_b32 v66, 16, v177
    v_and_b32 v67, 0xffff0000, v177
    v_add_f32 v66, v66, v123
    v_add_f32 v67, v67, v123
    v_cvt_pk_bf16_f32 v177, v66, v67
    v_mfma_f32_32x32x16_bf16 v[16:31], v[172:175], v[96:99], v[16:31]
    ds_read_b64_tr_b16 v[96:97], v120 offset:8192
    ds_read_b64_tr_b16 v[98:99], v120 offset:8704
    v_lshlrev_b32 v64, 16, v178
    v_and_b32 v65, 0xffff0000, v178
    v_add_f32 v64, v64, v123
    v_add_f32 v65, v65, v123
    v_cvt_pk_bf16_f32 v178, v64, v65
    s_waitcnt lgkmcnt(6)
    v_mfma_f32_32x32x16_bf16 v[32:47], v[172:175], v[100:103], v[32:47]
    ds_read_b64_tr_b16 v[100:101], v121 offset:8192
    ds_read_b64_tr_b16 v[102:103], v121 offset:8704
    v_lshlrev_b32 v66, 16, v179
    v_and_b32 v67, 0xffff0000, v179
    v_add_f32 v66, v66, v123
    v_add_f32 v67, v67, v123
    v_cvt_pk_bf16_f32 v179, v66, v67
    v_mfma_f32_32x32x16_bf16 v[48:63], v[172:175], v[104:107], v[48:63]
    ds_read_b64_tr_b16 v[104:105], v120 offset:2048
    ds_read_b64_tr_b16 v[106:107], v120 offset:2560
    v_lshlrev_b32 v64, 16, v180
    v_and_b32 v65, 0xffff0000, v180
    v_add_f32 v64, v64, v123
    v_add_f32 v65, v65, v123
    v_cvt_pk_bf16_f32 v180, v64, v65
    s_waitcnt lgkmcnt(6)
    v_mfma_f32_32x32x16_bf16 v[0:15], v[176:179], v[108:111], v[0:15]
    ds_read_b64_tr_b16 v[108:109], v121 offset:2048
    ds_read_b64_tr_b16 v[110:111], v121 offset:2560
    v_lshlrev_b32 v66, 16, v181
    v_and_b32 v67, 0xffff0000, v181
    v_add_f32 v66, v66, v123
    v_add_f32 v67, v67, v123
    v_cvt_pk_bf16_f32 v181, v66, v67
    v_mfma_f32_32x32x16_bf16 v[16:31], v[176:179], v[112:115], v[16:31]
    ds_read_b64_tr_b16 v[112:113], v120 offset:10240
    ds_read_b64_tr_b16 v[114:115], v120 offset:10752
    v_lshlrev_b32 v64, 16, v182
    v_and_b32 v65, 0xffff0000, v182
    v_add_f32 v64, v64, v123
    v_add_f32 v65, v65, v123
    v_cvt_pk_bf16_f32 v182, v64, v65
    s_waitcnt lgkmcnt(6)
    v_mfma_f32_32x32x16_bf16 v[32:47], v[176:179], v[96:99], v[32:47]
    ds_read_b64_tr_b16 v[96:97], v121 offset:10240
    ds_read_b64_tr_b16 v[98:99], v121 offset:10752
    v_lshlrev_b32 v66, 16, v183
    v_and_b32 v67, 0xffff0000, v183
    v_add_f32 v66, v66, v123
    v_add_f32 v67, v67, v123
    v_cvt_pk_bf16_f32 v183, v66, v67
    v_mfma_f32_32x32x16_bf16 v[48:63], v[176:179], v[100:103], v[48:63]
    ds_read_b64_tr_b16 v[100:101], v120 offset:4096
    ds_read_b64_tr_b16 v[102:103], v120 offset:4608
    v_lshlrev_b32 v64, 16, v184
    v_and_b32 v65, 0xffff0000, v184
    v_add_f32 v64, v64, v123
    v_add_f32 v65, v65, v123
    v_cvt_pk_bf16_f32 v184, v64, v65
    s_waitcnt lgkmcnt(6)
    v_mfma_f32_32x32x16_bf16 v[0:15], v[180:183], v[104:107], v[0:15]
    ds_read_b64_tr_b16 v[104:105], v121 offset:4096
    ds_read_b64_tr_b16 v[106:107], v121 offset:4608
    v_lshlrev_b32 v66, 16, v185
    v_and_b32 v67, 0xffff0000, v185
    v_add_f32 v66, v66, v123
    v_add_f32 v67, v67, v123
    v_cvt_pk_bf16_f32 v185, v66, v67
    v_mfma_f32_32x32x16_bf16 v[16:31], v[180:183], v[108:111], v[16:31]
    ds_read_b64_tr_b16 v[108:109], v120 offset:12288
    ds_read_b64_tr_b16 v[110:111], v120 offset:12800
    v_lshlrev_b32 v64, 16, v186
    v_and_b32 v65, 0xffff0000, v186
    v_add_f32 v64, v64, v123
    v_add_f32 v65, v65, v123
    v_cvt_pk_bf16_f32 v186, v64, v65
    s_waitcnt lgkmcnt(6)
    v_mfma_f32_32x32x16_bf16 v[32:47], v[180:183], v[112:115], v[32:47]
    ds_read_b64_tr_b16 v[112:113], v121 offset:12288
    ds_read_b64_tr_b16 v[114:115], v121 offset:12800
    v_lshlrev_b32 v66, 16, v187
    v_and_b32 v67, 0xffff0000, v187
    v_add_f32 v66, v66, v123
    v_add_f32 v67, v67, v123
    v_cvt_pk_bf16_f32 v187, v66, v67
    v_mfma_f32_32x32x16_bf16 v[48:63], v[180:183], v[96:99], v[48:63]
    ds_read_b64_tr_b16 v[96:97], v120 offset:6144
    ds_read_b64_tr_b16 v[98:99], v120 offset:6656
    v_lshlrev_b32 v64, 16, v188
    v_and_b32 v65, 0xffff0000, v188
    v_add_f32 v64, v64, v123
    v_add_f32 v65, v65, v123
    v_cvt_pk_bf16_f32 v188, v64, v65
    s_waitcnt lgkmcnt(6)
    v_mfma_f32_32x32x16_bf16 v[0:15], v[184:187], v[100:103], v[0:15]
    ds_read_b64_tr_b16 v[100:101], v121 offset:6144
    ds_read_b64_tr_b16 v[102:103], v121 offset:6656
    v_lshlrev_b32 v66, 16, v189
    v_and_b32 v67, 0xffff0000, v189
    v_add_f32 v66, v66, v123
    v_add_f32 v67, v67, v123
    v_cvt_pk_bf16_f32 v189, v66, v67
    v_mfma_f32_32x32x16_bf16 v[16:31], v[184:187], v[104:107], v[16:31]
    ds_read_b64_tr_b16 v[104:105], v120 offset:14336
    ds_read_b64_tr_b16 v[106:107], v120 offset:14848
    v_lshlrev_b32 v64, 16, v190
    v_and_b32 v65, 0xffff0000, v190
    v_add_f32 v64, v64, v123
    v_add_f32 v65, v65, v123
    v_cvt_pk_bf16_f32 v190, v64, v65
    s_waitcnt lgkmcnt(6)
    v_mfma_f32_32x32x16_bf16 v[32:47], v[184:187], v[108:111], v[32:47]
    ds_read_b64_tr_b16 v[108:109], v121 offset:14336
    ds_read_b64_tr_b16 v[110:111], v121 offset:14848
    v_lshlrev_b32 v66, 16, v191
    v_and_b32 v67, 0xffff0000, v191
    v_add_f32 v66, v66, v123
    v_add_f32 v67, v67, v123
    v_cvt_pk_bf16_f32 v191, v66, v67
    v_mfma_f32_32x32x16_bf16 v[48:63], v[184:187], v[112:115], v[48:63]
    s_barrier
    ds_read_b64_tr_b16 v[112:113], v120 offset:16384
    ds_read_b64_tr_b16 v[114:115], v120 offset:16896
    v_lshlrev_b32 v64, 16, v192
    v_and_b32 v65, 0xffff0000, v192
    v_add_f32 v64, v64, v123
    v_add_f32 v65, v65, v123
    v_cvt_pk_bf16_f32 v192, v64, v65
    s_waitcnt lgkmcnt(6)
    v_mfma_f32_32x32x16_bf16 v[0:15], v[188:191], v[96:99], v[0:15]
    ds_read_b64_tr_b16 v[96:97], v121 offset:16384
    ds_read_b64_tr_b16 v[98:99], v121 offset:16896
    v_lshlrev_b32 v66, 16, v193
    v_and_b32 v67, 0xffff0000, v193
    v_add_f32 v66, v66, v123
    v_add_f32 v67, v67, v123
    v_cvt_pk_bf16_f32 v193, v66, v67
    v_mfma_f32_32x32x16_bf16 v[16:31], v[188:191], v[100:103], v[16:31]
    ds_read_b64_tr_b16 v[100:101], v120 offset:24576
    ds_read_b64_tr_b16 v[102:103], v120 offset:25088
    v_lshlrev_b32 v64, 16, v194
    v_and_b32 v65, 0xffff0000, v194
    v_add_f32 v64, v64, v123
    v_add_f32 v65, v65, v123
    v_cvt_pk_bf16_f32 v194, v64, v65
    s_waitcnt lgkmcnt(6)
    v_mfma_f32_32x32x16_bf16 v[32:47], v[188:191], v[104:107], v[32:47]
    ds_read_b64_tr_b16 v[104:105], v121 offset:24576
    ds_read_b64_tr_b16 v[106:107], v121 offset:25088
    v_lshlrev_b32 v66, 16, v195
    v_and_b32 v67, 0xffff0000, v195
    v_add_f32 v66, v66, v123
    v_add_f32 v67, v67, v123
    v_cvt_pk_bf16_f32 v195, v66, v67
    v_mfma_f32_32x32x16_bf16 v[48:63], v[188:191], v[108:111], v[48:63]
    ds_read_b64_tr_b16 v[108:109], v120 offset:18432
    ds_read_b64_tr_b16 v[110:111], v120 offset:18944
    v_lshlrev_b32 v64, 16, v196
    v_and_b32 v65, 0xffff0000, v196
    v_add_f32 v64, v64, v123
    v_add_f32 v65, v65, v123
    v_cvt_pk_bf16_f32 v196, v64, v65
    s_waitcnt lgkmcnt(6)
    v_mfma_f32_32x32x16_bf16 v[0:15], v[192:195], v[112:115], v[0:15]
    ds_read_b64_tr_b16 v[112:113], v121 offset:18432
    ds_read_b64_tr_b16 v[114:115], v121 offset:18944
    v_lshlrev_b32 v66, 16, v197
    v_and_b32 v67, 0xffff0000, v197
    v_add_f32 v66, v66, v123
    v_add_f32 v67, v67, v123
    v_cvt_pk_bf16_f32 v197, v66, v67
    v_mfma_f32_32x32x16_bf16 v[16:31], v[192:195], v[96:99], v[16:31]
    ds_read_b64_tr_b16 v[96:97], v120 offset:26624
    ds_read_b64_tr_b16 v[98:99], v120 offset:27136
    v_lshlrev_b32 v64, 16, v198
    v_and_b32 v65, 0xffff0000, v198
    v_add_f32 v64, v64, v123
    v_add_f32 v65, v65, v123
    v_cvt_pk_bf16_f32 v198, v64, v65
    s_waitcnt lgkmcnt(6)
    v_mfma_f32_32x32x16_bf16 v[32:47], v[192:195], v[100:103], v[32:47]
    ds_read_b64_tr_b16 v[100:101], v121 offset:26624
    ds_read_b64_tr_b16 v[102:103], v121 offset:27136
    v_lshlrev_b32 v66, 16, v199
    v_and_b32 v67, 0xffff0000, v199
    v_add_f32 v66, v66, v123
    v_add_f32 v67, v67, v123
    v_cvt_pk_bf16_f32 v199, v66, v67
    v_mfma_f32_32x32x16_bf16 v[48:63], v[192:195], v[104:107], v[48:63]
    ds_read_b64_tr_b16 v[104:105], v120 offset:20480
    ds_read_b64_tr_b16 v[106:107], v120 offset:20992
    v_lshlrev_b32 v64, 16, v200
    v_and_b32 v65, 0xffff0000, v200
    v_add_f32 v64, v64, v123
    v_add_f32 v65, v65, v123
    v_cvt_pk_bf16_f32 v200, v64, v65
    s_waitcnt lgkmcnt(6)
    v_mfma_f32_32x32x16_bf16 v[0:15], v[196:199], v[108:111], v[0:15]
    ds_read_b64_tr_b16 v[108:109], v121 offset:20480
    ds_read_b64_tr_b16 v[110:111], v121 offset:20992
    v_lshlrev_b32 v66, 16, v201
    v_and_b32 v67, 0xffff0000, v201
    v_add_f32 v66, v66, v123
    v_add_f32 v67, v67, v123
    v_cvt_pk_bf16_f32 v201, v66, v67
    v_mfma_f32_32x32x16_bf16 v[16:31], v[196:199], v[112:115], v[16:31]
    ds_read_b64_tr_b16 v[112:113], v120 offset:28672
    ds_read_b64_tr_b16 v[114:115], v120 offset:29184
    v_lshlrev_b32 v64, 16, v202
    v_and_b32 v65, 0xffff0000, v202
    v_add_f32 v64, v64, v123
    v_add_f32 v65, v65, v123
    v_cvt_pk_bf16_f32 v202, v64, v65
    s_waitcnt lgkmcnt(6)
    v_mfma_f32_32x32x16_bf16 v[32:47], v[196:199], v[96:99], v[32:47]
    ds_read_b64_tr_b16 v[96:97], v121 offset:28672
    ds_read_b64_tr_b16 v[98:99], v121 offset:29184
    v_lshlrev_b32 v66, 16, v203
    v_and_b32 v67, 0xffff0000, v203
    v_add_f32 v66, v66, v123
    v_add_f32 v67, v67, v123
    v_cvt_pk_bf16_f32 v203, v66, v67
    v_mfma_f32_32x32x16_bf16 v[48:63], v[196:199], v[100:103], v[48:63]
    ds_read_b64_tr_b16 v[100:101], v120 offset:22528
    ds_read_b64_tr_b16 v[102:103], v120 offset:23040
    v_lshlrev_b32 v64, 16, v204
    v_and_b32 v65, 0xffff0000, v204
    v_add_f32 v64, v64, v123
    v_add_f32 v65, v65, v123
    v_cvt_pk_bf16_f32 v204, v64, v65
    s_waitcnt lgkmcnt(6)
    v_mfma_f32_32x32x16_bf16 v[0:15], v[200:203], v[104:107], v[0:15]
    ds_read_b64_tr_b16 v[104:105], v121 offset:22528
    ds_read_b64_tr_b16 v[106:107], v121 offset:23040
    v_lshlrev_b32 v66, 16, v205
    v_and_b32 v67, 0xffff0000, v205
    v_add_f32 v66, v66, v123
    v_add_f32 v67, v67, v123
    v_cvt_pk_bf16_f32 v205, v66, v67
    v_mfma_f32_32x32x16_bf16 v[16:31], v[200:203], v[108:111], v[16:31]
    ds_read_b64_tr_b16 v[108:109], v120 offset:30720
    ds_read_b64_tr_b16 v[110:111], v120 offset:31232
    v_lshlrev_b32 v64, 16, v206
    v_and_b32 v65, 0xffff0000, v206
    v_add_f32 v64, v64, v123
    v_add_f32 v65, v65, v123
    v_cvt_pk_bf16_f32 v206, v64, v65
    s_waitcnt lgkmcnt(6)
    v_mfma_f32_32x32x16_bf16 v[32:47], v[200:203], v[112:115], v[32:47]
    ds_read_b64_tr_b16 v[112:113], v121 offset:30720
    ds_read_b64_tr_b16 v[114:115], v121 offset:31232
    v_lshlrev_b32 v66, 16, v207
    v_and_b32 v67, 0xffff0000, v207
    v_add_f32 v66, v66, v123
    v_add_f32 v67, v67, v123
    v_cvt_pk_bf16_f32 v207, v66, v67
    v_mfma_f32_32x32x16_bf16 v[48:63], v[200:203], v[96:99], v[48:63]
    s_barrier
    ds_read_b64_tr_b16 v[96:97], v120 offset:32768
    ds_read_b64_tr_b16 v[98:99], v120 offset:33280
    v_lshlrev_b32 v64, 16, v208
    v_and_b32 v65, 0xffff0000, v208
    v_add_f32 v64, v64, v123
    v_add_f32 v65, v65, v123
    v_cvt_pk_bf16_f32 v208, v64, v65
    s_waitcnt lgkmcnt(6)
    v_mfma_f32_32x32x16_bf16 v[0:15], v[204:207], v[100:103], v[0:15]
    ds_read_b64_tr_b16 v[100:101], v121 offset:32768
    ds_read_b64_tr_b16 v[102:103], v121 offset:33280
    v_lshlrev_b32 v66, 16, v209
    v_and_b32 v67, 0xffff0000, v209
    v_add_f32 v66, v66, v123
    v_add_f32 v67, v67, v123
    v_cvt_pk_bf16_f32 v209, v66, v67
    v_mfma_f32_32x32x16_bf16 v[16:31], v[204:207], v[104:107], v[16:31]
    ds_read_b64_tr_b16 v[104:105], v120 offset:40960
    ds_read_b64_tr_b16 v[106:107], v120 offset:41472
    v_lshlrev_b32 v64, 16, v210
    v_and_b32 v65, 0xffff0000, v210
    v_add_f32 v64, v64, v123
    v_add_f32 v65, v65, v123
    v_cvt_pk_bf16_f32 v210, v64, v65
    s_waitcnt lgkmcnt(6)
    v_mfma_f32_32x32x16_bf16 v[32:47], v[204:207], v[108:111], v[32:47]
    ds_read_b64_tr_b16 v[108:109], v121 offset:40960
    ds_read_b64_tr_b16 v[110:111], v121 offset:41472
    v_lshlrev_b32 v66, 16, v211
    v_and_b32 v67, 0xffff0000, v211
    v_add_f32 v66, v66, v123
    v_add_f32 v67, v67, v123
    v_cvt_pk_bf16_f32 v211, v66, v67
    v_mfma_f32_32x32x16_bf16 v[48:63], v[204:207], v[112:115], v[48:63]
    ds_read_b64_tr_b16 v[112:113], v120 offset:34816
    ds_read_b64_tr_b16 v[114:115], v120 offset:35328
    v_lshlrev_b32 v64, 16, v212
    v_and_b32 v65, 0xffff0000, v212
    v_add_f32 v64, v64, v123
    v_add_f32 v65, v65, v123
    v_cvt_pk_bf16_f32 v212, v64, v65
    s_waitcnt lgkmcnt(6)
    v_mfma_f32_32x32x16_bf16 v[0:15], v[208:211], v[96:99], v[0:15]
    ds_read_b64_tr_b16 v[96:97], v121 offset:34816
    ds_read_b64_tr_b16 v[98:99], v121 offset:35328
    v_lshlrev_b32 v66, 16, v213
    v_and_b32 v67, 0xffff0000, v213
    v_add_f32 v66, v66, v123
    v_add_f32 v67, v67, v123
    v_cvt_pk_bf16_f32 v213, v66, v67
    v_mfma_f32_32x32x16_bf16 v[16:31], v[208:211], v[100:103], v[16:31]
    ds_read_b64_tr_b16 v[100:101], v120 offset:43008
    ds_read_b64_tr_b16 v[102:103], v120 offset:43520
    v_lshlrev_b32 v64, 16, v214
    v_and_b32 v65, 0xffff0000, v214
    v_add_f32 v64, v64, v123
    v_add_f32 v65, v65, v123
    v_cvt_pk_bf16_f32 v214, v64, v65
    s_waitcnt lgkmcnt(6)
    v_mfma_f32_32x32x16_bf16 v[32:47], v[208:211], v[104:107], v[32:47]
    ds_read_b64_tr_b16 v[104:105], v121 offset:43008
    ds_read_b64_tr_b16 v[106:107], v121 offset:43520
    v_lshlrev_b32 v66, 16, v215
    v_and_b32 v67, 0xffff0000, v215
    v_add_f32 v66, v66, v123
    v_add_f32 v67, v67, v123
    v_cvt_pk_bf16_f32 v215, v66, v67
    v_mfma_f32_32x32x16_bf16 v[48:63], v[208:211], v[108:111], v[48:63]
    ds_read_b64_tr_b16 v[108:109], v120 offset:36864
    ds_read_b64_tr_b16 v[110:111], v120 offset:37376
    v_lshlrev_b32 v64, 16, v216
    v_and_b32 v65, 0xffff0000, v216
    v_add_f32 v64, v64, v123
    v_add_f32 v65, v65, v123
    v_cvt_pk_bf16_f32 v216, v64, v65
    s_waitcnt lgkmcnt(6)
    v_mfma_f32_32x32x16_bf16 v[0:15], v[212:215], v[112:115], v[0:15]
    ds_read_b64_tr_b16 v[112:113], v121 offset:36864
    ds_read_b64_tr_b16 v[114:115], v121 offset:37376
    v_lshlrev_b32 v66, 16, v217
    v_and_b32 v67, 0xffff0000, v217
    v_add_f32 v66, v66, v123
    v_add_f32 v67, v67, v123
    v_cvt_pk_bf16_f32 v217, v66, v67
    v_mfma_f32_32x32x16_bf16 v[16:31], v[212:215], v[96:99], v[16:31]
    ds_read_b64_tr_b16 v[96:97], v120 offset:45056
    ds_read_b64_tr_b16 v[98:99], v120 offset:45568
    v_lshlrev_b32 v64, 16, v218
    v_and_b32 v65, 0xffff0000, v218
    v_add_f32 v64, v64, v123
    v_add_f32 v65, v65, v123
    v_cvt_pk_bf16_f32 v218, v64, v65
    s_waitcnt lgkmcnt(6)
    v_mfma_f32_32x32x16_bf16 v[32:47], v[212:215], v[100:103], v[32:47]
    ds_read_b64_tr_b16 v[100:101], v121 offset:45056
    ds_read_b64_tr_b16 v[102:103], v121 offset:45568
    v_lshlrev_b32 v66, 16, v219
    v_and_b32 v67, 0xffff0000, v219
    v_add_f32 v66, v66, v123
    v_add_f32 v67, v67, v123
    v_cvt_pk_bf16_f32 v219, v66, v67
    v_mfma_f32_32x32x16_bf16 v[48:63], v[212:215], v[104:107], v[48:63]
    ds_read_b64_tr_b16 v[104:105], v120 offset:38912
    ds_read_b64_tr_b16 v[106:107], v120 offset:39424
    v_lshlrev_b32 v64, 16, v220
    v_and_b32 v65, 0xffff0000, v220
    v_add_f32 v64, v64, v123
    v_add_f32 v65, v65, v123
    v_cvt_pk_bf16_f32 v220, v64, v65
    s_waitcnt lgkmcnt(6)
    v_mfma_f32_32x32x16_bf16 v[0:15], v[216:219], v[108:111], v[0:15]
    ds_read_b64_tr_b16 v[108:109], v121 offset:38912
    ds_read_b64_tr_b16 v[110:111], v121 offset:39424
    v_lshlrev_b32 v66, 16, v221
    v_and_b32 v67, 0xffff0000, v221
    v_add_f32 v66, v66, v123
    v_add_f32 v67, v67, v123
    v_cvt_pk_bf16_f32 v221, v66, v67
    v_mfma_f32_32x32x16_bf16 v[16:31], v[216:219], v[112:115], v[16:31]
    ds_read_b64_tr_b16 v[112:113], v120 offset:47104
    ds_read_b64_tr_b16 v[114:115], v120 offset:47616
    v_lshlrev_b32 v64, 16, v222
    v_and_b32 v65, 0xffff0000, v222
    v_add_f32 v64, v64, v123
    v_add_f32 v65, v65, v123
    v_cvt_pk_bf16_f32 v222, v64, v65
    s_waitcnt lgkmcnt(6)
    v_mfma_f32_32x32x16_bf16 v[32:47], v[216:219], v[96:99], v[32:47]
    ds_read_b64_tr_b16 v[96:97], v121 offset:47104
    ds_read_b64_tr_b16 v[98:99], v121 offset:47616
    v_lshlrev_b32 v66, 16, v223
    v_and_b32 v67, 0xffff0000, v223
    v_add_f32 v66, v66, v123
    v_add_f32 v67, v67, v123
    v_cvt_pk_bf16_f32 v223, v66, v67
    v_mfma_f32_32x32x16_bf16 v[48:63], v[216:219], v[100:103], v[48:63]
    s_barrier
    v_add_u32 v120, 4294901760, v120
    v_add_u32 v121, 4294901760, v121
    ds_read_b64_tr_b16 v[100:101], v120 offset:16384
    ds_read_b64_tr_b16 v[102:103], v120 offset:16896
    v_lshlrev_b32 v64, 16, v224
    v_and_b32 v65, 0xffff0000, v224
    v_add_f32 v64, v64, v123
    v_add_f32 v65, v65, v123
    v_cvt_pk_bf16_f32 v224, v64, v65
    s_waitcnt lgkmcnt(6)
    v_mfma_f32_32x32x16_bf16 v[0:15], v[220:223], v[104:107], v[0:15]
    ds_read_b64_tr_b16 v[104:105], v121 offset:16384
    ds_read_b64_tr_b16 v[106:107], v121 offset:16896
    v_lshlrev_b32 v66, 16, v225
    v_and_b32 v67, 0xffff0000, v225
    v_add_f32 v66, v66, v123
    v_add_f32 v67, v67, v123
    v_cvt_pk_bf16_f32 v225, v66, v67
    v_mfma_f32_32x32x16_bf16 v[16:31], v[220:223], v[108:111], v[16:31]
    ds_read_b64_tr_b16 v[108:109], v120 offset:24576
    ds_read_b64_tr_b16 v[110:111], v120 offset:25088
    v_lshlrev_b32 v64, 16, v226
    v_and_b32 v65, 0xffff0000, v226
    v_add_f32 v64, v64, v123
    v_add_f32 v65, v65, v123
    v_cvt_pk_bf16_f32 v226, v64, v65
    s_waitcnt lgkmcnt(6)
    v_mfma_f32_32x32x16_bf16 v[32:47], v[220:223], v[112:115], v[32:47]
    ds_read_b64_tr_b16 v[112:113], v121 offset:24576
    ds_read_b64_tr_b16 v[114:115], v121 offset:25088
    v_lshlrev_b32 v66, 16, v227
    v_and_b32 v67, 0xffff0000, v227
    v_add_f32 v66, v66, v123
    v_add_f32 v67, v67, v123
    v_cvt_pk_bf16_f32 v227, v66, v67
    v_mfma_f32_32x32x16_bf16 v[48:63], v[220:223], v[96:99], v[48:63]
    ds_read_b64_tr_b16 v[96:97], v120 offset:18432
    ds_read_b64_tr_b16 v[98:99], v120 offset:18944
    v_lshlrev_b32 v64, 16, v228
    v_and_b32 v65, 0xffff0000, v228
    v_add_f32 v64, v64, v123
    v_add_f32 v65, v65, v123
    v_cvt_pk_bf16_f32 v228, v64, v65
    s_waitcnt lgkmcnt(6)
    v_mfma_f32_32x32x16_bf16 v[0:15], v[224:227], v[100:103], v[0:15]
    ds_read_b64_tr_b16 v[100:101], v121 offset:18432
    ds_read_b64_tr_b16 v[102:103], v121 offset:18944
    v_lshlrev_b32 v66, 16, v229
    v_and_b32 v67, 0xffff0000, v229
    v_add_f32 v66, v66, v123
    v_add_f32 v67, v67, v123
    v_cvt_pk_bf16_f32 v229, v66, v67
    v_mfma_f32_32x32x16_bf16 v[16:31], v[224:227], v[104:107], v[16:31]
    ds_read_b64_tr_b16 v[104:105], v120 offset:26624
    ds_read_b64_tr_b16 v[106:107], v120 offset:27136
    v_lshlrev_b32 v64, 16, v230
    v_and_b32 v65, 0xffff0000, v230
    v_add_f32 v64, v64, v123
    v_add_f32 v65, v65, v123
    v_cvt_pk_bf16_f32 v230, v64, v65
    s_waitcnt lgkmcnt(6)
    v_mfma_f32_32x32x16_bf16 v[32:47], v[224:227], v[108:111], v[32:47]
    ds_read_b64_tr_b16 v[108:109], v121 offset:26624
    ds_read_b64_tr_b16 v[110:111], v121 offset:27136
    v_lshlrev_b32 v66, 16, v231
    v_and_b32 v67, 0xffff0000, v231
    v_add_f32 v66, v66, v123
    v_add_f32 v67, v67, v123
    v_cvt_pk_bf16_f32 v231, v66, v67
    v_mfma_f32_32x32x16_bf16 v[48:63], v[224:227], v[112:115], v[48:63]
    ds_read_b64_tr_b16 v[112:113], v120 offset:20480
    ds_read_b64_tr_b16 v[114:115], v120 offset:20992
    v_lshlrev_b32 v64, 16, v232
    v_and_b32 v65, 0xffff0000, v232
    v_add_f32 v64, v64, v123
    v_add_f32 v65, v65, v123
    v_cvt_pk_bf16_f32 v232, v64, v65
    s_waitcnt lgkmcnt(6)
    v_mfma_f32_32x32x16_bf16 v[0:15], v[228:231], v[96:99], v[0:15]
    ds_read_b64_tr_b16 v[96:97], v121 offset:20480
    ds_read_b64_tr_b16 v[98:99], v121 offset:20992
    v_lshlrev_b32 v66, 16, v233
    v_and_b32 v67, 0xffff0000, v233
    v_add_f32 v66, v66, v123
    v_add_f32 v67, v67, v123
    v_cvt_pk_bf16_f32 v233, v66, v67
    v_mfma_f32_32x32x16_bf16 v[16:31], v[228:231], v[100:103], v[16:31]
    ds_read_b64_tr_b16 v[100:101], v120 offset:28672
    ds_read_b64_tr_b16 v[102:103], v120 offset:29184
    v_lshlrev_b32 v64, 16, v234
    v_and_b32 v65, 0xffff0000, v234
    v_add_f32 v64, v64, v123
    v_add_f32 v65, v65, v123
    v_cvt_pk_bf16_f32 v234, v64, v65
    s_waitcnt lgkmcnt(6)
    v_mfma_f32_32x32x16_bf16 v[32:47], v[228:231], v[104:107], v[32:47]
    ds_read_b64_tr_b16 v[104:105], v121 offset:28672
    ds_read_b64_tr_b16 v[106:107], v121 offset:29184
    v_lshlrev_b32 v66, 16, v235
    v_and_b32 v67, 0xffff0000, v235
    v_add_f32 v66, v66, v123
    v_add_f32 v67, v67, v123
    v_cvt_pk_bf16_f32 v235, v66, v67
    v_mfma_f32_32x32x16_bf16 v[48:63], v[228:231], v[108:111], v[48:63]
    ds_read_b64_tr_b16 v[108:109], v120 offset:22528
    ds_read_b64_tr_b16 v[110:111], v120 offset:23040
    v_lshlrev_b32 v64, 16, v236
    v_and_b32 v65, 0xffff0000, v236
    v_add_f32 v64, v64, v123
    v_add_f32 v65, v65, v123
    v_cvt_pk_bf16_f32 v236, v64, v65
    s_waitcnt lgkmcnt(6)
    v_mfma_f32_32x32x16_bf16 v[0:15], v[232:235], v[112:115], v[0:15]
    ds_read_b64_tr_b16 v[112:113], v121 offset:22528
    ds_read_b64_tr_b16 v[114:115], v121 offset:23040
    v_lshlrev_b32 v66, 16, v237
    v_and_b32 v67, 0xffff0000, v237
    v_add_f32 v66, v66, v123
    v_add_f32 v67, v67, v123
    v_cvt_pk_bf16_f32 v237, v66, v67
    v_mfma_f32_32x32x16_bf16 v[16:31], v[232:235], v[96:99], v[16:31]
    ds_read_b64_tr_b16 v[96:97], v120 offset:30720
    ds_read_b64_tr_b16 v[98:99], v120 offset:31232
    v_lshlrev_b32 v64, 16, v238
    v_and_b32 v65, 0xffff0000, v238
    v_add_f32 v64, v64, v123
    v_add_f32 v65, v65, v123
    v_cvt_pk_bf16_f32 v238, v64, v65
    s_waitcnt lgkmcnt(6)
    v_mfma_f32_32x32x16_bf16 v[32:47], v[232:235], v[100:103], v[32:47]
    ds_read_b64_tr_b16 v[100:101], v121 offset:30720
    ds_read_b64_tr_b16 v[102:103], v121 offset:31232
    v_lshlrev_b32 v66, 16, v239
    v_and_b32 v67, 0xffff0000, v239
    v_add_f32 v66, v66, v123
    v_add_f32 v67, v67, v123
    v_cvt_pk_bf16_f32 v239, v66, v67
    v_mfma_f32_32x32x16_bf16 v[48:63], v[232:235], v[104:107], v[48:63]
    s_barrier
    ds_read_b64_tr_b16 v[104:105], v120 offset:32768
    ds_read_b64_tr_b16 v[106:107], v120 offset:33280
    v_lshlrev_b32 v64, 16, v240
    v_and_b32 v65, 0xffff0000, v240
    v_add_f32 v64, v64, v123
    v_add_f32 v65, v65, v123
    v_cvt_pk_bf16_f32 v240, v64, v65
    s_waitcnt lgkmcnt(6)
    v_mfma_f32_32x32x16_bf16 v[0:15], v[236:239], v[108:111], v[0:15]
    ds_read_b64_tr_b16 v[108:109], v121 offset:32768
    ds_read_b64_tr_b16 v[110:111], v121 offset:33280
    v_lshlrev_b32 v66, 16, v241
    v_and_b32 v67, 0xffff0000, v241
    v_add_f32 v66, v66, v123
    v_add_f32 v67, v67, v123
    v_cvt_pk_bf16_f32 v241, v66, v67
    v_mfma_f32_32x32x16_bf16 v[16:31], v[236:239], v[112:115], v[16:31]
    ds_read_b64_tr_b16 v[112:113], v120 offset:40960
    ds_read_b64_tr_b16 v[114:115], v120 offset:41472
    v_lshlrev_b32 v64, 16, v242
    v_and_b32 v65, 0xffff0000, v242
    v_add_f32 v64, v64, v123
    v_add_f32 v65, v65, v123
    v_cvt_pk_bf16_f32 v242, v64, v65
    s_waitcnt lgkmcnt(6)
    v_mfma_f32_32x32x16_bf16 v[32:47], v[236:239], v[96:99], v[32:47]
    ds_read_b64_tr_b16 v[96:97], v121 offset:40960
    ds_read_b64_tr_b16 v[98:99], v121 offset:41472
    v_lshlrev_b32 v66, 16, v243
    v_and_b32 v67, 0xffff0000, v243
    v_add_f32 v66, v66, v123
    v_add_f32 v67, v67, v123
    v_cvt_pk_bf16_f32 v243, v66, v67
    v_mfma_f32_32x32x16_bf16 v[48:63], v[236:239], v[100:103], v[48:63]
    ds_read_b64_tr_b16 v[100:101], v120 offset:34816
    ds_read_b64_tr_b16 v[102:103], v120 offset:35328
    v_lshlrev_b32 v64, 16, v244
    v_and_b32 v65, 0xffff0000, v244
    v_add_f32 v64, v64, v123
    v_add_f32 v65, v65, v123
    v_cvt_pk_bf16_f32 v244, v64, v65
    s_waitcnt lgkmcnt(6)
    v_mfma_f32_32x32x16_bf16 v[0:15], v[240:243], v[104:107], v[0:15]
    ds_read_b64_tr_b16 v[104:105], v121 offset:34816
    ds_read_b64_tr_b16 v[106:107], v121 offset:35328
    v_lshlrev_b32 v66, 16, v245
    v_and_b32 v67, 0xffff0000, v245
    v_add_f32 v66, v66, v123
    v_add_f32 v67, v67, v123
    v_cvt_pk_bf16_f32 v245, v66, v67
    v_mfma_f32_32x32x16_bf16 v[16:31], v[240:243], v[108:111], v[16:31]
    ds_read_b64_tr_b16 v[108:109], v120 offset:43008
    ds_read_b64_tr_b16 v[110:111], v120 offset:43520
    v_lshlrev_b32 v64, 16, v246
    v_and_b32 v65, 0xffff0000, v246
    v_add_f32 v64, v64, v123
    v_add_f32 v65, v65, v123
    v_cvt_pk_bf16_f32 v246, v64, v65
    s_waitcnt lgkmcnt(6)
    v_mfma_f32_32x32x16_bf16 v[32:47], v[240:243], v[112:115], v[32:47]
    ds_read_b64_tr_b16 v[112:113], v121 offset:43008
    ds_read_b64_tr_b16 v[114:115], v121 offset:43520
    v_lshlrev_b32 v66, 16, v247
    v_and_b32 v67, 0xffff0000, v247
    v_add_f32 v66, v66, v123
    v_add_f32 v67, v67, v123
    v_cvt_pk_bf16_f32 v247, v66, v67
    v_mfma_f32_32x32x16_bf16 v[48:63], v[240:243], v[96:99], v[48:63]
    ds_read_b64_tr_b16 v[96:97], v120 offset:36864
    ds_read_b64_tr_b16 v[98:99], v120 offset:37376
    v_lshlrev_b32 v64, 16, v248
    v_and_b32 v65, 0xffff0000, v248
    v_add_f32 v64, v64, v123
    v_add_f32 v65, v65, v123
    v_cvt_pk_bf16_f32 v248, v64, v65
    s_waitcnt lgkmcnt(6)
    v_mfma_f32_32x32x16_bf16 v[0:15], v[244:247], v[100:103], v[0:15]
    ds_read_b64_tr_b16 v[100:101], v121 offset:36864
    ds_read_b64_tr_b16 v[102:103], v121 offset:37376
    v_lshlrev_b32 v66, 16, v249
    v_and_b32 v67, 0xffff0000, v249
    v_add_f32 v66, v66, v123
    v_add_f32 v67, v67, v123
    v_cvt_pk_bf16_f32 v249, v66, v67
    v_mfma_f32_32x32x16_bf16 v[16:31], v[244:247], v[104:107], v[16:31]
    ds_read_b64_tr_b16 v[104:105], v120 offset:45056
    ds_read_b64_tr_b16 v[106:107], v120 offset:45568
    v_lshlrev_b32 v64, 16, v250
    v_and_b32 v65, 0xffff0000, v250
    v_add_f32 v64, v64, v123
    v_add_f32 v65, v65, v123
    v_cvt_pk_bf16_f32 v250, v64, v65
    s_waitcnt lgkmcnt(6)
    v_mfma_f32_32x32x16_bf16 v[32:47], v[244:247], v[108:111], v[32:47]
    ds_read_b64_tr_b16 v[108:109], v121 offset:45056
    ds_read_b64_tr_b16 v[110:111], v121 offset:45568
    v_lshlrev_b32 v66, 16, v251
    v_and_b32 v67, 0xffff0000, v251
    v_add_f32 v66, v66, v123
    v_add_f32 v67, v67, v123
    v_cvt_pk_bf16_f32 v251, v66, v67
    v_mfma_f32_32x32x16_bf16 v[48:63], v[244:247], v[112:115], v[48:63]
    ds_read_b64_tr_b16 v[112:113], v120 offset:38912
    ds_read_b64_tr_b16 v[114:115], v120 offset:39424
    v_lshlrev_b32 v64, 16, v252
    v_and_b32 v65, 0xffff0000, v252
    v_add_f32 v64, v64, v123
    v_add_f32 v65, v65, v123
    v_cvt_pk_bf16_f32 v252, v64, v65
    s_waitcnt lgkmcnt(6)
    v_mfma_f32_32x32x16_bf16 v[0:15], v[248:251], v[96:99], v[0:15]
    ds_read_b64_tr_b16 v[96:97], v121 offset:38912
    ds_read_b64_tr_b16 v[98:99], v121 offset:39424
    v_lshlrev_b32 v66, 16, v253
    v_and_b32 v67, 0xffff0000, v253
    v_add_f32 v66, v66, v123
    v_add_f32 v67, v67, v123
    v_cvt_pk_bf16_f32 v253, v66, v67
    v_mfma_f32_32x32x16_bf16 v[16:31], v[248:251], v[100:103], v[16:31]
    ds_read_b64_tr_b16 v[100:101], v120 offset:47104
    ds_read_b64_tr_b16 v[102:103], v120 offset:47616
    v_lshlrev_b32 v64, 16, v254
    v_and_b32 v65, 0xffff0000, v254
    v_add_f32 v64, v64, v123
    v_add_f32 v65, v65, v123
    v_cvt_pk_bf16_f32 v254, v64, v65
    s_waitcnt lgkmcnt(6)
    v_mfma_f32_32x32x16_bf16 v[32:47], v[248:251], v[104:107], v[32:47]
    ds_read_b64_tr_b16 v[104:105], v121 offset:47104
    ds_read_b64_tr_b16 v[106:107], v121 offset:47616
    v_lshlrev_b32 v66, 16, v255
    v_and_b32 v67, 0xffff0000, v255
    v_add_f32 v66, v66, v123
    v_add_f32 v67, v67, v123
    v_cvt_pk_bf16_f32 v255, v66, v67
    v_mfma_f32_32x32x16_bf16 v[48:63], v[248:251], v[108:111], v[48:63]
    s_barrier
    ds_read_b64_tr_b16 v[108:109], v120 offset:49152
    ds_read_b64_tr_b16 v[110:111], v120 offset:49664
    s_waitcnt lgkmcnt(6)
    v_mfma_f32_32x32x16_bf16 v[0:15], v[252:255], v[112:115], v[0:15]
    ds_read_b64_tr_b16 v[112:113], v121 offset:49152
    ds_read_b64_tr_b16 v[114:115], v121 offset:49664
    v_mfma_f32_32x32x16_bf16 v[16:31], v[252:255], v[96:99], v[16:31]
    ds_read_b64_tr_b16 v[96:97], v120 offset:51200
    ds_read_b64_tr_b16 v[98:99], v120 offset:51712
    s_waitcnt lgkmcnt(6)
    v_mfma_f32_32x32x16_bf16 v[32:47], v[252:255], v[100:103], v[32:47]
    ds_read_b64_tr_b16 v[100:101], v121 offset:51200
    ds_read_b64_tr_b16 v[102:103], v121 offset:51712
    v_mfma_f32_32x32x16_bf16 v[48:63], v[252:255], v[104:107], v[48:63]
    ds_read_b64_tr_b16 v[104:105], v120 offset:53248
    ds_read_b64_tr_b16 v[106:107], v120 offset:53760
    v_lshrrev_b32 v123, 9, v122
    v_lshl_add_u32 v123, v123, 4, s72
    s_waitcnt lgkmcnt(6)
    v_mfma_f32_32x32x16_bf16 v[64:79], v[108:111], v[128:131], 0
    ds_read_b64_tr_b16 v[108:109], v121 offset:53248
    ds_read_b64_tr_b16 v[110:111], v121 offset:53760
    ds_read_b128 v[116:119], v123 offset:0
    v_mfma_f32_32x32x16_bf16 v[80:95], v[112:115], v[128:131], 0
    ds_read_b64_tr_b16 v[112:113], v120 offset:55296
    ds_read_b64_tr_b16 v[114:115], v120 offset:55808
    s_waitcnt lgkmcnt(7)
    v_mfma_f32_32x32x16_bf16 v[64:79], v[96:99], v[132:135], v[64:79]
    ds_read_b64_tr_b16 v[96:97], v121 offset:55296
    ds_read_b64_tr_b16 v[98:99], v121 offset:55808
    v_mfma_f32_32x32x16_bf16 v[80:95], v[100:103], v[132:135], v[80:95]
    ds_read_b64_tr_b16 v[100:101], v120 offset:57344
    ds_read_b64_tr_b16 v[102:103], v120 offset:57856
    s_waitcnt lgkmcnt(7)
    v_mfma_f32_32x32x16_bf16 v[64:79], v[104:107], v[136:139], v[64:79]
    ds_read_b64_tr_b16 v[104:105], v121 offset:57344
    ds_read_b64_tr_b16 v[106:107], v121 offset:57856
    s_waitcnt lgkmcnt(8)
    v_mul_f32 v0, v116, v0
    v_mul_f32 v1, v117, v1
    v_mfma_f32_32x32x16_bf16 v[80:95], v[108:111], v[136:139], v[80:95]
    ds_read_b64_tr_b16 v[108:109], v120 offset:59392
    ds_read_b64_tr_b16 v[110:111], v120 offset:59904
    v_mul_f32 v2, v118, v2
    v_mul_f32 v3, v119, v3
    s_waitcnt lgkmcnt(6)
    v_mfma_f32_32x32x16_bf16 v[64:79], v[112:115], v[140:143], v[64:79]
    ds_read_b64_tr_b16 v[112:113], v121 offset:59392
    ds_read_b64_tr_b16 v[114:115], v121 offset:59904
    v_mul_f32 v16, v116, v16
    v_mul_f32 v17, v117, v17
    v_mfma_f32_32x32x16_bf16 v[80:95], v[96:99], v[140:143], v[80:95]
    ds_read_b64_tr_b16 v[96:97], v120 offset:61440
    ds_read_b64_tr_b16 v[98:99], v120 offset:61952
    v_mul_f32 v18, v118, v18
    v_mul_f32 v19, v119, v19
    s_waitcnt lgkmcnt(6)
    v_mfma_f32_32x32x16_bf16 v[64:79], v[100:103], v[144:147], v[64:79]
    ds_read_b64_tr_b16 v[100:101], v121 offset:61440
    ds_read_b64_tr_b16 v[102:103], v121 offset:61952
    v_mul_f32 v32, v116, v32
    v_mul_f32 v33, v117, v33
    v_mfma_f32_32x32x16_bf16 v[80:95], v[104:107], v[144:147], v[80:95]
    ds_read_b64_tr_b16 v[104:105], v120 offset:63488
    ds_read_b64_tr_b16 v[106:107], v120 offset:64000
    v_mul_f32 v34, v118, v34
    v_mul_f32 v35, v119, v35
    s_waitcnt lgkmcnt(6)
    v_mfma_f32_32x32x16_bf16 v[64:79], v[108:111], v[148:151], v[64:79]
    ds_read_b64_tr_b16 v[108:109], v121 offset:63488
    ds_read_b64_tr_b16 v[110:111], v121 offset:64000
    v_mul_f32 v48, v116, v48
    v_mul_f32 v49, v117, v49
    v_mfma_f32_32x32x16_bf16 v[80:95], v[112:115], v[148:151], v[80:95]
    s_barrier
    v_add_u32 v120, 65536, v120
    v_add_u32 v121, 65536, v121
    ds_read_b64_tr_b16 v[112:113], v120 offset:0
    ds_read_b64_tr_b16 v[114:115], v120 offset:512
    v_mul_f32 v50, v118, v50
    v_mul_f32 v51, v119, v51
    s_waitcnt lgkmcnt(6)
    v_mfma_f32_32x32x16_bf16 v[64:79], v[96:99], v[152:155], v[64:79]
    ds_read_b64_tr_b16 v[96:97], v121 offset:0
    ds_read_b64_tr_b16 v[98:99], v121 offset:512
    ds_read_b128 v[116:119], v123 offset:32
    v_mfma_f32_32x32x16_bf16 v[80:95], v[100:103], v[152:155], v[80:95]
    ds_read_b64_tr_b16 v[100:101], v120 offset:2048
    ds_read_b64_tr_b16 v[102:103], v120 offset:2560
    s_waitcnt lgkmcnt(7)
    v_mfma_f32_32x32x16_bf16 v[64:79], v[104:107], v[156:159], v[64:79]
    ds_read_b64_tr_b16 v[104:105], v121 offset:2048
    ds_read_b64_tr_b16 v[106:107], v121 offset:2560
    v_mfma_f32_32x32x16_bf16 v[80:95], v[108:111], v[156:159], v[80:95]
    ds_read_b64_tr_b16 v[108:109], v120 offset:4096
    ds_read_b64_tr_b16 v[110:111], v120 offset:4608
    s_waitcnt lgkmcnt(7)
    v_mfma_f32_32x32x16_bf16 v[64:79], v[112:115], v[160:163], v[64:79]
    ds_read_b64_tr_b16 v[112:113], v121 offset:4096
    ds_read_b64_tr_b16 v[114:115], v121 offset:4608
    s_waitcnt lgkmcnt(8)
    v_mul_f32 v4, v116, v4
    v_mul_f32 v5, v117, v5
    v_mul_f32 v6, v118, v6
    v_mul_f32 v7, v119, v7
    v_mul_f32 v20, v116, v20
    v_mfma_f32_32x32x16_bf16 v[80:95], v[96:99], v[160:163], v[80:95]
    ds_read_b64_tr_b16 v[96:97], v120 offset:6144
    ds_read_b64_tr_b16 v[98:99], v120 offset:6656
    v_mul_f32 v21, v117, v21
    v_mul_f32 v22, v118, v22
    v_mul_f32 v23, v119, v23
    v_mul_f32 v36, v116, v36
    v_mul_f32 v37, v117, v37
    s_waitcnt lgkmcnt(6)
    v_mfma_f32_32x32x16_bf16 v[64:79], v[100:103], v[164:167], v[64:79]
    ds_read_b64_tr_b16 v[100:101], v121 offset:6144
    ds_read_b64_tr_b16 v[102:103], v121 offset:6656
    v_mul_f32 v38, v118, v38
    v_mul_f32 v39, v119, v39
    v_mul_f32 v52, v116, v52
    v_mul_f32 v53, v117, v53
    v_mul_f32 v54, v118, v54
    v_mfma_f32_32x32x16_bf16 v[80:95], v[104:107], v[164:167], v[80:95]
    ds_read_b64_tr_b16 v[104:105], v120 offset:8192
    ds_read_b64_tr_b16 v[106:107], v120 offset:8704
    v_mul_f32 v55, v119, v55
    v_cvt_pk_bf16_f32 v0, v0, v1
    v_cvt_pk_bf16_f32 v1, v2, v3
    v_cvt_pk_bf16_f32 v2, v4, v5
    v_cvt_pk_bf16_f32 v3, v6, v7
    s_waitcnt lgkmcnt(6)
    v_mfma_f32_32x32x16_bf16 v[64:79], v[108:111], v[168:171], v[64:79]
    ds_read_b64_tr_b16 v[108:109], v121 offset:8192
    ds_read_b64_tr_b16 v[110:111], v121 offset:8704
    s_add_u32 s4, s64, 0
    buffer_store_dwordx4 v[0:3], v127, s[32:35], s4 offen offset:0 sc1
    v_cvt_pk_bf16_f32 v16, v16, v17
    v_cvt_pk_bf16_f32 v17, v18, v19
    v_cvt_pk_bf16_f32 v18, v20, v21
    v_mfma_f32_32x32x16_bf16 v[80:95], v[112:115], v[168:171], v[80:95]
    ds_read_b64_tr_b16 v[112:113], v120 offset:10240
    ds_read_b64_tr_b16 v[114:115], v120 offset:10752
    v_cvt_pk_bf16_f32 v19, v22, v23
    s_add_u32 s4, s64, 131072
    buffer_store_dwordx4 v[16:19], v127, s[32:35], s4 offen offset:0 sc1
    v_cvt_pk_bf16_f32 v32, v32, v33
    v_cvt_pk_bf16_f32 v33, v34, v35
    s_waitcnt lgkmcnt(6)
    v_mfma_f32_32x32x16_bf16 v[64:79], v[96:99], v[172:175], v[64:79]
    ds_read_b64_tr_b16 v[96:97], v121 offset:10240
    ds_read_b64_tr_b16 v[98:99], v121 offset:10752
    v_cvt_pk_bf16_f32 v34, v36, v37
    v_cvt_pk_bf16_f32 v35, v38, v39
    s_add_u32 s4, s64, 262144
    buffer_store_dwordx4 v[32:35], v127, s[32:35], s4 offen offset:0 sc1
    v_cvt_pk_bf16_f32 v48, v48, v49
    v_mfma_f32_32x32x16_bf16 v[80:95], v[100:103], v[172:175], v[80:95]
    ds_read_b64_tr_b16 v[100:101], v120 offset:12288
    ds_read_b64_tr_b16 v[102:103], v120 offset:12800
    v_cvt_pk_bf16_f32 v49, v50, v51
    v_cvt_pk_bf16_f32 v50, v52, v53
    v_cvt_pk_bf16_f32 v51, v54, v55
    s_add_u32 s4, s64, 393216
    buffer_store_dwordx4 v[48:51], v127, s[32:35], s4 offen offset:0 sc1
    s_waitcnt lgkmcnt(6)
    v_mfma_f32_32x32x16_bf16 v[64:79], v[104:107], v[176:179], v[64:79]
    ds_read_b64_tr_b16 v[104:105], v121 offset:12288
    ds_read_b64_tr_b16 v[106:107], v121 offset:12800
    ds_read_b128 v[116:119], v123 offset:64
    v_mfma_f32_32x32x16_bf16 v[80:95], v[108:111], v[176:179], v[80:95]
    ds_read_b64_tr_b16 v[108:109], v120 offset:14336
    ds_read_b64_tr_b16 v[110:111], v120 offset:14848
    s_waitcnt lgkmcnt(7)
    v_mfma_f32_32x32x16_bf16 v[64:79], v[112:115], v[180:183], v[64:79]
    ds_read_b64_tr_b16 v[112:113], v121 offset:14336
    ds_read_b64_tr_b16 v[114:115], v121 offset:14848
    v_mfma_f32_32x32x16_bf16 v[80:95], v[96:99], v[180:183], v[80:95]
    s_barrier
    v_add_u32 v120, 4294901760, v120
    v_add_u32 v121, 4294901760, v121
    ds_read_b64_tr_b16 v[96:97], v120 offset:0
    ds_read_b64_tr_b16 v[98:99], v120 offset:512
    s_waitcnt lgkmcnt(7)
    v_mfma_f32_32x32x16_bf16 v[64:79], v[100:103], v[184:187], v[64:79]
    ds_read_b64_tr_b16 v[100:101], v121 offset:0
    ds_read_b64_tr_b16 v[102:103], v121 offset:512
    s_waitcnt lgkmcnt(8)
    v_mul_f32 v8, v116, v8
    v_mul_f32 v9, v117, v9
    v_mfma_f32_32x32x16_bf16 v[80:95], v[104:107], v[184:187], v[80:95]
    ds_read_b64_tr_b16 v[104:105], v120 offset:2048
    ds_read_b64_tr_b16 v[106:107], v120 offset:2560
    v_mul_f32 v10, v118, v10
    v_mul_f32 v11, v119, v11
    s_waitcnt lgkmcnt(6)
    v_mfma_f32_32x32x16_bf16 v[64:79], v[108:111], v[188:191], v[64:79]
    ds_read_b64_tr_b16 v[108:109], v121 offset:2048
    ds_read_b64_tr_b16 v[110:111], v121 offset:2560
    v_mul_f32 v24, v116, v24
    v_mul_f32 v25, v117, v25
    v_mfma_f32_32x32x16_bf16 v[80:95], v[112:115], v[188:191], v[80:95]
    ds_read_b64_tr_b16 v[112:113], v120 offset:4096
    ds_read_b64_tr_b16 v[114:115], v120 offset:4608
    v_mul_f32 v26, v118, v26
    v_mul_f32 v27, v119, v27
    s_waitcnt lgkmcnt(6)
    v_mfma_f32_32x32x16_bf16 v[64:79], v[96:99], v[192:195], v[64:79]
    ds_read_b64_tr_b16 v[96:97], v121 offset:4096
    ds_read_b64_tr_b16 v[98:99], v121 offset:4608
    v_mul_f32 v40, v116, v40
    v_mul_f32 v41, v117, v41
    v_mfma_f32_32x32x16_bf16 v[80:95], v[100:103], v[192:195], v[80:95]
    ds_read_b64_tr_b16 v[100:101], v120 offset:6144
    ds_read_b64_tr_b16 v[102:103], v120 offset:6656
    v_mul_f32 v42, v118, v42
    v_mul_f32 v43, v119, v43
    s_waitcnt lgkmcnt(6)
    v_mfma_f32_32x32x16_bf16 v[64:79], v[104:107], v[196:199], v[64:79]
    ds_read_b64_tr_b16 v[104:105], v121 offset:6144
    ds_read_b64_tr_b16 v[106:107], v121 offset:6656
    v_mul_f32 v56, v116, v56
    v_mul_f32 v57, v117, v57
    v_mfma_f32_32x32x16_bf16 v[80:95], v[108:111], v[196:199], v[80:95]
    ds_read_b64_tr_b16 v[108:109], v120 offset:8192
    ds_read_b64_tr_b16 v[110:111], v120 offset:8704
    v_mul_f32 v58, v118, v58
    v_mul_f32 v59, v119, v59
    s_waitcnt lgkmcnt(6)
    v_mfma_f32_32x32x16_bf16 v[64:79], v[112:115], v[200:203], v[64:79]
    ds_read_b64_tr_b16 v[112:113], v121 offset:8192
    ds_read_b64_tr_b16 v[114:115], v121 offset:8704
    ds_read_b128 v[116:119], v123 offset:96
    v_mfma_f32_32x32x16_bf16 v[80:95], v[96:99], v[200:203], v[80:95]
    ds_read_b64_tr_b16 v[96:97], v120 offset:10240
    ds_read_b64_tr_b16 v[98:99], v120 offset:10752
    s_waitcnt lgkmcnt(7)
    v_mfma_f32_32x32x16_bf16 v[64:79], v[100:103], v[204:207], v[64:79]
    ds_read_b64_tr_b16 v[100:101], v121 offset:10240
    ds_read_b64_tr_b16 v[102:103], v121 offset:10752
    v_mfma_f32_32x32x16_bf16 v[80:95], v[104:107], v[204:207], v[80:95]
    ds_read_b64_tr_b16 v[104:105], v120 offset:12288
    ds_read_b64_tr_b16 v[106:107], v120 offset:12800
    s_waitcnt lgkmcnt(7)
    v_mfma_f32_32x32x16_bf16 v[64:79], v[108:111], v[208:211], v[64:79]
    ds_read_b64_tr_b16 v[108:109], v121 offset:12288
    ds_read_b64_tr_b16 v[110:111], v121 offset:12800
    s_waitcnt lgkmcnt(8)
    v_mul_f32 v12, v116, v12
    v_mul_f32 v13, v117, v13
    v_mul_f32 v14, v118, v14
    v_mfma_f32_32x32x16_bf16 v[80:95], v[112:115], v[208:211], v[80:95]
    ds_read_b64_tr_b16 v[112:113], v120 offset:14336
    ds_read_b64_tr_b16 v[114:115], v120 offset:14848
    v_mul_f32 v15, v119, v15
    v_mul_f32 v28, v116, v28
    s_waitcnt lgkmcnt(6)
    v_mfma_f32_32x32x16_bf16 v[64:79], v[96:99], v[212:215], v[64:79]
    ds_read_b64_tr_b16 v[96:97], v121 offset:14336
    ds_read_b64_tr_b16 v[98:99], v121 offset:14848
    v_mul_f32 v29, v117, v29
    v_mul_f32 v30, v118, v30
    v_mul_f32 v31, v119, v31
    v_mfma_f32_32x32x16_bf16 v[80:95], v[100:103], v[212:215], v[80:95]
    s_barrier
    ds_read_b64_tr_b16 v[100:101], v120 offset:16384
    ds_read_b64_tr_b16 v[102:103], v120 offset:16896
    v_mul_f32 v44, v116, v44
    v_mul_f32 v45, v117, v45
    s_waitcnt lgkmcnt(6)
    v_mfma_f32_32x32x16_bf16 v[64:79], v[104:107], v[216:219], v[64:79]
    ds_read_b64_tr_b16 v[104:105], v121 offset:16384
    ds_read_b64_tr_b16 v[106:107], v121 offset:16896
    v_mul_f32 v46, v118, v46
    v_mul_f32 v47, v119, v47
    v_mul_f32 v60, v116, v60
    v_mfma_f32_32x32x16_bf16 v[80:95], v[108:111], v[216:219], v[80:95]
    ds_read_b64_tr_b16 v[108:109], v120 offset:18432
    ds_read_b64_tr_b16 v[110:111], v120 offset:18944
    v_mul_f32 v61, v117, v61
    v_mul_f32 v62, v118, v62
    s_waitcnt lgkmcnt(6)
    v_mfma_f32_32x32x16_bf16 v[64:79], v[112:115], v[220:223], v[64:79]
    ds_read_b64_tr_b16 v[112:113], v121 offset:18432
    ds_read_b64_tr_b16 v[114:115], v121 offset:18944
    v_mul_f32 v63, v119, v63
    v_cvt_pk_bf16_f32 v8, v8, v9
    v_cvt_pk_bf16_f32 v9, v10, v11
    v_mfma_f32_32x32x16_bf16 v[80:95], v[96:99], v[220:223], v[80:95]
    ds_read_b64_tr_b16 v[96:97], v120 offset:20480
    ds_read_b64_tr_b16 v[98:99], v120 offset:20992
    v_cvt_pk_bf16_f32 v10, v12, v13
    v_cvt_pk_bf16_f32 v11, v14, v15
    s_waitcnt lgkmcnt(6)
    v_mfma_f32_32x32x16_bf16 v[64:79], v[100:103], v[224:227], v[64:79]
    ds_read_b64_tr_b16 v[100:101], v121 offset:20480
    ds_read_b64_tr_b16 v[102:103], v121 offset:20992
    s_add_u32 s4, s64, 0
    buffer_store_dwordx4 v[8:11], v127, s[32:35], s4 offen offset:512 sc1
    v_cvt_pk_bf16_f32 v24, v24, v25
    v_mfma_f32_32x32x16_bf16 v[80:95], v[104:107], v[224:227], v[80:95]
    ds_read_b64_tr_b16 v[104:105], v120 offset:22528
    ds_read_b64_tr_b16 v[106:107], v120 offset:23040
    v_cvt_pk_bf16_f32 v25, v26, v27
    v_cvt_pk_bf16_f32 v26, v28, v29
    s_waitcnt lgkmcnt(6)
    v_mfma_f32_32x32x16_bf16 v[64:79], v[108:111], v[228:231], v[64:79]
    ds_read_b64_tr_b16 v[108:109], v121 offset:22528
    ds_read_b64_tr_b16 v[110:111], v121 offset:23040
    v_cvt_pk_bf16_f32 v27, v30, v31
    s_add_u32 s4, s64, 131072
    buffer_store_dwordx4 v[24:27], v127, s[32:35], s4 offen offset:512 sc1
    v_mfma_f32_32x32x16_bf16 v[80:95], v[112:115], v[228:231], v[80:95]
    ds_read_b64_tr_b16 v[112:113], v120 offset:24576
    ds_read_b64_tr_b16 v[114:115], v120 offset:25088
    v_cvt_pk_bf16_f32 v40, v40, v41
    v_cvt_pk_bf16_f32 v41, v42, v43
    s_waitcnt lgkmcnt(6)
    v_mfma_f32_32x32x16_bf16 v[64:79], v[96:99], v[232:235], v[64:79]
    ds_read_b64_tr_b16 v[96:97], v121 offset:24576
    ds_read_b64_tr_b16 v[98:99], v121 offset:25088
    v_cvt_pk_bf16_f32 v42, v44, v45
    v_cvt_pk_bf16_f32 v43, v46, v47
    s_add_u32 s4, s64, 262144
    v_mfma_f32_32x32x16_bf16 v[80:95], v[100:103], v[232:235], v[80:95]
    ds_read_b64_tr_b16 v[100:101], v120 offset:26624
    ds_read_b64_tr_b16 v[102:103], v120 offset:27136
    buffer_store_dwordx4 v[40:43], v127, s[32:35], s4 offen offset:512 sc1
    v_cvt_pk_bf16_f32 v56, v56, v57
    s_waitcnt lgkmcnt(6)
    v_mfma_f32_32x32x16_bf16 v[64:79], v[104:107], v[236:239], v[64:79]
    ds_read_b64_tr_b16 v[104:105], v121 offset:26624
    ds_read_b64_tr_b16 v[106:107], v121 offset:27136
    v_cvt_pk_bf16_f32 v57, v58, v59
    v_cvt_pk_bf16_f32 v58, v60, v61
    v_cvt_pk_bf16_f32 v59, v62, v63
    v_mfma_f32_32x32x16_bf16 v[80:95], v[108:111], v[236:239], v[80:95]
    ds_read_b64_tr_b16 v[108:109], v120 offset:28672
    ds_read_b64_tr_b16 v[110:111], v120 offset:29184
    s_add_u32 s4, s64, 393216
    buffer_store_dwordx4 v[56:59], v127, s[32:35], s4 offen offset:512 sc1
    s_waitcnt lgkmcnt(6)
    v_mfma_f32_32x32x16_bf16 v[64:79], v[112:115], v[240:243], v[64:79]
    ds_read_b64_tr_b16 v[112:113], v121 offset:28672
    ds_read_b64_tr_b16 v[114:115], v121 offset:29184
    v_mfma_f32_32x32x16_bf16 v[80:95], v[96:99], v[240:243], v[80:95]
    ds_read_b64_tr_b16 v[96:97], v120 offset:30720
    ds_read_b64_tr_b16 v[98:99], v120 offset:31232
    s_waitcnt lgkmcnt(6)
    v_mfma_f32_32x32x16_bf16 v[64:79], v[100:103], v[244:247], v[64:79]
    ds_read_b64_tr_b16 v[100:101], v121 offset:30720
    ds_read_b64_tr_b16 v[102:103], v121 offset:31232
    v_mfma_f32_32x32x16_bf16 v[80:95], v[104:107], v[244:247], v[80:95]
    s_barrier
    ds_read_b64_tr_b16 v[104:105], v120 offset:32768
    ds_read_b64_tr_b16 v[106:107], v120 offset:33280
    s_waitcnt lgkmcnt(6)
    v_mfma_f32_32x32x16_bf16 v[64:79], v[108:111], v[248:251], v[64:79]
    ds_read_b64_tr_b16 v[108:109], v121 offset:32768
    ds_read_b64_tr_b16 v[110:111], v121 offset:33280
    v_mfma_f32_32x32x16_bf16 v[80:95], v[112:115], v[248:251], v[80:95]
    ds_read_b64_tr_b16 v[112:113], v120 offset:40960
    ds_read_b64_tr_b16 v[114:115], v120 offset:41472
    s_waitcnt lgkmcnt(6)
    v_mfma_f32_32x32x16_bf16 v[64:79], v[96:99], v[252:255], v[64:79]
    ds_read_b64_tr_b16 v[96:97], v121 offset:40960
    ds_read_b64_tr_b16 v[98:99], v121 offset:41472
    v_mfma_f32_32x32x16_bf16 v[80:95], v[100:103], v[252:255], v[80:95]
    ds_read_b64_tr_b16 v[100:101], v120 offset:34816
    ds_read_b64_tr_b16 v[102:103], v120 offset:35328
mk_join:
    s_waitcnt lgkmcnt(6)
    v_mfma_f32_32x32x16_bf16 v[0:15], v[104:107], v[128:131], 0
    ds_read_b64_tr_b16 v[104:105], v121 offset:34816
    ds_read_b64_tr_b16 v[106:107], v121 offset:35328
    v_mfma_f32_32x32x16_bf16 v[16:31], v[108:111], v[128:131], 0
    ds_read_b64_tr_b16 v[108:109], v120 offset:43008
    ds_read_b64_tr_b16 v[110:111], v120 offset:43520
    v_mul_f32 v64, v126, v64
    v_mul_f32 v65, v126, v65
    v_mul_f32 v66, v126, v66
    v_mul_f32 v67, v126, v67
    s_waitcnt lgkmcnt(6)
    v_mfma_f32_32x32x16_bf16 v[32:47], v[112:115], v[128:131], 0
    ds_read_b64_tr_b16 v[112:113], v121 offset:43008
    ds_read_b64_tr_b16 v[114:115], v121 offset:43520
    v_mul_f32 v68, v126, v68
    v_mul_f32 v69, v126, v69
    v_mul_f32 v70, v126, v70
    v_mul_f32 v71, v126, v71
    v_mfma_f32_32x32x16_bf16 v[48:63], v[96:99], v[128:131], 0
    ds_read_b64_tr_b16 v[96:97], v120 offset:36864
    ds_read_b64_tr_b16 v[98:99], v120 offset:37376
    v_cvt_pk_bf16_f32 v64, v64, v65
    v_cvt_pk_bf16_f32 v65, v66, v67
    v_cvt_pk_bf16_f32 v66, v68, v69
    v_cvt_pk_bf16_f32 v67, v70, v71
    s_waitcnt lgkmcnt(6)
    v_mfma_f32_32x32x16_bf16 v[0:15], v[100:103], v[132:135], v[0:15]
    ds_read_b64_tr_b16 v[100:101], v121 offset:36864
    ds_read_b64_tr_b16 v[102:103], v121 offset:37376
    buffer_store_dwordx4 v[64:67], v122, s[32:35], s63 offen sc1
    s_add_u32 s63, s63, 65536
    v_mul_f32 v72, v126, v72
    v_mul_f32 v73, v126, v73
    v_mfma_f32_32x32x16_bf16 v[16:31], v[104:107], v[132:135], v[16:31]
    ds_read_b64_tr_b16 v[104:105], v120 offset:45056
    ds_read_b64_tr_b16 v[106:107], v120 offset:45568
    v_mul_f32 v74, v126, v74
    v_mul_f32 v75, v126, v75
    v_mul_f32 v76, v126, v76
    v_mul_f32 v77, v126, v77
    s_waitcnt lgkmcnt(6)
    v_mfma_f32_32x32x16_bf16 v[32:47], v[108:111], v[132:135], v[32:47]
    ds_read_b64_tr_b16 v[108:109], v121 offset:45056
    ds_read_b64_tr_b16 v[110:111], v121 offset:45568
    v_mul_f32 v78, v126, v78
    v_mul_f32 v79, v126, v79
    v_cvt_pk_bf16_f32 v72, v72, v73
    v_cvt_pk_bf16_f32 v73, v74, v75
    v_mfma_f32_32x32x16_bf16 v[48:63], v[112:115], v[132:135], v[48:63]
    ds_read_b64_tr_b16 v[112:113], v120 offset:38912
    ds_read_b64_tr_b16 v[114:115], v120 offset:39424
    v_cvt_pk_bf16_f32 v74, v76, v77
    v_cvt_pk_bf16_f32 v75, v78, v79
    buffer_store_dwordx4 v[72:75], v122, s[32:35], s63 offen sc1
    s_add_u32 s63, s63, 65536
    s_waitcnt lgkmcnt(6)
    v_mfma_f32_32x32x16_bf16 v[0:15], v[96:99], v[136:139], v[0:15]
    ds_read_b64_tr_b16 v[96:97], v121 offset:38912
    ds_read_b64_tr_b16 v[98:99], v121 offset:39424
    v_mul_f32 v80, v126, v80
    v_mul_f32 v81, v126, v81
    v_mul_f32 v82, v126, v82
    v_mfma_f32_32x32x16_bf16 v[16:31], v[100:103], v[136:139], v[16:31]
    ds_read_b64_tr_b16 v[100:101], v120 offset:47104
    ds_read_b64_tr_b16 v[102:103], v120 offset:47616
    v_mul_f32 v83, v126, v83
    v_mul_f32 v84, v126, v84
    v_mul_f32 v85, v126, v85
    v_mul_f32 v86, v126, v86
    s_waitcnt lgkmcnt(6)
    v_mfma_f32_32x32x16_bf16 v[32:47], v[104:107], v[136:139], v[32:47]
    ds_read_b64_tr_b16 v[104:105], v121 offset:47104
    ds_read_b64_tr_b16 v[106:107], v121 offset:47616
    v_mul_f32 v87, v126, v87
    v_cvt_pk_bf16_f32 v80, v80, v81
    v_cvt_pk_bf16_f32 v81, v82, v83
    v_cvt_pk_bf16_f32 v82, v84, v85
    v_mfma_f32_32x32x16_bf16 v[48:63], v[108:111], v[136:139], v[48:63]
    s_barrier
    ds_read_b64_tr_b16 v[108:109], v120 offset:49152
    ds_read_b64_tr_b16 v[110:111], v120 offset:49664
    v_cvt_pk_bf16_f32 v83, v86, v87
    buffer_store_dwordx4 v[80:83], v122, s[32:35], s63 offen sc1
    s_add_u32 s63, s63, 65536
    v_mul_f32 v88, v126, v88
    s_waitcnt lgkmcnt(6)
    v_mfma_f32_32x32x16_bf16 v[0:15], v[112:115], v[140:143], v[0:15]
    ds_read_b64_tr_b16 v[112:113], v121 offset:49152
    ds_read_b64_tr_b16 v[114:115], v121 offset:49664
    v_mul_f32 v89, v126, v89
    v_mul_f32 v90, v126, v90
    v_mul_f32 v91, v126, v91
    v_mul_f32 v92, v126, v92
    v_mfma_f32_32x32x16_bf16 v[16:31], v[96:99], v[140:143], v[16:31]
    ds_read_b64_tr_b16 v[96:97], v120 offset:57344
    ds_read_b64_tr_b16 v[98:99], v120 offset:57856
    v_mul_f32 v93, v126, v93
    v_mul_f32 v94, v126, v94
    v_mul_f32 v95, v126, v95
    v_cvt_pk_bf16_f32 v88, v88, v89
    s_waitcnt lgkmcnt(6)
    v_mfma_f32_32x32x16_bf16 v[32:47], v[100:103], v[140:143], v[32:47]
    ds_read_b64_tr_b16 v[100:101], v121 offset:57344
    ds_read_b64_tr_b16 v[102:103], v121 offset:57856
    v_cvt_pk_bf16_f32 v89, v90, v91
    v_cvt_pk_bf16_f32 v90, v92, v93
    v_cvt_pk_bf16_f32 v91, v94, v95
    buffer_store_dwordx4 v[88:91], v122, s[32:35], s63 offen sc1
    v_mfma_f32_32x32x16_bf16 v[48:63], v[104:107], v[140:143], v[48:63]
    ds_read_b64_tr_b16 v[104:105], v120 offset:51200
    ds_read_b64_tr_b16 v[106:107], v120 offset:51712
    s_waitcnt lgkmcnt(6)
    v_mfma_f32_32x32x16_bf16 v[0:15], v[108:111], v[144:147], v[0:15]
    ds_read_b64_tr_b16 v[108:109], v121 offset:51200
    ds_read_b64_tr_b16 v[110:111], v121 offset:51712
    v_mfma_f32_32x32x16_bf16 v[16:31], v[112:115], v[144:147], v[16:31]
    ds_read_b64_tr_b16 v[112:113], v120 offset:59392
    ds_read_b64_tr_b16 v[114:115], v120 offset:59904
    s_waitcnt lgkmcnt(6)
    v_mfma_f32_32x32x16_bf16 v[32:47], v[96:99], v[144:147], v[32:47]
    ds_read_b64_tr_b16 v[96:97], v121 offset:59392
    ds_read_b64_tr_b16 v[98:99], v121 offset:59904
    v_mfma_f32_32x32x16_bf16 v[48:63], v[100:103], v[144:147], v[48:63]
    ds_read_b64_tr_b16 v[100:101], v120 offset:53248
    ds_read_b64_tr_b16 v[102:103], v120 offset:53760
    s_waitcnt lgkmcnt(6)
    v_mfma_f32_32x32x16_bf16 v[0:15], v[104:107], v[148:151], v[0:15]
    ds_read_b64_tr_b16 v[104:105], v121 offset:53248
    ds_read_b64_tr_b16 v[106:107], v121 offset:53760
    v_mfma_f32_32x32x16_bf16 v[16:31], v[108:111], v[148:151], v[16:31]
    ds_read_b64_tr_b16 v[108:109], v120 offset:61440
    ds_read_b64_tr_b16 v[110:111], v120 offset:61952
    s_waitcnt lgkmcnt(6)
    v_mfma_f32_32x32x16_bf16 v[32:47], v[112:115], v[148:151], v[32:47]
    ds_read_b64_tr_b16 v[112:113], v121 offset:61440
    ds_read_b64_tr_b16 v[114:115], v121 offset:61952
    v_mfma_f32_32x32x16_bf16 v[48:63], v[96:99], v[148:151], v[48:63]
    ds_read_b64_tr_b16 v[96:97], v120 offset:55296
    ds_read_b64_tr_b16 v[98:99], v120 offset:55808
    s_waitcnt lgkmcnt(6)
    v_mfma_f32_32x32x16_bf16 v[0:15], v[100:103], v[152:155], v[0:15]
    ds_read_b64_tr_b16 v[100:101], v121 offset:55296
    ds_read_b64_tr_b16 v[102:103], v121 offset:55808
    v_mfma_f32_32x32x16_bf16 v[16:31], v[104:107], v[152:155], v[16:31]
    ds_read_b64_tr_b16 v[104:105], v120 offset:63488
    ds_read_b64_tr_b16 v[106:107], v120 offset:64000
    s_lshr_b32 s4, s67, 1
    s_lshl_b32 s5, s53, 4
    s_add_u32 s4, s4, s5
    s_lshl_b32 s4, s4, 5
    s_waitcnt lgkmcnt(6)
    v_mfma_f32_32x32x16_bf16 v[32:47], v[108:111], v[152:155], v[32:47]
    ds_read_b64_tr_b16 v[108:109], v121 offset:63488
    ds_read_b64_tr_b16 v[110:111], v121 offset:64000
    v_mfma_f32_32x32x16_bf16 v[48:63], v[112:115], v[152:155], v[48:63]
    s_waitcnt vmcnt(4)
    s_barrier
    v_add_u32 v120, 65536, v120
    v_add_u32 v121, 65536, v121
    ds_read_b64_tr_b16 v[112:113], v120 offset:0
    ds_read_b64_tr_b16 v[114:115], v120 offset:512
    s_waitcnt lgkmcnt(6)
    v_mfma_f32_32x32x16_bf16 v[0:15], v[96:99], v[156:159], v[0:15]
    ds_read_b64_tr_b16 v[96:97], v121 offset:0
    ds_read_b64_tr_b16 v[98:99], v121 offset:512
    v_bfe_u32 v68, v122, 4, 2
    v_mfma_f32_32x32x16_bf16 v[16:31], v[100:103], v[156:159], v[16:31]
    ds_read_b64_tr_b16 v[100:101], v120 offset:8192
    ds_read_b64_tr_b16 v[102:103], v120 offset:8704
    v_add_lshl_u32 v68, v68, s4, 2
    s_waitcnt lgkmcnt(6)
    v_mfma_f32_32x32x16_bf16 v[32:47], v[104:107], v[156:159], v[32:47]
    ds_read_b64_tr_b16 v[104:105], v121 offset:8192
    ds_read_b64_tr_b16 v[106:107], v121 offset:8704
    v_add_u32 v117, 15745024, v68
    v_mfma_f32_32x32x16_bf16 v[48:63], v[108:111], v[156:159], v[48:63]
    ds_read_b64_tr_b16 v[108:109], v120 offset:2048
    ds_read_b64_tr_b16 v[110:111], v120 offset:2560
    v_lshrrev_b32 v69, 7, v122
    s_waitcnt lgkmcnt(6)
    v_mfma_f32_32x32x16_bf16 v[0:15], v[112:115], v[160:163], v[0:15]
    ds_read_b64_tr_b16 v[112:113], v121 offset:2048
    ds_read_b64_tr_b16 v[114:115], v121 offset:2560
    v_bfe_u32 v70, v122, 4, 3
    v_mfma_f32_32x32x16_bf16 v[16:31], v[96:99], v[160:163], v[16:31]
    ds_read_b64_tr_b16 v[96:97], v120 offset:10240
    ds_read_b64_tr_b16 v[98:99], v120 offset:10752
    v_bfe_u32 v71, v122, 8, 1
    s_waitcnt lgkmcnt(6)
    v_mfma_f32_32x32x16_bf16 v[32:47], v[100:103], v[160:163], v[32:47]
    ds_read_b64_tr_b16 v[100:101], v121 offset:10240
    ds_read_b64_tr_b16 v[102:103], v121 offset:10752
    v_lshlrev_b32 v71, 2, v71
    v_mfma_f32_32x32x16_bf16 v[48:63], v[104:107], v[160:163], v[48:63]
    ds_read_b64_tr_b16 v[104:105], v120 offset:4096
    ds_read_b64_tr_b16 v[106:107], v120 offset:4608
    v_xor_b32 v70, v70, v71
    s_waitcnt lgkmcnt(6)
    v_mfma_f32_32x32x16_bf16 v[0:15], v[108:111], v[164:167], v[0:15]
    ds_read_b64_tr_b16 v[108:109], v121 offset:4096
    ds_read_b64_tr_b16 v[110:111], v121 offset:4608
    v_lshlrev_b32 v70, 4, v70
    v_mfma_f32_32x32x16_bf16 v[16:31], v[112:115], v[164:167], v[16:31]
    ds_read_b64_tr_b16 v[112:113], v120 offset:12288
    ds_read_b64_tr_b16 v[114:115], v120 offset:12800
    v_lshl_add_u32 v118, v69, 10, v70
    s_waitcnt lgkmcnt(6)
    v_mfma_f32_32x32x16_bf16 v[32:47], v[96:99], v[164:167], v[32:47]
    ds_read_b64_tr_b16 v[96:97], v121 offset:12288
    ds_read_b64_tr_b16 v[98:99], v121 offset:12800
    v_add_u32 v119, 7168, v118
    v_mfma_f32_32x32x16_bf16 v[48:63], v[100:103], v[164:167], v[48:63]
    ds_read_b64_tr_b16 v[100:101], v120 offset:6144
    ds_read_b64_tr_b16 v[102:103], v120 offset:6656
    v_add_u32 v127, 147456, v122
    s_waitcnt lgkmcnt(6)
    v_mfma_f32_32x32x16_bf16 v[0:15], v[104:107], v[168:171], v[0:15]
    ds_read_b64_tr_b16 v[104:105], v121 offset:6144
    ds_read_b64_tr_b16 v[106:107], v121 offset:6656
    v_mfma_f32_32x32x16_bf16 v[16:31], v[108:111], v[168:171], v[16:31]
    ds_read_b64_tr_b16 v[108:109], v120 offset:14336
    ds_read_b64_tr_b16 v[110:111], v120 offset:14848
    s_waitcnt lgkmcnt(6)
    v_mfma_f32_32x32x16_bf16 v[32:47], v[112:115], v[168:171], v[32:47]
    ds_read_b64_tr_b16 v[112:113], v121 offset:14336
    ds_read_b64_tr_b16 v[114:115], v121 offset:14848
    v_mfma_f32_32x32x16_bf16 v[48:63], v[96:99], v[168:171], v[48:63]
    s_waitcnt vmcnt(0)
    s_barrier
    v_add_u32 v120, 4294901760, v120
    v_add_u32 v121, 4294901760, v121
    ds_read_b64_tr_b16 v[96:97], v120 offset:0
    ds_read_b64_tr_b16 v[98:99], v120 offset:512
    s_waitcnt lgkmcnt(6)
    v_mfma_f32_32x32x16_bf16 v[0:15], v[100:103], v[172:175], v[0:15]
    ds_read_b64_tr_b16 v[100:101], v121 offset:0
    ds_read_b64_tr_b16 v[102:103], v121 offset:512
    v_mfma_f32_32x32x16_bf16 v[16:31], v[104:107], v[172:175], v[16:31]
    ds_read_b64_tr_b16 v[104:105], v120 offset:8192
    ds_read_b64_tr_b16 v[106:107], v120 offset:8704
    s_waitcnt lgkmcnt(6)
    v_mfma_f32_32x32x16_bf16 v[32:47], v[108:111], v[172:175], v[32:47]
    ds_read_b64_tr_b16 v[108:109], v121 offset:8192
    ds_read_b64_tr_b16 v[110:111], v121 offset:8704
    v_mfma_f32_32x32x16_bf16 v[48:63], v[112:115], v[172:175], v[48:63]
    ds_read_b64_tr_b16 v[112:113], v120 offset:2048
    ds_read_b64_tr_b16 v[114:115], v120 offset:2560
    s_waitcnt lgkmcnt(6)
    v_mfma_f32_32x32x16_bf16 v[0:15], v[96:99], v[176:179], v[0:15]
    ds_read_b64_tr_b16 v[96:97], v121 offset:2048
    ds_read_b64_tr_b16 v[98:99], v121 offset:2560
    v_mfma_f32_32x32x16_bf16 v[16:31], v[100:103], v[176:179], v[16:31]
    ds_read_b64_tr_b16 v[100:101], v120 offset:10240
    ds_read_b64_tr_b16 v[102:103], v120 offset:10752
    s_waitcnt lgkmcnt(6)
    v_mfma_f32_32x32x16_bf16 v[32:47], v[104:107], v[176:179], v[32:47]
    ds_read_b64_tr_b16 v[104:105], v121 offset:10240
    ds_read_b64_tr_b16 v[106:107], v121 offset:10752
    v_mfma_f32_32x32x16_bf16 v[48:63], v[108:111], v[176:179], v[48:63]
    ds_read_b64_tr_b16 v[108:109], v120 offset:4096
    ds_read_b64_tr_b16 v[110:111], v120 offset:4608
    s_waitcnt lgkmcnt(6)
    v_mfma_f32_32x32x16_bf16 v[0:15], v[112:115], v[180:183], v[0:15]
    ds_read_b64_tr_b16 v[112:113], v121 offset:4096
    ds_read_b64_tr_b16 v[114:115], v121 offset:4608
    v_mfma_f32_32x32x16_bf16 v[16:31], v[96:99], v[180:183], v[16:31]
    ds_read_b64_tr_b16 v[96:97], v120 offset:12288
    ds_read_b64_tr_b16 v[98:99], v120 offset:12800
    s_waitcnt lgkmcnt(6)
    v_mfma_f32_32x32x16_bf16 v[32:47], v[100:103], v[180:183], v[32:47]
    ds_read_b64_tr_b16 v[100:101], v121 offset:12288
    ds_read_b64_tr_b16 v[102:103], v121 offset:12800
    v_mfma_f32_32x32x16_bf16 v[48:63], v[104:107], v[180:183], v[48:63]
    ds_read_b64_tr_b16 v[104:105], v120 offset:6144
    ds_read_b64_tr_b16 v[106:107], v120 offset:6656
    s_waitcnt lgkmcnt(6)
    v_mfma_f32_32x32x16_bf16 v[0:15], v[108:111], v[184:187], v[0:15]
    ds_read_b64_tr_b16 v[108:109], v121 offset:6144
    ds_read_b64_tr_b16 v[110:111], v121 offset:6656
    v_lshrrev_b32 v84, 4, v122
    v_mfma_f32_32x32x16_bf16 v[16:31], v[112:115], v[184:187], v[16:31]
    ds_read_b64_tr_b16 v[112:113], v120 offset:14336
    ds_read_b64_tr_b16 v[114:115], v120 offset:14848
    s_waitcnt lgkmcnt(6)
    v_mfma_f32_32x32x16_bf16 v[32:47], v[96:99], v[184:187], v[32:47]
    ds_read_b64_tr_b16 v[96:97], v121 offset:14336
    ds_read_b64_tr_b16 v[98:99], v121 offset:14848
    v_lshrrev_b32 v85, 5, v84
    v_mfma_f32_32x32x16_bf16 v[48:63], v[100:103], v[184:187], v[48:63]
    s_barrier
    ds_read_b64_tr_b16 v[100:101], v120 offset:16384
    ds_read_b64_tr_b16 v[102:103], v120 offset:16896
    v_bfe_u32 v86, v84, 2, 2
    s_waitcnt lgkmcnt(6)
    v_mfma_f32_32x32x16_bf16 v[0:15], v[104:107], v[188:191], v[0:15]
    ds_read_b64_tr_b16 v[104:105], v121 offset:16384
    ds_read_b64_tr_b16 v[106:107], v121 offset:16896
    v_lshl_add_u32 v86, v85, 2, v86
    v_mfma_f32_32x32x16_bf16 v[16:31], v[108:111], v[188:191], v[16:31]
    ds_read_b64_tr_b16 v[108:109], v120 offset:24576
    ds_read_b64_tr_b16 v[110:111], v120 offset:25088
    s_waitcnt lgkmcnt(6)
    v_mfma_f32_32x32x16_bf16 v[32:47], v[112:115], v[188:191], v[32:47]
    ds_read_b64_tr_b16 v[112:113], v121 offset:24576
    ds_read_b64_tr_b16 v[114:115], v121 offset:25088
    v_lshlrev_b32 v86, 7, v86
    v_mfma_f32_32x32x16_bf16 v[48:63], v[96:99], v[188:191], v[48:63]
    ds_read_b64_tr_b16 v[96:97], v120 offset:18432
    ds_read_b64_tr_b16 v[98:99], v120 offset:18944
    v_bfe_u32 v87, v84, 4, 1
    s_waitcnt lgkmcnt(6)
    v_mfma_f32_32x32x16_bf16 v[0:15], v[100:103], v[192:195], v[0:15]
    ds_read_b64_tr_b16 v[100:101], v121 offset:18432
    ds_read_b64_tr_b16 v[102:103], v121 offset:18944
    v_lshl_add_u32 v86, v87, 5, v86
    v_mfma_f32_32x32x16_bf16 v[16:31], v[104:107], v[192:195], v[16:31]
    ds_read_b64_tr_b16 v[104:105], v120 offset:26624
    ds_read_b64_tr_b16 v[106:107], v120 offset:27136
    s_waitcnt lgkmcnt(6)
    v_mfma_f32_32x32x16_bf16 v[32:47], v[108:111], v[192:195], v[32:47]
    ds_read_b64_tr_b16 v[108:109], v121 offset:26624
    ds_read_b64_tr_b16 v[110:111], v121 offset:27136
    v_and_b32 v92, 3, v84
    v_mfma_f32_32x32x16_bf16 v[48:63], v[112:115], v[192:195], v[48:63]
    ds_read_b64_tr_b16 v[112:113], v120 offset:20480
    ds_read_b64_tr_b16 v[114:115], v120 offset:20992
    v_lshl_add_u32 v86, v92, 3, v86
    s_waitcnt lgkmcnt(6)
    v_mfma_f32_32x32x16_bf16 v[0:15], v[96:99], v[196:199], v[0:15]
    ds_read_b64_tr_b16 v[96:97], v121 offset:20480
    ds_read_b64_tr_b16 v[98:99], v121 offset:20992
    v_mfma_f32_32x32x16_bf16 v[16:31], v[100:103], v[196:199], v[16:31]
    ds_read_b64_tr_b16 v[100:101], v120 offset:28672
    ds_read_b64_tr_b16 v[102:103], v120 offset:29184
    v_bfe_u32 v92, v84, 3, 1
    s_waitcnt lgkmcnt(6)
    v_mfma_f32_32x32x16_bf16 v[32:47], v[104:107], v[196:199], v[32:47]
    ds_read_b64_tr_b16 v[104:105], v121 offset:28672
    ds_read_b64_tr_b16 v[106:107], v121 offset:29184
    v_lshl_add_u32 v76, v92, 6, v86
    v_mfma_f32_32x32x16_bf16 v[48:63], v[108:111], v[196:199], v[48:63]
    ds_read_b64_tr_b16 v[108:109], v120 offset:22528
    ds_read_b64_tr_b16 v[110:111], v120 offset:23040
    v_add_u32 v76, s69, v76
    s_waitcnt lgkmcnt(6)
    v_mfma_f32_32x32x16_bf16 v[0:15], v[112:115], v[200:203], v[0:15]
    ds_read_b64_tr_b16 v[112:113], v121 offset:22528
    ds_read_b64_tr_b16 v[114:115], v121 offset:23040
    v_mfma_f32_32x32x16_bf16 v[16:31], v[96:99], v[200:203], v[16:31]
    ds_read_b64_tr_b16 v[96:97], v120 offset:30720
    ds_read_b64_tr_b16 v[98:99], v120 offset:31232
    v_xor_b32 v77, 64, v76
    s_waitcnt lgkmcnt(6)
    v_mfma_f32_32x32x16_bf16 v[32:47], v[100:103], v[200:203], v[32:47]
    ds_read_b64_tr_b16 v[100:101], v121 offset:30720
    ds_read_b64_tr_b16 v[102:103], v121 offset:31232
    v_mfma_f32_32x32x16_bf16 v[48:63], v[104:107], v[200:203], v[48:63]
    s_barrier
    ds_read_b64_tr_b16 v[104:105], v120 offset:32768
    ds_read_b64_tr_b16 v[106:107], v120 offset:33280
    s_waitcnt lgkmcnt(6)
    v_mfma_f32_32x32x16_bf16 v[0:15], v[108:111], v[204:207], v[0:15]
    ds_read_b64_tr_b16 v[108:109], v121 offset:32768
    ds_read_b64_tr_b16 v[110:111], v121 offset:33280
    v_mfma_f32_32x32x16_bf16 v[16:31], v[112:115], v[204:207], v[16:31]
    ds_read_b64_tr_b16 v[112:113], v120 offset:40960
    ds_read_b64_tr_b16 v[114:115], v120 offset:41472
    s_waitcnt lgkmcnt(6)
    v_mfma_f32_32x32x16_bf16 v[32:47], v[96:99], v[204:207], v[32:47]
    ds_read_b64_tr_b16 v[96:97], v121 offset:40960
    ds_read_b64_tr_b16 v[98:99], v121 offset:41472
    v_mfma_f32_32x32x16_bf16 v[48:63], v[100:103], v[204:207], v[48:63]
    ds_read_b64_tr_b16 v[100:101], v120 offset:34816
    ds_read_b64_tr_b16 v[102:103], v120 offset:35328
    s_waitcnt lgkmcnt(6)
    v_mfma_f32_32x32x16_bf16 v[0:15], v[104:107], v[208:211], v[0:15]
    ds_read_b64_tr_b16 v[104:105], v121 offset:34816
    ds_read_b64_tr_b16 v[106:107], v121 offset:35328
    v_mfma_f32_32x32x16_bf16 v[16:31], v[108:111], v[208:211], v[16:31]
    ds_read_b64_tr_b16 v[108:109], v120 offset:43008
    ds_read_b64_tr_b16 v[110:111], v120 offset:43520
    s_waitcnt lgkmcnt(6)
    v_mfma_f32_32x32x16_bf16 v[32:47], v[112:115], v[208:211], v[32:47]
    ds_read_b64_tr_b16 v[112:113], v121 offset:43008
    ds_read_b64_tr_b16 v[114:115], v121 offset:43520
    v_mfma_f32_32x32x16_bf16 v[48:63], v[96:99], v[208:211], v[48:63]
    ds_read_b64_tr_b16 v[96:97], v120 offset:36864
    ds_read_b64_tr_b16 v[98:99], v120 offset:37376
    s_waitcnt lgkmcnt(6)
    v_mfma_f32_32x32x16_bf16 v[0:15], v[100:103], v[212:215], v[0:15]
    ds_read_b64_tr_b16 v[100:101], v121 offset:36864
    ds_read_b64_tr_b16 v[102:103], v121 offset:37376
    v_mfma_f32_32x32x16_bf16 v[16:31], v[104:107], v[212:215], v[16:31]
    ds_read_b64_tr_b16 v[104:105], v120 offset:45056
    ds_read_b64_tr_b16 v[106:107], v120 offset:45568
    s_waitcnt lgkmcnt(6)
    v_mfma_f32_32x32x16_bf16 v[32:47], v[108:111], v[212:215], v[32:47]
    ds_read_b64_tr_b16 v[108:109], v121 offset:45056
    ds_read_b64_tr_b16 v[110:111], v121 offset:45568
    v_mfma_f32_32x32x16_bf16 v[48:63], v[112:115], v[212:215], v[48:63]
    ds_read_b64_tr_b16 v[112:113], v120 offset:38912
    ds_read_b64_tr_b16 v[114:115], v120 offset:39424
    s_waitcnt lgkmcnt(6)
    v_mfma_f32_32x32x16_bf16 v[0:15], v[96:99], v[216:219], v[0:15]
    ds_read_b64_tr_b16 v[96:97], v121 offset:38912
    ds_read_b64_tr_b16 v[98:99], v121 offset:39424
    v_mfma_f32_32x32x16_bf16 v[16:31], v[100:103], v[216:219], v[16:31]
    ds_read_b64_tr_b16 v[100:101], v120 offset:47104
    ds_read_b64_tr_b16 v[102:103], v120 offset:47616
    s_waitcnt lgkmcnt(6)
    v_mfma_f32_32x32x16_bf16 v[32:47], v[104:107], v[216:219], v[32:47]
    ds_read_b64_tr_b16 v[104:105], v121 offset:47104
    ds_read_b64_tr_b16 v[106:107], v121 offset:47616
    v_mfma_f32_32x32x16_bf16 v[48:63], v[108:111], v[216:219], v[48:63]
    s_barrier
    ds_read_b64_tr_b16 v[108:109], v120 offset:49152
    ds_read_b64_tr_b16 v[110:111], v120 offset:49664
    s_waitcnt lgkmcnt(6)
    v_mfma_f32_32x32x16_bf16 v[0:15], v[112:115], v[220:223], v[0:15]
    ds_read_b64_tr_b16 v[112:113], v121 offset:49152
    ds_read_b64_tr_b16 v[114:115], v121 offset:49664
    v_mfma_f32_32x32x16_bf16 v[16:31], v[96:99], v[220:223], v[16:31]
    ds_read_b64_tr_b16 v[96:97], v120 offset:57344
    ds_read_b64_tr_b16 v[98:99], v120 offset:57856
    s_waitcnt lgkmcnt(6)
    v_mfma_f32_32x32x16_bf16 v[32:47], v[100:103], v[220:223], v[32:47]
    ds_read_b64_tr_b16 v[100:101], v121 offset:57344
    ds_read_b64_tr_b16 v[102:103], v121 offset:57856
    v_mfma_f32_32x32x16_bf16 v[48:63], v[104:107], v[220:223], v[48:63]
    ds_read_b64_tr_b16 v[104:105], v120 offset:51200
    ds_read_b64_tr_b16 v[106:107], v120 offset:51712
    s_waitcnt lgkmcnt(6)
    v_mfma_f32_32x32x16_bf16 v[0:15], v[108:111], v[224:227], v[0:15]
    ds_read_b64_tr_b16 v[108:109], v121 offset:51200
    ds_read_b64_tr_b16 v[110:111], v121 offset:51712
    v_mov_b32 v123, 156168
    ds_read_b32 v123, v123
    v_mfma_f32_32x32x16_bf16 v[16:31], v[112:115], v[224:227], v[16:31]
    ds_read_b64_tr_b16 v[112:113], v120 offset:59392
    ds_read_b64_tr_b16 v[114:115], v120 offset:59904
    s_waitcnt lgkmcnt(7)
    v_mfma_f32_32x32x16_bf16 v[32:47], v[96:99], v[224:227], v[32:47]
    ds_read_b64_tr_b16 v[96:97], v121 offset:59392
    ds_read_b64_tr_b16 v[98:99], v121 offset:59904
    v_mfma_f32_32x32x16_bf16 v[48:63], v[100:103], v[224:227], v[48:63]
    ds_read_b64_tr_b16 v[100:101], v120 offset:53248
    ds_read_b64_tr_b16 v[102:103], v120 offset:53760
    s_waitcnt lgkmcnt(7)
    v_mfma_f32_32x32x16_bf16 v[0:15], v[104:107], v[228:231], v[0:15]
    ds_read_b64_tr_b16 v[104:105], v121 offset:53248
    ds_read_b64_tr_b16 v[106:107], v121 offset:53760
    v_mfma_f32_32x32x16_bf16 v[16:31], v[108:111], v[228:231], v[16:31]
    ds_read_b64_tr_b16 v[108:109], v120 offset:61440
    ds_read_b64_tr_b16 v[110:111], v120 offset:61952
    s_waitcnt lgkmcnt(6)
    v_mfma_f32_32x32x16_bf16 v[32:47], v[112:115], v[228:231], v[32:47]
    ds_read_b64_tr_b16 v[112:113], v121 offset:61440
    ds_read_b64_tr_b16 v[114:115], v121 offset:61952
    v_mfma_f32_32x32x16_bf16 v[48:63], v[96:99], v[228:231], v[48:63]
    ds_read_b64_tr_b16 v[96:97], v120 offset:55296
    ds_read_b64_tr_b16 v[98:99], v120 offset:55808
    s_waitcnt lgkmcnt(6)
    v_mfma_f32_32x32x16_bf16 v[0:15], v[100:103], v[232:235], v[0:15]
    ds_read_b64_tr_b16 v[100:101], v121 offset:55296
    ds_read_b64_tr_b16 v[102:103], v121 offset:55808
    v_mfma_f32_32x32x16_bf16 v[16:31], v[104:107], v[232:235], v[16:31]
    ds_read_b64_tr_b16 v[104:105], v120 offset:63488
    ds_read_b64_tr_b16 v[106:107], v120 offset:64000
    s_waitcnt lgkmcnt(6)
    v_mfma_f32_32x32x16_bf16 v[32:47], v[108:111], v[232:235], v[32:47]
    ds_read_b64_tr_b16 v[108:109], v121 offset:63488
    ds_read_b64_tr_b16 v[110:111], v121 offset:64000
    v_mfma_f32_32x32x16_bf16 v[48:63], v[112:115], v[232:235], v[48:63]
    v_add_u32 v120, 65536, v120
    v_add_u32 v121, 65536, v121
    ds_read_b64_tr_b16 v[112:113], v120 offset:0
    ds_read_b64_tr_b16 v[114:115], v120 offset:512
    s_waitcnt lgkmcnt(6)
    v_mfma_f32_32x32x16_bf16 v[0:15], v[96:99], v[236:239], v[0:15]
    ds_read_b64_tr_b16 v[96:97], v121 offset:0
    ds_read_b64_tr_b16 v[98:99], v121 offset:512
    v_mfma_f32_32x32x16_bf16 v[16:31], v[100:103], v[236:239], v[16:31]
    ds_read_b64_tr_b16 v[100:101], v120 offset:8192
    ds_read_b64_tr_b16 v[102:103], v120 offset:8704
    s_waitcnt lgkmcnt(6)
    v_mfma_f32_32x32x16_bf16 v[32:47], v[104:107], v[236:239], v[32:47]
    ds_read_b64_tr_b16 v[104:105], v121 offset:8192
    ds_read_b64_tr_b16 v[106:107], v121 offset:8704
    v_readfirstlane_b32 s58, v123
    v_mfma_f32_32x32x16_bf16 v[48:63], v[108:111], v[236:239], v[48:63]
    ds_read_b64_tr_b16 v[108:109], v120 offset:2048
    ds_read_b64_tr_b16 v[110:111], v120 offset:2560
    s_waitcnt lgkmcnt(6)
    v_mfma_f32_32x32x16_bf16 v[0:15], v[112:115], v[240:243], v[0:15]
    ds_read_b64_tr_b16 v[112:113], v121 offset:2048
    ds_read_b64_tr_b16 v[114:115], v121 offset:2560
    s_lshl_b32 s0, s53, 2
    s_add_u32 s0, s0, 156176
    v_mov_b32 v68, s0
    v_mfma_f32_32x32x16_bf16 v[16:31], v[96:99], v[240:243], v[16:31]
    ds_read_b64_tr_b16 v[96:97], v120 offset:10240
    ds_read_b64_tr_b16 v[98:99], v120 offset:10752
    s_waitcnt lgkmcnt(6)
    v_mfma_f32_32x32x16_bf16 v[32:47], v[100:103], v[240:243], v[32:47]
    ds_read_b64_tr_b16 v[100:101], v121 offset:10240
    ds_read_b64_tr_b16 v[102:103], v121 offset:10752
    v_mfma_f32_32x32x16_bf16 v[48:63], v[104:107], v[240:243], v[48:63]
    ds_read_b64_tr_b16 v[104:105], v120 offset:4096
    ds_read_b64_tr_b16 v[106:107], v120 offset:4608
    s_waitcnt lgkmcnt(6)
    v_mfma_f32_32x32x16_bf16 v[0:15], v[108:111], v[244:247], v[0:15]
    ds_read_b64_tr_b16 v[108:109], v121 offset:4096
    ds_read_b64_tr_b16 v[110:111], v121 offset:4608
    v_mfma_f32_32x32x16_bf16 v[16:31], v[112:115], v[244:247], v[16:31]
    ds_read_b64_tr_b16 v[112:113], v120 offset:12288
    ds_read_b64_tr_b16 v[114:115], v120 offset:12800
    s_waitcnt lgkmcnt(6)
    v_mfma_f32_32x32x16_bf16 v[32:47], v[96:99], v[244:247], v[32:47]
    ds_read_b64_tr_b16 v[96:97], v121 offset:12288
    ds_read_b64_tr_b16 v[98:99], v121 offset:12800
    v_mfma_f32_32x32x16_bf16 v[48:63], v[100:103], v[244:247], v[48:63]
    ds_read_b64_tr_b16 v[100:101], v120 offset:6144
    ds_read_b64_tr_b16 v[102:103], v120 offset:6656
    s_waitcnt lgkmcnt(6)
    v_mfma_f32_32x32x16_bf16 v[0:15], v[104:107], v[248:251], v[0:15]
    ds_read_b64_tr_b16 v[104:105], v121 offset:6144
    ds_read_b64_tr_b16 v[106:107], v121 offset:6656
    v_mfma_f32_32x32x16_bf16 v[16:31], v[108:111], v[248:251], v[16:31]
    ds_read_b64_tr_b16 v[108:109], v120 offset:14336
    ds_read_b64_tr_b16 v[110:111], v120 offset:14848
    s_waitcnt lgkmcnt(6)
    v_mfma_f32_32x32x16_bf16 v[32:47], v[112:115], v[248:251], v[32:47]
    ds_read_b64_tr_b16 v[112:113], v121 offset:14336
    ds_read_b64_tr_b16 v[114:115], v121 offset:14848
    v_mfma_f32_32x32x16_bf16 v[48:63], v[96:99], v[248:251], v[48:63]
    s_waitcnt lgkmcnt(4)
    v_mfma_f32_32x32x16_bf16 v[0:15], v[100:103], v[252:255], v[0:15]
    ds_read_b32 v116, v68
    v_mfma_f32_32x32x16_bf16 v[16:31], v[104:107], v[252:255], v[16:31]
    s_waitcnt lgkmcnt(1)
    v_mfma_f32_32x32x16_bf16 v[32:47], v[108:111], v[252:255], v[32:47]
    v_mfma_f32_32x32x16_bf16 v[48:63], v[112:115], v[252:255], v[48:63]
    v_mov_b32 v120, 156160
    v_mov_b32 v121, 1
    s_mov_b64 exec, 1
    ds_add_u32 v120, v121
    s_mov_b64 exec, -1
    s_waitcnt lgkmcnt(0)
    v_cmp_eq_u32 vcc, 0, v116
    s_cbranch_vccz mk_hk_ok
    s_nop 0
    s_mov_b32 s59, 32000
mk_hk:
    ds_read_b32 v116, v68
    s_waitcnt lgkmcnt(0)
    v_cmp_eq_u32 vcc, 0, v116
    s_cbranch_vccz mk_hk_ok
    s_sleep 1
    s_sub_u32 s59, s59, 1
    s_cmp_lg_u32 s59, 0
    s_cbranch_scc1 mk_hk
mk_hk_ok:
    s_add_u32 s1, s71, 0
    buffer_load_dwordx4 v[128:131], v122, s[32:35], s1 offen offset:0 sc1
    buffer_load_dwordx4 v[132:135], v127, s[32:35], s1 offen offset:0 sc1
    buffer_load_dwordx4 v[136:139], v122, s[32:35], s1 offen offset:1024 sc1
    buffer_load_dwordx4 v[140:143], v127, s[32:35], s1 offen offset:1024 sc1
    buffer_load_dwordx4 v[144:147], v122, s[32:35], s1 offen offset:2048 sc1
    buffer_load_dwordx4 v[148:151], v127, s[32:35], s1 offen offset:2048 sc1
    buffer_load_dwordx4 v[152:155], v122, s[32:35], s1 offen offset:3072 sc1
    buffer_load_dwordx4 v[156:159], v127, s[32:35], s1 offen offset:3072 sc1
    v_mul_f32 v0, v125, v0
    v_mul_f32 v1, v125, v1
    v_mul_f32 v2, v125, v2
    v_mul_f32 v3, v125, v3
    v_exp_f32 v0, v0
    v_exp_f32 v1, v1
    v_exp_f32 v2, v2
    v_exp_f32 v3, v3
    v_fma_f32 v0, v0, v124, v124
    v_fma_f32 v1, v1, v124, v124
    v_fma_f32 v2, v2, v124, v124
    v_fma_f32 v3, v3, v124, v124
    v_rcp_f32 v0, v0
    v_rcp_f32 v1, v1
    v_rcp_f32 v2, v2
    v_rcp_f32 v3, v3
    v_mul_f32 v32, v0, v32
    v_mul_f32 v33, v1, v33
    v_mul_f32 v34, v2, v34
    v_mul_f32 v35, v3, v35
    v_mul_f32 v4, v125, v4
    v_mul_f32 v5, v125, v5
    v_mul_f32 v6, v125, v6
    v_mul_f32 v7, v125, v7
    v_exp_f32 v4, v4
    v_exp_f32 v5, v5
    v_exp_f32 v6, v6
    v_exp_f32 v7, v7
    v_fma_f32 v4, v4, v124, v124
    v_fma_f32 v5, v5, v124, v124
    v_fma_f32 v6, v6, v124, v124
    v_fma_f32 v7, v7, v124, v124
    v_rcp_f32 v4, v4
    v_rcp_f32 v5, v5
    v_rcp_f32 v6, v6
    v_rcp_f32 v7, v7
    v_mul_f32 v36, v4, v36
    v_mul_f32 v37, v5, v37
    v_mul_f32 v38, v6, v38
    v_mul_f32 v39, v7, v39
    v_cvt_pk_bf16_f32 v0, v32, v33
    v_cvt_pk_bf16_f32 v1, v34, v35
    v_cvt_pk_bf16_f32 v2, v36, v37
    v_cvt_pk_bf16_f32 v3, v38, v39
    buffer_store_dwordx4 v[0:3], v122, s[32:35], s62 offen offset:0 sc1
    v_mul_f32 v8, v125, v8
    v_mul_f32 v9, v125, v9
    v_mul_f32 v10, v125, v10
    v_mul_f32 v11, v125, v11
    v_exp_f32 v8, v8
    v_exp_f32 v9, v9
    v_exp_f32 v10, v10
    v_exp_f32 v11, v11
    v_fma_f32 v8, v8, v124, v124
    v_fma_f32 v9, v9, v124, v124
    v_fma_f32 v10, v10, v124, v124
    v_fma_f32 v11, v11, v124, v124
    v_rcp_f32 v8, v8
    v_rcp_f32 v9, v9
    v_rcp_f32 v10, v10
    v_rcp_f32 v11, v11
    v_mul_f32 v40, v8, v40
    v_mul_f32 v41, v9, v41
    v_mul_f32 v42, v10, v42
    v_mul_f32 v43, v11, v43
    v_mul_f32 v12, v125, v12
    v_mul_f32 v13, v125, v13
    v_mul_f32 v14, v125, v14
    v_mul_f32 v15, v125, v15
    v_exp_f32 v12, v12
    v_exp_f32 v13, v13
    v_exp_f32 v14, v14
    v_exp_f32 v15, v15
    v_fma_f32 v12, v12, v124, v124
    v_fma_f32 v13, v13, v124, v124
    v_fma_f32 v14, v14, v124, v124
    v_fma_f32 v15, v15, v124, v124
    v_rcp_f32 v12, v12
    v_rcp_f32 v13, v13
    v_rcp_f32 v14, v14
    v_rcp_f32 v15, v15
    v_mul_f32 v44, v12, v44
    v_mul_f32 v45, v13, v45
    v_mul_f32 v46, v14, v46
    v_mul_f32 v47, v15, v47
    v_cvt_pk_bf16_f32 v8, v40, v41
    v_cvt_pk_bf16_f32 v9, v42, v43
    v_cvt_pk_bf16_f32 v10, v44, v45
    v_cvt_pk_bf16_f32 v11, v46, v47
    buffer_store_dwordx4 v[8:11], v122, s[32:35], s62 offen offset:1024 sc1
    v_mul_f32 v16, v125, v16
    v_mul_f32 v17, v125, v17
    v_mul_f32 v18, v125, v18
    v_mul_f32 v19, v125, v19
    v_exp_f32 v16, v16
    v_exp_f32 v17, v17
    v_exp_f32 v18, v18
    v_exp_f32 v19, v19
    v_fma_f32 v16, v16, v124, v124
    v_fma_f32 v17, v17, v124, v124
    v_fma_f32 v18, v18, v124, v124
    v_fma_f32 v19, v19, v124, v124
    v_rcp_f32 v16, v16
    v_rcp_f32 v17, v17
    v_rcp_f32 v18, v18
    v_rcp_f32 v19, v19
    v_mul_f32 v48, v16, v48
    v_mul_f32 v49, v17, v49
    v_mul_f32 v50, v18, v50
    v_mul_f32 v51, v19, v51
    v_mul_f32 v20, v125, v20
    v_mul_f32 v21, v125, v21
    v_mul_f32 v22, v125, v22
    v_mul_f32 v23, v125, v23
    v_exp_f32 v20, v20
    v_exp_f32 v21, v21
    v_exp_f32 v22, v22
    v_exp_f32 v23, v23
    v_fma_f32 v20, v20, v124, v124
    v_fma_f32 v21, v21, v124, v124
    v_fma_f32 v22, v22, v124, v124
    v_fma_f32 v23, v23, v124, v124
    v_rcp_f32 v20, v20
    v_rcp_f32 v21, v21
    v_rcp_f32 v22, v22
    v_rcp_f32 v23, v23
    v_mul_f32 v52, v20, v52
    v_mul_f32 v53, v21, v53
    v_mul_f32 v54, v22, v54
    v_mul_f32 v55, v23, v55
    v_cvt_pk_bf16_f32 v16, v48, v49
    v_cvt_pk_bf16_f32 v17, v50, v51
    v_cvt_pk_bf16_f32 v18, v52, v53
    v_cvt_pk_bf16_f32 v19, v54, v55
    buffer_store_dwordx4 v[16:19], v122, s[32:35], s62 offen offset:2048 sc1
    v_mul_f32 v24, v125, v24
    v_mul_f32 v25, v125, v25
    v_mul_f32 v26, v125, v26
    v_mul_f32 v27, v125, v27
    v_exp_f32 v24, v24
    v_exp_f32 v25, v25
    v_exp_f32 v26, v26
    v_exp_f32 v27, v27
    v_fma_f32 v24, v24, v124, v124
    v_fma_f32 v25, v25, v124, v124
    v_fma_f32 v26, v26, v124, v124
    v_fma_f32 v27, v27, v124, v124
    v_rcp_f32 v24, v24
    v_rcp_f32 v25, v25
    v_rcp_f32 v26, v26
    v_rcp_f32 v27, v27
    v_mul_f32 v56, v24, v56
    v_mul_f32 v57, v25, v57
    v_mul_f32 v58, v26, v58
    v_mul_f32 v59, v27, v59
    v_mul_f32 v28, v125, v28
    v_mul_f32 v29, v125, v29
    v_mul_f32 v30, v125, v30
    v_mul_f32 v31, v125, v31
    v_exp_f32 v28, v28
    v_exp_f32 v29, v29
    v_exp_f32 v30, v30
    v_exp_f32 v31, v31
    v_fma_f32 v28, v28, v124, v124
    v_fma_f32 v29, v29, v124, v124
    v_fma_f32 v30, v30, v124, v124
    v_fma_f32 v31, v31, v124, v124
    v_rcp_f32 v28, v28
    v_rcp_f32 v29, v29
    v_rcp_f32 v30, v30
    v_rcp_f32 v31, v31
    v_mul_f32 v60, v28, v60
    v_mul_f32 v61, v29, v61
    v_mul_f32 v62, v30, v62
    v_mul_f32 v63, v31, v63
    v_cvt_pk_bf16_f32 v24, v56, v57
    v_cvt_pk_bf16_f32 v25, v58, v59
    v_cvt_pk_bf16_f32 v26, v60, v61
    v_cvt_pk_bf16_f32 v27, v62, v63
    buffer_store_dwordx4 v[24:27], v122, s[32:35], s62 offen offset:3072 sc1
    s_setprio 0
    ds_read_b64_tr_b16 v[96:97], v76 offset:0
    ds_read_b64_tr_b16 v[98:99], v76 offset:1024
    ds_read_b64_tr_b16 v[100:101], v77 offset:0
    ds_read_b64_tr_b16 v[102:103], v77 offset:1024
    s_waitcnt vmcnt(10) lgkmcnt(0)
    v_mfma_f32_32x32x16_bf16 v[192:207], v[96:99], v[128:131], 0
    ds_read_b64_tr_b16 v[104:105], v76 offset:2048
    ds_read_b64_tr_b16 v[106:107], v76 offset:3072
    v_mfma_f32_32x32x16_bf16 v[208:223], v[100:103], v[128:131], 0
    ds_read_b64_tr_b16 v[108:109], v77 offset:2048
    ds_read_b64_tr_b16 v[110:111], v77 offset:3072
    v_mfma_f32_32x32x16_bf16 v[224:239], v[96:99], v[132:135], 0
    s_add_u32 m0, s69, 0
    s_add_u32 s0, s70, 131072
    buffer_load_dwordx4 v118, s[36:39], s0 offen lds
    buffer_load_dwordx4 v119, s[36:39], s0 offen offset:1024 lds
    v_mfma_f32_32x32x16_bf16 v[240:255], v[100:103], v[132:135], 0
    s_add_u32 s1, s71, 8192
    buffer_load_dwordx4 v[128:131], v122, s[32:35], s1 offen offset:0 sc1
    buffer_load_dwordx4 v[132:135], v127, s[32:35], s1 offen offset:0 sc1
    s_waitcnt vmcnt(12) lgkmcnt(0)
    v_mfma_f32_32x32x16_bf16 v[192:207], v[104:107], v[136:139], v[192:207]
    ds_read_b64_tr_b16 v[96:97], v76 offset:4096
    ds_read_b64_tr_b16 v[98:99], v76 offset:5120
    v_mfma_f32_32x32x16_bf16 v[208:223], v[108:111], v[136:139], v[208:223]
    ds_read_b64_tr_b16 v[100:101], v77 offset:4096
    ds_read_b64_tr_b16 v[102:103], v77 offset:5120
    v_mfma_f32_32x32x16_bf16 v[224:239], v[104:107], v[140:143], v[224:239]
    s_add_u32 m0, s69, 2048
    s_add_u32 s0, s70, 147456
    buffer_load_dwordx4 v118, s[36:39], s0 offen lds
    buffer_load_dwordx4 v119, s[36:39], s0 offen offset:1024 lds
    v_mfma_f32_32x32x16_bf16 v[240:255], v[108:111], v[140:143], v[240:255]
    buffer_load_dwordx4 v[136:139], v122, s[32:35], s1 offen offset:1024 sc1
    buffer_load_dwordx4 v[140:143], v127, s[32:35], s1 offen offset:1024 sc1
    s_waitcnt vmcnt(8) lgkmcnt(0)
    v_mov_b32 v120, 156172
    v_mov_b32 v121, 1
    s_add_u32 s0, s66, 16384
    s_mov_b64 exec, 1
    ds_add_rtn_u32 v121, v120, v121
    s_waitcnt lgkmcnt(0)
    v_cmp_eq_u32 vcc, 3, v121
    s_cbranch_vccz mk_hnl
    buffer_store_dword v123, off, s[32:35], s0 sc1
mk_hnl:
    s_mov_b64 exec, -1
    s_nop 3
    v_mfma_f32_32x32x16_bf16 v[192:207], v[96:99], v[144:147], v[192:207]
    ds_read_b64_tr_b16 v[104:105], v76 offset:6144
    ds_read_b64_tr_b16 v[106:107], v76 offset:7168
    v_mfma_f32_32x32x16_bf16 v[208:223], v[100:103], v[144:147], v[208:223]
    ds_read_b64_tr_b16 v[108:109], v77 offset:6144
    ds_read_b64_tr_b16 v[110:111], v77 offset:7168
    v_mfma_f32_32x32x16_bf16 v[224:239], v[96:99], v[148:151], v[224:239]
    s_add_u32 m0, s69, 4096
    s_add_u32 s0, s70, 163840
    buffer_load_dwordx4 v118, s[36:39], s0 offen lds
    buffer_load_dwordx4 v119, s[36:39], s0 offen offset:1024 lds
    v_mfma_f32_32x32x16_bf16 v[240:255], v[100:103], v[148:151], v[240:255]
    buffer_load_dwordx4 v[144:147], v122, s[32:35], s1 offen offset:2048 sc1
    buffer_load_dwordx4 v[148:151], v127, s[32:35], s1 offen offset:2048 sc1
    s_waitcnt vmcnt(10) lgkmcnt(0)
    v_mfma_f32_32x32x16_bf16 v[192:207], v[104:107], v[152:155], v[192:207]
    ds_read_b64_tr_b16 v[96:97], v76 offset:0
    ds_read_b64_tr_b16 v[98:99], v76 offset:1024
    v_mfma_f32_32x32x16_bf16 v[208:223], v[108:111], v[152:155], v[208:223]
    ds_read_b64_tr_b16 v[100:101], v77 offset:0
    ds_read_b64_tr_b16 v[102:103], v77 offset:1024
    v_mfma_f32_32x32x16_bf16 v[224:239], v[104:107], v[156:159], v[224:239]
    s_add_u32 m0, s69, 6144
    s_add_u32 s0, s70, 180224
    buffer_load_dwordx4 v118, s[36:39], s0 offen lds
    buffer_load_dwordx4 v119, s[36:39], s0 offen offset:1024 lds
    v_mfma_f32_32x32x16_bf16 v[240:255], v[108:111], v[156:159], v[240:255]
    buffer_load_dwordx4 v[152:155], v122, s[32:35], s1 offen offset:3072 sc1
    buffer_load_dwordx4 v[156:159], v127, s[32:35], s1 offen offset:3072 sc1
    s_waitcnt vmcnt(10) lgkmcnt(0)
    v_mfma_f32_32x32x16_bf16 v[192:207], v[96:99], v[128:131], v[192:207]
    ds_read_b64_tr_b16 v[104:105], v76 offset:2048
    ds_read_b64_tr_b16 v[106:107], v76 offset:3072
    v_mfma_f32_32x32x16_bf16 v[208:223], v[100:103], v[128:131], v[208:223]
    ds_read_b64_tr_b16 v[108:109], v77 offset:2048
    ds_read_b64_tr_b16 v[110:111], v77 offset:3072
    v_mfma_f32_32x32x16_bf16 v[224:239], v[96:99], v[132:135], v[224:239]
    s_add_u32 m0, s69, 0
    s_add_u32 s0, s70, 262144
    buffer_load_dwordx4 v118, s[36:39], s0 offen lds
    buffer_load_dwordx4 v119, s[36:39], s0 offen offset:1024 lds
    v_mfma_f32_32x32x16_bf16 v[240:255], v[100:103], v[132:135], v[240:255]
    s_add_u32 s1, s71, 16384
    buffer_load_dwordx4 v[128:131], v122, s[32:35], s1 offen offset:0 sc1
    buffer_load_dwordx4 v[132:135], v127, s[32:35], s1 offen offset:0 sc1
    s_waitcnt vmcnt(10) lgkmcnt(0)
    v_mfma_f32_32x32x16_bf16 v[192:207], v[104:107], v[136:139], v[192:207]
    ds_read_b64_tr_b16 v[96:97], v76 offset:4096
    ds_read_b64_tr_b16 v[98:99], v76 offset:5120
    v_mfma_f32_32x32x16_bf16 v[208:223], v[108:111], v[136:139], v[208:223]
    ds_read_b64_tr_b16 v[100:101], v77 offset:4096
    ds_read_b64_tr_b16 v[102:103], v77 offset:5120
    v_mfma_f32_32x32x16_bf16 v[224:239], v[104:107], v[140:143], v[224:239]
    s_add_u32 m0, s69, 2048
    s_add_u32 s0, s70, 278528
    buffer_load_dwordx4 v118, s[36:39], s0 offen lds
    buffer_load_dwordx4 v119, s[36:39], s0 offen offset:1024 lds
    v_mfma_f32_32x32x16_bf16 v[240:255], v[108:111], v[140:143], v[240:255]
    buffer_load_dwordx4 v[136:139], v122, s[32:35], s1 offen offset:1024 sc1
    buffer_load_dwordx4 v[140:143], v127, s[32:35], s1 offen offset:1024 sc1
    s_waitcnt vmcnt(10) lgkmcnt(0)
    v_mfma_f32_32x32x16_bf16 v[192:207], v[96:99], v[144:147], v[192:207]
    ds_read_b64_tr_b16 v[104:105], v76 offset:6144
    ds_read_b64_tr_b16 v[106:107], v76 offset:7168
    v_mfma_f32_32x32x16_bf16 v[208:223], v[100:103], v[144:147], v[208:223]
    ds_read_b64_tr_b16 v[108:109], v77 offset:6144
    ds_read_b64_tr_b16 v[110:111], v77 offset:7168
    v_mfma_f32_32x32x16_bf16 v[224:239], v[96:99], v[148:151], v[224:239]
    s_add_u32 m0, s69, 4096
    s_add_u32 s0, s70, 294912
    buffer_load_dwordx4 v118, s[36:39], s0 offen lds
    buffer_load_dwordx4 v119, s[36:39], s0 offen offset:1024 lds
    v_mfma_f32_32x32x16_bf16 v[240:255], v[100:103], v[148:151], v[240:255]
    buffer_load_dwordx4 v[144:147], v122, s[32:35], s1 offen offset:2048 sc1
    buffer_load_dwordx4 v[148:151], v127, s[32:35], s1 offen offset:2048 sc1
    s_waitcnt vmcnt(10) lgkmcnt(0)
    v_mfma_f32_32x32x16_bf16 v[192:207], v[104:107], v[152:155], v[192:207]
    ds_read_b64_tr_b16 v[96:97], v76 offset:0
    ds_read_b64_tr_b16 v[98:99], v76 offset:1024
    v_mfma_f32_32x32x16_bf16 v[208:223], v[108:111], v[152:155], v[208:223]
    ds_read_b64_tr_b16 v[100:101], v77 offset:0
    ds_read_b64_tr_b16 v[102:103], v77 offset:1024
    v_mfma_f32_32x32x16_bf16 v[224:239], v[104:107], v[156:159], v[224:239]
    s_add_u32 m0, s69, 6144
    s_add_u32 s0, s70, 311296
    buffer_load_dwordx4 v118, s[36:39], s0 offen lds
    buffer_load_dwordx4 v119, s[36:39], s0 offen offset:1024 lds
    v_mfma_f32_32x32x16_bf16 v[240:255], v[108:111], v[156:159], v[240:255]
    buffer_load_dwordx4 v[152:155], v122, s[32:35], s1 offen offset:3072 sc1
    buffer_load_dwordx4 v[156:159], v127, s[32:35], s1 offen offset:3072 sc1
    s_waitcnt vmcnt(10) lgkmcnt(0)
    buffer_load_dword v116, v117, s[32:35], 0 offen sc1
    v_mfma_f32_32x32x16_bf16 v[192:207], v[96:99], v[128:131], v[192:207]
    ds_read_b64_tr_b16 v[104:105], v76 offset:2048
    ds_read_b64_tr_b16 v[106:107], v76 offset:3072
    v_mfma_f32_32x32x16_bf16 v[208:223], v[100:103], v[128:131], v[208:223]
    ds_read_b64_tr_b16 v[108:109], v77 offset:2048
    ds_read_b64_tr_b16 v[110:111], v77 offset:3072
    v_mfma_f32_32x32x16_bf16 v[224:239], v[96:99], v[132:135], v[224:239]
    s_add_u32 m0, s69, 0
    s_add_u32 s0, s70, 65536
    buffer_load_dwordx4 v118, s[36:39], s0 offen lds
    buffer_load_dwordx4 v119, s[36:39], s0 offen offset:1024 lds
    v_mfma_f32_32x32x16_bf16 v[240:255], v[100:103], v[132:135], v[240:255]
    s_waitcnt vmcnt(9) lgkmcnt(0)
    v_mfma_f32_32x32x16_bf16 v[192:207], v[104:107], v[136:139], v[192:207]
    ds_read_b64_tr_b16 v[96:97], v76 offset:4096
    ds_read_b64_tr_b16 v[98:99], v76 offset:5120
    v_mfma_f32_32x32x16_bf16 v[208:223], v[108:111], v[136:139], v[208:223]
    ds_read_b64_tr_b16 v[100:101], v77 offset:4096
    ds_read_b64_tr_b16 v[102:103], v77 offset:5120
    v_mfma_f32_32x32x16_bf16 v[224:239], v[104:107], v[140:143], v[224:239]
    s_add_u32 m0, s69, 2048
    s_add_u32 s0, s70, 81920
    buffer_load_dwordx4 v118, s[36:39], s0 offen lds
    buffer_load_dwordx4 v119, s[36:39], s0 offen offset:1024 lds
    v_mfma_f32_32x32x16_bf16 v[240:255], v[108:111], v[140:143], v[240:255]
    s_waitcnt vmcnt(4)
    v_cmp_ne_u32 vcc, s58, v116
    s_cbranch_vccz mk_h2_ok
    s_mov_b32 s59, 4000
mk_h2s_loop:
    buffer_load_dword v116, v117, s[32:35], 0 offen sc1
    s_waitcnt vmcnt(0)
    v_cmp_ne_u32 vcc, s58, v116
    s_cbranch_vccz mk_h2s_ok
    s_sleep 8
    s_sub_u32 s59, s59, 1
    s_cmp_lg_u32 s59, 0
    s_cbranch_scc1 mk_h2s_loop
mk_h2s_ok:
mk_h2_ok:
    s_add_u32 s1, s71, 4096
    buffer_load_dwordx4 v[128:131], v122, s[32:35], s1 offen offset:0 sc1
    buffer_load_dwordx4 v[132:135], v127, s[32:35], s1 offen offset:0 sc1
    buffer_load_dwordx4 v[136:139], v122, s[32:35], s1 offen offset:1024 sc1
    buffer_load_dwordx4 v[140:143], v127, s[32:35], s1 offen offset:1024 sc1
    s_waitcnt vmcnt(11) lgkmcnt(0)
    v_mfma_f32_32x32x16_bf16 v[192:207], v[96:99], v[144:147], v[192:207]
    ds_read_b64_tr_b16 v[104:105], v76 offset:6144
    ds_read_b64_tr_b16 v[106:107], v76 offset:7168
    v_mfma_f32_32x32x16_bf16 v[208:223], v[100:103], v[144:147], v[208:223]
    ds_read_b64_tr_b16 v[108:109], v77 offset:6144
    ds_read_b64_tr_b16 v[110:111], v77 offset:7168
    v_mfma_f32_32x32x16_bf16 v[224:239], v[96:99], v[148:151], v[224:239]
    s_add_u32 m0, s69, 4096
    s_add_u32 s0, s70, 98304
    buffer_load_dwordx4 v118, s[36:39], s0 offen lds
    buffer_load_dwordx4 v119, s[36:39], s0 offen offset:1024 lds
    v_mfma_f32_32x32x16_bf16 v[240:255], v[100:103], v[148:151], v[240:255]
    buffer_load_dwordx4 v[144:147], v122, s[32:35], s1 offen offset:2048 sc1
    buffer_load_dwordx4 v[148:151], v127, s[32:35], s1 offen offset:2048 sc1
    s_waitcnt vmcnt(10) lgkmcnt(0)
    v_mfma_f32_32x32x16_bf16 v[192:207], v[104:107], v[152:155], v[192:207]
    ds_read_b64_tr_b16 v[96:97], v76 offset:0
    ds_read_b64_tr_b16 v[98:99], v76 offset:1024
    v_mfma_f32_32x32x16_bf16 v[208:223], v[108:111], v[152:155], v[208:223]
    ds_read_b64_tr_b16 v[100:101], v77 offset:0
    ds_read_b64_tr_b16 v[102:103], v77 offset:1024
    v_mfma_f32_32x32x16_bf16 v[224:239], v[104:107], v[156:159], v[224:239]
    s_add_u32 m0, s69, 6144
    s_add_u32 s0, s70, 114688
    buffer_load_dwordx4 v118, s[36:39], s0 offen lds
    buffer_load_dwordx4 v119, s[36:39], s0 offen offset:1024 lds
    v_mfma_f32_32x32x16_bf16 v[240:255], v[108:111], v[156:159], v[240:255]
    buffer_load_dwordx4 v[152:155], v122, s[32:35], s1 offen offset:3072 sc1
    buffer_load_dwordx4 v[156:159], v127, s[32:35], s1 offen offset:3072 sc1
    s_waitcnt vmcnt(10) lgkmcnt(0)
    v_mfma_f32_32x32x16_bf16 v[192:207], v[96:99], v[128:131], v[192:207]
    ds_read_b64_tr_b16 v[104:105], v76 offset:2048
    ds_read_b64_tr_b16 v[106:107], v76 offset:3072
    v_mfma_f32_32x32x16_bf16 v[208:223], v[100:103], v[128:131], v[208:223]
    ds_read_b64_tr_b16 v[108:109], v77 offset:2048
    ds_read_b64_tr_b16 v[110:111], v77 offset:3072
    v_mfma_f32_32x32x16_bf16 v[224:239], v[96:99], v[132:135], v[224:239]
    s_add_u32 m0, s69, 0
    s_add_u32 s0, s70, 196608
    buffer_load_dwordx4 v118, s[36:39], s0 offen lds
    buffer_load_dwordx4 v119, s[36:39], s0 offen offset:1024 lds
    v_mfma_f32_32x32x16_bf16 v[240:255], v[100:103], v[132:135], v[240:255]
    s_add_u32 s1, s71, 12288
    buffer_load_dwordx4 v[128:131], v122, s[32:35], s1 offen offset:0 sc1
    buffer_load_dwordx4 v[132:135], v127, s[32:35], s1 offen offset:0 sc1
    s_waitcnt vmcnt(10) lgkmcnt(0)
    v_mfma_f32_32x32x16_bf16 v[192:207], v[104:107], v[136:139], v[192:207]
    ds_read_b64_tr_b16 v[96:97], v76 offset:4096
    ds_read_b64_tr_b16 v[98:99], v76 offset:5120
    v_mfma_f32_32x32x16_bf16 v[208:223], v[108:111], v[136:139], v[208:223]
    ds_read_b64_tr_b16 v[100:101], v77 offset:4096
    ds_read_b64_tr_b16 v[102:103], v77 offset:5120
    v_mfma_f32_32x32x16_bf16 v[224:239], v[104:107], v[140:143], v[224:239]
    s_add_u32 m0, s69, 2048
    s_add_u32 s0, s70, 212992
    buffer_load_dwordx4 v118, s[36:39], s0 offen lds
    buffer_load_dwordx4 v119, s[36:39], s0 offen offset:1024 lds
    v_mfma_f32_32x32x16_bf16 v[240:255], v[108:111], v[140:143], v[240:255]
    buffer_load_dwordx4 v[136:139], v122, s[32:35], s1 offen offset:1024 sc1
    buffer_load_dwordx4 v[140:143], v127, s[32:35], s1 offen offset:1024 sc1
    s_waitcnt vmcnt(10) lgkmcnt(0)
    v_lshrrev_b32 v0, 7, v122
    s_lshl_b32 s4, s52, 3
    v_add_u32 v0, s4, v0
    v_bfe_u32 v1, v122, 4, 3
    v_lshrrev_b32 v2, 5, v0
    v_lshl_add_u32 v2, v2, 3, v1
    v_cmp_gt_u32 vcc, 7, v2
    v_mul_u32_u24 v2, 1088, v2
    v_and_b32 v3, 31, v0
    v_lshl_add_u32 v2, v3, 4, v2
    s_lshl_b32 s5, s67, 6
    v_add_u32 v0, s5, v0
    v_lshlrev_b32 v0, 10, v0
    v_lshl_add_u32 v0, v1, 4, v0
    s_bfe_u32 s5, s2, 0x30003
    s_lshl_b32 s5, s5, 7
    v_add_u32 v0, s5, v0
    buffer_load_dwordx4 v[8:11], v0, s[8:11], 0 offen
    v_add_u32 v1, 90112, v2
    v_add_u32 v3, 25152, v2
    v_cndmask_b32 v4, v3, v2, vcc
    v_mov_b32 v2, 9792
    v_mov_b32 v3, 8192
    v_cndmask_b32 v2, v2, v3, vcc
    v_add_u32 v5, v4, v2
    v_add_u32 v6, v5, v2
    v_add_u32 v7, v6, v2
    v_mov_b32 v12, 156160
    s_mov_b32 s59, 32000
mk_cs:
    ds_read_b32 v13, v12
    s_waitcnt lgkmcnt(0)
    v_cmp_ne_u32 vcc, 4, v13
    s_cbranch_vccz mk_cs_ok
    s_sleep 1
    s_sub_u32 s59, s59, 1
    s_cmp_lg_u32 s59, 0
    s_cbranch_scc1 mk_cs
mk_cs_ok:
    v_add_u32 v12, s69, v122
    s_mul_i32 s4, s53, 9792
    s_add_u32 s4, s4, 32768
    v_add_u32 v13, s4, v122
    v_mfma_f32_32x32x16_bf16 v[192:207], v[96:99], v[144:147], v[192:207]
    ds_read_b64_tr_b16 v[104:105], v76 offset:6144
    ds_read_b64_tr_b16 v[106:107], v76 offset:7168
    v_mfma_f32_32x32x16_bf16 v[208:223], v[100:103], v[144:147], v[208:223]
    ds_read_b64_tr_b16 v[108:109], v77 offset:6144
    ds_read_b64_tr_b16 v[110:111], v77 offset:7168
    v_mfma_f32_32x32x16_bf16 v[224:239], v[96:99], v[148:151], v[224:239]
    s_add_u32 m0, s69, 4096
    s_add_u32 s0, s70, 229376
    buffer_load_dwordx4 v118, s[36:39], s0 offen lds
    buffer_load_dwordx4 v119, s[36:39], s0 offen offset:1024 lds
    v_mfma_f32_32x32x16_bf16 v[240:255], v[100:103], v[148:151], v[240:255]
    buffer_load_dwordx4 v[144:147], v122, s[32:35], s1 offen offset:2048 sc1
    buffer_load_dwordx4 v[148:151], v127, s[32:35], s1 offen offset:2048 sc1
    s_waitcnt vmcnt(11) lgkmcnt(0)
    v_mfma_f32_32x32x16_bf16 v[192:207], v[104:107], v[152:155], v[192:207]
    ds_read_b64_tr_b16 v[96:97], v76 offset:0
    ds_read_b64_tr_b16 v[98:99], v76 offset:1024
    v_mfma_f32_32x32x16_bf16 v[208:223], v[108:111], v[152:155], v[208:223]
    ds_read_b64_tr_b16 v[100:101], v77 offset:0
    ds_read_b64_tr_b16 v[102:103], v77 offset:1024
    v_mfma_f32_32x32x16_bf16 v[224:239], v[104:107], v[156:159], v[224:239]
    s_add_u32 m0, s69, 6144
    s_add_u32 s0, s70, 245760
    buffer_load_dwordx4 v118, s[36:39], s0 offen lds
    buffer_load_dwordx4 v119, s[36:39], s0 offen offset:1024 lds
    v_mfma_f32_32x32x16_bf16 v[240:255], v[108:111], v[156:159], v[240:255]
    buffer_load_dwordx4 v[152:155], v122, s[32:35], s1 offen offset:3072 sc1
    buffer_load_dwordx4 v[156:159], v127, s[32:35], s1 offen offset:3072 sc1
    s_waitcnt vmcnt(11) lgkmcnt(0)
    v_mfma_f32_32x32x16_bf16 v[192:207], v[96:99], v[128:131], v[192:207]
    ds_read_b64_tr_b16 v[104:105], v76 offset:2048
    ds_read_b64_tr_b16 v[106:107], v76 offset:3072
    v_mfma_f32_32x32x16_bf16 v[208:223], v[100:103], v[128:131], v[208:223]
    ds_read_b64_tr_b16 v[108:109], v77 offset:2048
    ds_read_b64_tr_b16 v[110:111], v77 offset:3072
    v_mfma_f32_32x32x16_bf16 v[224:239], v[96:99], v[132:135], v[224:239]
    s_add_u32 m0, s69, 0
    s_add_u32 s0, s70, 327680
    buffer_load_dwordx4 v118, s[36:39], s0 offen lds
    buffer_load_dwordx4 v119, s[36:39], s0 offen offset:1024 lds
    v_mfma_f32_32x32x16_bf16 v[240:255], v[100:103], v[132:135], v[240:255]
    s_add_u32 s1, s71, 20480
    buffer_load_dwordx4 v[128:131], v122, s[32:35], s1 offen offset:0 sc1
    buffer_load_dwordx4 v[132:135], v127, s[32:35], s1 offen offset:0 sc1
    s_waitcnt vmcnt(10) lgkmcnt(0)
    v_mfma_f32_32x32x16_bf16 v[192:207], v[104:107], v[136:139], v[192:207]
    ds_read_b64_tr_b16 v[96:97], v76 offset:4096
    ds_read_b64_tr_b16 v[98:99], v76 offset:5120
    v_mfma_f32_32x32x16_bf16 v[208:223], v[108:111], v[136:139], v[208:223]
    ds_read_b64_tr_b16 v[100:101], v77 offset:4096
    ds_read_b64_tr_b16 v[102:103], v77 offset:5120
    v_mfma_f32_32x32x16_bf16 v[224:239], v[104:107], v[140:143], v[224:239]
    s_add_u32 m0, s69, 2048
    s_add_u32 s0, s70, 344064
    buffer_load_dwordx4 v118, s[36:39], s0 offen lds
    buffer_load_dwordx4 v119, s[36:39], s0 offen offset:1024 lds
    v_mfma_f32_32x32x16_bf16 v[240:255], v[108:111], v[140:143], v[240:255]
    buffer_load_dwordx4 v[136:139], v122, s[32:35], s1 offen offset:1024 sc1
    buffer_load_dwordx4 v[140:143], v127, s[32:35], s1 offen offset:1024 sc1
    s_waitcnt vmcnt(10) lgkmcnt(0)
    v_mfma_f32_32x32x16_bf16 v[192:207], v[96:99], v[144:147], v[192:207]
    ds_read_b64_tr_b16 v[104:105], v76 offset:6144
    ds_read_b64_tr_b16 v[106:107], v76 offset:7168
    v_mfma_f32_32x32x16_bf16 v[208:223], v[100:103], v[144:147], v[208:223]
    ds_read_b64_tr_b16 v[108:109], v77 offset:6144
    ds_read_b64_tr_b16 v[110:111], v77 offset:7168
    v_mfma_f32_32x32x16_bf16 v[224:239], v[96:99], v[148:151], v[224:239]
    s_add_u32 m0, s69, 4096
    s_add_u32 s0, s70, 360448
    buffer_load_dwordx4 v118, s[36:39], s0 offen lds
    buffer_load_dwordx4 v119, s[36:39], s0 offen offset:1024 lds
    v_mfma_f32_32x32x16_bf16 v[240:255], v[100:103], v[148:151], v[240:255]
    buffer_load_dwordx4 v[144:147], v122, s[32:35], s1 offen offset:2048 sc1
    buffer_load_dwordx4 v[148:151], v127, s[32:35], s1 offen offset:2048 sc1
    s_waitcnt vmcnt(10) lgkmcnt(0)
    v_mfma_f32_32x32x16_bf16 v[192:207], v[104:107], v[152:155], v[192:207]
    ds_read_b64_tr_b16 v[96:97], v76 offset:0
    ds_read_b64_tr_b16 v[98:99], v76 offset:1024
    v_mfma_f32_32x32x16_bf16 v[208:223], v[108:111], v[152:155], v[208:223]
    ds_read_b64_tr_b16 v[100:101], v77 offset:0
    ds_read_b64_tr_b16 v[102:103], v77 offset:1024
    v_mfma_f32_32x32x16_bf16 v[224:239], v[104:107], v[156:159], v[224:239]
    s_add_u32 m0, s69, 6144
    s_add_u32 s0, s70, 376832
    buffer_load_dwordx4 v118, s[36:39], s0 offen lds
    buffer_load_dwordx4 v119, s[36:39], s0 offen offset:1024 lds
    v_mfma_f32_32x32x16_bf16 v[240:255], v[108:111], v[156:159], v[240:255]
    buffer_load_dwordx4 v[152:155], v122, s[32:35], s1 offen offset:3072 sc1
    buffer_load_dwordx4 v[156:159], v127, s[32:35], s1 offen offset:3072 sc1
    s_waitcnt vmcnt(10) lgkmcnt(0)
    v_mfma_f32_32x32x16_bf16 v[192:207], v[96:99], v[128:131], v[192:207]
    ds_read_b64_tr_b16 v[104:105], v76 offset:2048
    ds_read_b64_tr_b16 v[106:107], v76 offset:3072
    v_mfma_f32_32x32x16_bf16 v[208:223], v[100:103], v[128:131], v[208:223]
    ds_read_b64_tr_b16 v[108:109], v77 offset:2048
    ds_read_b64_tr_b16 v[110:111], v77 offset:3072
    v_mfma_f32_32x32x16_bf16 v[224:239], v[96:99], v[132:135], v[224:239]
    s_add_u32 m0, s69, 0
    s_add_u32 s0, s70, 393216
    buffer_load_dwordx4 v118, s[36:39], s0 offen lds
    buffer_load_dwordx4 v119, s[36:39], s0 offen offset:1024 lds
    v_mfma_f32_32x32x16_bf16 v[240:255], v[100:103], v[132:135], v[240:255]
    s_add_u32 s1, s71, 24576
    buffer_load_dwordx4 v[128:131], v122, s[32:35], s1 offen offset:0 sc1
    buffer_load_dwordx4 v[132:135], v127, s[32:35], s1 offen offset:0 sc1
    s_waitcnt vmcnt(10) lgkmcnt(0)
    s_lshl_b32 s4, s53, 2
    s_add_u32 s4, s4, 156192
    v_mov_b32 v120, s4
    v_mov_b32 v121, 1
    ds_write_b32 v120, v121
    v_mfma_f32_32x32x16_bf16 v[192:207], v[104:107], v[136:139], v[192:207]
    ds_read_b64_tr_b16 v[96:97], v76 offset:4096
    ds_read_b64_tr_b16 v[98:99], v76 offset:5120
    v_mfma_f32_32x32x16_bf16 v[208:223], v[108:111], v[136:139], v[208:223]
    ds_read_b64_tr_b16 v[100:101], v77 offset:4096
    ds_read_b64_tr_b16 v[102:103], v77 offset:5120
    v_mfma_f32_32x32x16_bf16 v[224:239], v[104:107], v[140:143], v[224:239]
    s_add_u32 m0, s69, 2048
    s_add_u32 s0, s70, 409600
    buffer_load_dwordx4 v118, s[36:39], s0 offen lds
    buffer_load_dwordx4 v119, s[36:39], s0 offen offset:1024 lds
    v_mfma_f32_32x32x16_bf16 v[240:255], v[108:111], v[140:143], v[240:255]
    buffer_load_dwordx4 v[136:139], v122, s[32:35], s1 offen offset:1024 sc1
    buffer_load_dwordx4 v[140:143], v127, s[32:35], s1 offen offset:1024 sc1
    s_waitcnt vmcnt(10) lgkmcnt(0)
    v_mfma_f32_32x32x16_bf16 v[192:207], v[96:99], v[144:147], v[192:207]
    ds_read_b64_tr_b16 v[104:105], v76 offset:6144
    ds_read_b64_tr_b16 v[106:107], v76 offset:7168
    v_mfma_f32_32x32x16_bf16 v[208:223], v[100:103], v[144:147], v[208:223]
    ds_read_b64_tr_b16 v[108:109], v77 offset:6144
    ds_read_b64_tr_b16 v[110:111], v77 offset:7168
    v_mfma_f32_32x32x16_bf16 v[224:239], v[96:99], v[148:151], v[224:239]
    s_add_u32 m0, s69, 4096
    s_add_u32 s0, s70, 425984
    buffer_load_dwordx4 v118, s[36:39], s0 offen lds
    buffer_load_dwordx4 v119, s[36:39], s0 offen offset:1024 lds
    v_mfma_f32_32x32x16_bf16 v[240:255], v[100:103], v[148:151], v[240:255]
    buffer_load_dwordx4 v[144:147], v122, s[32:35], s1 offen offset:2048 sc1
    buffer_load_dwordx4 v[148:151], v127, s[32:35], s1 offen offset:2048 sc1
    s_waitcnt vmcnt(10) lgkmcnt(0)
    v_mfma_f32_32x32x16_bf16 v[192:207], v[104:107], v[152:155], v[192:207]
    ds_read_b64_tr_b16 v[96:97], v76 offset:0
    ds_read_b64_tr_b16 v[98:99], v76 offset:1024
    v_mfma_f32_32x32x16_bf16 v[208:223], v[108:111], v[152:155], v[208:223]
    ds_read_b64_tr_b16 v[100:101], v77 offset:0
    ds_read_b64_tr_b16 v[102:103], v77 offset:1024
    v_mfma_f32_32x32x16_bf16 v[224:239], v[104:107], v[156:159], v[224:239]
    s_add_u32 m0, s69, 6144
    s_add_u32 s0, s70, 442368
    buffer_load_dwordx4 v118, s[36:39], s0 offen lds
    buffer_load_dwordx4 v119, s[36:39], s0 offen offset:1024 lds
    v_mfma_f32_32x32x16_bf16 v[240:255], v[108:111], v[156:159], v[240:255]
    buffer_load_dwordx4 v[152:155], v122, s[32:35], s1 offen offset:3072 sc1
    buffer_load_dwordx4 v[156:159], v127, s[32:35], s1 offen offset:3072 sc1
    s_waitcnt vmcnt(10) lgkmcnt(0)
    s_lshl_b32 s4, s53, 2
    s_add_u32 s4, s4, 156192
    v_mov_b32 v120, s4
    v_mov_b32 v121, 2
    ds_write_b32 v120, v121
    v_mfma_f32_32x32x16_bf16 v[192:207], v[96:99], v[128:131], v[192:207]
    ds_read_b64_tr_b16 v[104:105], v76 offset:2048
    ds_read_b64_tr_b16 v[106:107], v76 offset:3072
    v_mfma_f32_32x32x16_bf16 v[208:223], v[100:103], v[128:131], v[208:223]
    ds_read_b64_tr_b16 v[108:109], v77 offset:2048
    ds_read_b64_tr_b16 v[110:111], v77 offset:3072
    v_mfma_f32_32x32x16_bf16 v[224:239], v[96:99], v[132:135], v[224:239]
    v_mfma_f32_32x32x16_bf16 v[240:255], v[100:103], v[132:135], v[240:255]
    s_waitcnt vmcnt(6) lgkmcnt(0)
    v_mfma_f32_32x32x16_bf16 v[192:207], v[104:107], v[136:139], v[192:207]
    ds_read_b64_tr_b16 v[96:97], v76 offset:4096
    ds_read_b64_tr_b16 v[98:99], v76 offset:5120
    v_mfma_f32_32x32x16_bf16 v[208:223], v[108:111], v[136:139], v[208:223]
    ds_read_b64_tr_b16 v[100:101], v77 offset:4096
    ds_read_b64_tr_b16 v[102:103], v77 offset:5120
    v_mfma_f32_32x32x16_bf16 v[224:239], v[104:107], v[140:143], v[224:239]
    v_mfma_f32_32x32x16_bf16 v[240:255], v[108:111], v[140:143], v[240:255]
    s_waitcnt vmcnt(2) lgkmcnt(0)
    v_mfma_f32_32x32x16_bf16 v[192:207], v[96:99], v[144:147], v[192:207]
    ds_read_b64_tr_b16 v[104:105], v76 offset:6144
    ds_read_b64_tr_b16 v[106:107], v76 offset:7168
    v_mfma_f32_32x32x16_bf16 v[208:223], v[100:103], v[144:147], v[208:223]
    ds_read_b64_tr_b16 v[108:109], v77 offset:6144
    ds_read_b64_tr_b16 v[110:111], v77 offset:7168
    v_mfma_f32_32x32x16_bf16 v[224:239], v[96:99], v[148:151], v[224:239]
    v_mfma_f32_32x32x16_bf16 v[240:255], v[100:103], v[148:151], v[240:255]
    s_waitcnt vmcnt(0) lgkmcnt(0)
    v_mfma_f32_32x32x16_bf16 v[192:207], v[104:107], v[152:155], v[192:207]
    v_mfma_f32_32x32x16_bf16 v[208:223], v[108:111], v[152:155], v[208:223]
    v_mfma_f32_32x32x16_bf16 v[224:239], v[104:107], v[156:159], v[224:239]
    v_mfma_f32_32x32x16_bf16 v[240:255], v[108:111], v[156:159], v[240:255]
    s_nop 8
    ds_write_b128 v12, v[192:195] offset:0
    ds_write_b128 v12, v[196:199] offset:1088
    ds_write_b128 v12, v[200:203] offset:2176
    ds_write_b128 v12, v[204:207] offset:3264
    ds_write_b128 v12, v[208:211] offset:4352
    ds_write_b128 v12, v[212:215] offset:5440
    ds_write_b128 v12, v[216:219] offset:6528
    ds_write_b128 v13, v[220:223] offset:0
    ds_write_b128 v13, v[224:227] offset:1088
    ds_write_b128 v13, v[228:231] offset:2176
    ds_write_b128 v13, v[232:235] offset:3264
    ds_write_b128 v13, v[236:239] offset:4352
    ds_write_b128 v13, v[240:243] offset:5440
    ds_write_b128 v13, v[244:247] offset:6528
    ds_write_b128 v13, v[248:251] offset:7616
    ds_write_b128 v13, v[252:255] offset:8704
    s_waitcnt lgkmcnt(0)
    s_barrier
    ds_read_b128 v[128:131], v4 offset:0
    ds_read_b128 v[132:135], v4 offset:512
    ds_read_b128 v[136:139], v5 offset:0
    ds_read_b128 v[140:143], v5 offset:512
    ds_read_b128 v[144:147], v6 offset:0
    ds_read_b128 v[148:151], v6 offset:512
    ds_read_b128 v[152:155], v7 offset:0
    ds_read_b128 v[156:159], v7 offset:512
    ds_read_b128 v[160:163], v1 offset:0
    ds_read_b128 v[164:167], v1 offset:512
    ds_read_b128 v[168:171], v1 offset:32768
    ds_read_b128 v[172:175], v1 offset:33280
    s_waitcnt lgkmcnt(8)
    v_pk_add_f32 v[128:129], v[128:129], v[136:137]
    v_pk_add_f32 v[130:131], v[130:131], v[138:139]
    v_pk_add_f32 v[132:133], v[132:133], v[140:141]
    v_pk_add_f32 v[134:135], v[134:135], v[142:143]
    s_waitcnt lgkmcnt(4)
    v_pk_add_f32 v[144:145], v[144:145], v[152:153]
    v_pk_add_f32 v[146:147], v[146:147], v[154:155]
    v_pk_add_f32 v[148:149], v[148:149], v[156:157]
    v_pk_add_f32 v[150:151], v[150:151], v[158:159]
    v_pk_add_f32 v[128:129], v[128:129], v[144:145]
    v_pk_add_f32 v[130:131], v[130:131], v[146:147]
    v_pk_add_f32 v[132:133], v[132:133], v[148:149]
    v_pk_add_f32 v[134:135], v[134:135], v[150:151]
    v_mul_f32 v136, 0xbfb8aa3b, v128
    v_mul_f32 v137, 0xbfb8aa3b, v129
    v_mul_f32 v138, 0xbfb8aa3b, v130
    v_mul_f32 v139, 0xbfb8aa3b, v131
    v_mul_f32 v140, 0xbfb8aa3b, v132
    v_mul_f32 v141, 0xbfb8aa3b, v133
    v_mul_f32 v142, 0xbfb8aa3b, v134
    v_mul_f32 v143, 0xbfb8aa3b, v135
    v_exp_f32 v136, v136
    v_exp_f32 v137, v137
    v_exp_f32 v138, v138
    v_exp_f32 v139, v139
    v_exp_f32 v140, v140
    v_exp_f32 v141, v141
    v_exp_f32 v142, v142
    v_exp_f32 v143, v143
    s_waitcnt vmcnt(0) lgkmcnt(0)
    v_pk_add_f32 v[160:161], v[160:161], v[168:169]
    v_pk_add_f32 v[162:163], v[162:163], v[170:171]
    v_pk_add_f32 v[164:165], v[164:165], v[172:173]
    v_pk_add_f32 v[166:167], v[166:167], v[174:175]
    v_add_f32 v136, 1.0, v136
    v_add_f32 v137, 1.0, v137
    v_add_f32 v138, 1.0, v138
    v_add_f32 v139, 1.0, v139
    v_add_f32 v140, 1.0, v140
    v_add_f32 v141, 1.0, v141
    v_add_f32 v142, 1.0, v142
    v_add_f32 v143, 1.0, v143
    v_rcp_f32 v136, v136
    v_rcp_f32 v137, v137
    v_rcp_f32 v138, v138
    v_rcp_f32 v139, v139
    v_rcp_f32 v140, v140
    v_rcp_f32 v141, v141
    v_rcp_f32 v142, v142
    v_rcp_f32 v143, v143
    v_mul_f32 v128, v128, v160
    v_mul_f32 v129, v129, v161
    v_mul_f32 v130, v130, v162
    v_mul_f32 v131, v131, v163
    v_mul_f32 v132, v132, v164
    v_mul_f32 v133, v133, v165
    v_mul_f32 v134, v134, v166
    v_mul_f32 v135, v135, v167
    v_lshlrev_b32 v144, 16, v8
    v_and_b32 v145, 0xffff0000, v8
    v_lshlrev_b32 v146, 16, v9
    v_and_b32 v147, 0xffff0000, v9
    v_lshlrev_b32 v148, 16, v10
    v_and_b32 v149, 0xffff0000, v10
    v_lshlrev_b32 v150, 16, v11
    v_and_b32 v151, 0xffff0000, v11
    v_fma_f32 v128, v128, v136, v144
    v_fma_f32 v129, v129, v137, v145
    v_fma_f32 v130, v130, v138, v146
    v_fma_f32 v131, v131, v139, v147
    v_fma_f32 v132, v132, v140, v148
    v_fma_f32 v133, v133, v141, v149
    v_fma_f32 v134, v134, v142, v150
    v_fma_f32 v135, v135, v143, v151
    v_cvt_pk_bf16_f32 v136, v128, v129
    v_cvt_pk_bf16_f32 v137, v130, v131
    v_cvt_pk_bf16_f32 v138, v132, v133
    v_cvt_pk_bf16_f32 v139, v134, v135
    buffer_store_dwordx4 v[136:139], v0, s[44:47], 0 offen
mk_end:
    s_endpgm
mk_B1:
    s_waitcnt vmcnt(8)
    s_barrier
    s_add_u32 m0, s60, 49152
    s_add_u32 s69, s57, 3
    s_and_b32 s69, s69, 7
    s_lshl_b32 s0, s69, 7
    s_add_u32 s0, s0, s61
    buffer_load_dwordx4 v104, s[8:11], s0 offen lds
    buffer_load_dwordx4 v105, s[8:11], s0 offen offset:1024 lds
    s_add_u32 m0, s60, 57344
    s_add_u32 s0, s0, 65536
    buffer_load_dwordx4 v104, s[8:11], s0 offen lds
    buffer_load_dwordx4 v105, s[8:11], s0 offen offset:1024 lds
    s_mov_b32 s12, s6
    s_mov_b32 s13, s7
    s_mov_b32 s14, 1572864
    s_mov_b32 s15, 0x20000
    s_mov_b32 s18, 1835008
    s_mov_b32 s19, 0x20000
    s_mov_b32 s22, 1835008
    s_mov_b32 s23, 0x20000
    s_mov_b32 s42, 524288
    s_mov_b32 s43, 0x20000
    s_mov_b32 s44, s38
    s_mov_b32 s45, s39
    s_mov_b32 s46, 2097152
    s_mov_b32 s47, 0x20000
    s_mov_b32 s38, 1835008
    s_mov_b32 s39, 0x20000
    s_mov_b32 s32, s50
    s_mov_b32 s33, s51
    s_mov_b32 s34, 15761664
    s_mov_b32 s35, 0x20000
    s_mov_b32 s50, 256
    s_mov_b32 s51, 0x20000
    s_waitcnt vmcnt(8)
    s_barrier
    s_add_u32 m0, s60, 65536
    s_add_u32 s69, s57, 4
    s_and_b32 s69, s69, 7
    s_lshl_b32 s0, s69, 7
    s_add_u32 s0, s0, s61
    buffer_load_dwordx4 v104, s[8:11], s0 offen lds
    buffer_load_dwordx4 v105, s[8:11], s0 offen offset:1024 lds
    s_add_u32 m0, s60, 73728
    s_add_u32 s0, s0, 65536
    buffer_load_dwordx4 v104, s[8:11], s0 offen lds
    buffer_load_dwordx4 v105, s[8:11], s0 offen offset:1024 lds
    s_cmp_eq_u32 s55, 3
    s_cselect_b32 s24, s12, s16
    s_cselect_b32 s25, s13, s17
    s_cselect_b32 s26, s14, s18
    s_mov_b32 s27, 0x20000
    s_cselect_b32 s28, s12, s20
    s_cselect_b32 s29, s13, s21
    s_mov_b32 s30, s26
    s_mov_b32 s31, 0x20000
    s_movk_i32 s4, 3584
    s_cselect_b32 s4, 3072, s4
    s_cselect_b32 s6, 128, 0
    s_lshl_b32 s68, s4, 6
    v_and_b32 v10, 1, v5
    v_lshlrev_b32 v10, 2, v10
    v_xor_b32 v10, v4, v10
    v_lshlrev_b32 v10, 4, v10
    s_lshl_b32 s7, s53, 4
    v_add_u32 v11, s7, v3
    v_mul_lo_u32 v106, v11, s4
    v_add_u32 v106, v106, v10
    s_lshl_b32 s5, s4, 3
    s_sub_u32 s5, s5, 1024
    v_add_u32 v107, s5, v106
    s_mul_i32 s5, s54, 7
    s_lshl_b32 s7, s55, 1
    s_add_u32 s62, s5, s7
    s_lshl_b32 s62, s62, 7
    s_add_u32 s7, s7, 1
    s_min_u32 s7, s7, 6
    s_add_u32 s65, s5, s7
    s_lshl_b32 s65, s65, 7
    s_lshl_b32 s5, s54, 8
    s_add_u32 s7, s5, 2048
    s_cmp_eq_u32 s55, 3
    s_cselect_b32 s62, s7, s62
    s_add_u32 s63, s62, s6
    s_waitcnt vmcnt(8)
    s_barrier
    s_add_u32 m0, s60, 81920
    s_add_u32 s69, s57, 5
    s_and_b32 s69, s69, 7
    s_lshl_b32 s0, s69, 7
    s_add_u32 s0, s0, s61
    buffer_load_dwordx4 v104, s[8:11], s0 offen lds
    buffer_load_dwordx4 v105, s[8:11], s0 offen offset:1024 lds
    s_add_u32 m0, s60, 90112
    s_add_u32 s0, s0, 65536
    buffer_load_dwordx4 v104, s[8:11], s0 offen lds
    buffer_load_dwordx4 v105, s[8:11], s0 offen offset:1024 lds
    s_lshr_b32 s7, s55, 1
    s_lshl_b32 s7, s7, 10
    s_add_u32 s64, s5, s7
    s_and_b32 s7, s55, 1
    s_lshl_b32 s7, s7, 7
    s_add_u32 s64, s64, s7
    v_mul_u32_u24 v108, 3072, v11
    v_add_u32 v108, v108, v10
    v_add_u32 v109, 23552, v108
    v_mul_u32_u24 v110, 3584, v11
    v_add_u32 v110, v110, v10
    v_add_u32 v111, 27648, v110
    v_lshl_add_u32 v112, v11, 10, v10
    v_add_u32 v113, 7168, v112
    s_bfe_u32 s73, s2, 0x30003
    s_lshl_b32 s73, s73, 7
    v_lshlrev_b32 v122, 4, v2
    s_lshr_b32 s71, s2, 3
    s_lshl_b32 s71, s71, 2
    s_add_u32 s71, s71, s53
    s_lshl_b32 s71, s71, 11
    v_lshlrev_b32 v15, 6, v2
    s_lshl_b32 s66, s54, 4
    s_add_u32 s66, s66, s56
    s_lshl_b32 s66, s66, 5
    s_add_u32 s66, s66, s55
    s_lshl_b32 s66, s66, 2
    s_add_u32 s66, s66, 15728640
    s_waitcnt vmcnt(8)
    s_barrier
    s_add_u32 m0, s60, 98304
    s_add_u32 s69, s57, 6
    s_and_b32 s69, s69, 7
    s_lshl_b32 s0, s69, 7
    s_add_u32 s0, s0, s61
    buffer_load_dwordx4 v104, s[8:11], s0 offen lds
    buffer_load_dwordx4 v105, s[8:11], s0 offen offset:1024 lds
    s_add_u32 m0, s60, 106496
    s_add_u32 s0, s0, 65536
    buffer_load_dwordx4 v104, s[8:11], s0 offen lds
    buffer_load_dwordx4 v105, s[8:11], s0 offen offset:1024 lds
    s_waitcnt vmcnt(8)
    s_barrier
    s_add_u32 m0, s60, 114688
    s_add_u32 s69, s57, 7
    s_and_b32 s69, s69, 7
    s_lshl_b32 s0, s69, 7
    s_add_u32 s0, s0, s61
    buffer_load_dwordx4 v104, s[8:11], s0 offen lds
    buffer_load_dwordx4 v105, s[8:11], s0 offen offset:1024 lds
    s_add_u32 m0, s60, 122880
    s_add_u32 s0, s0, 65536
    buffer_load_dwordx4 v104, s[8:11], s0 offen lds
    buffer_load_dwordx4 v105, s[8:11], s0 offen offset:1024 lds
    s_waitcnt vmcnt(8)
    s_barrier
    s_add_u32 m0, s60, 131072
    s_add_u32 s69, s57, 0
    s_and_b32 s69, s69, 7
    s_mul_i32 s0, s69, s68
    s_add_u32 s0, s0, s62
    buffer_load_dwordx4 v106, s[24:27], s0 offen lds
    buffer_load_dwordx4 v107, s[24:27], s0 offen offset:1024 lds
    s_add_u32 m0, s60, 139264
    s_add_u32 s69, s57, 0
    s_and_b32 s69, s69, 7
    s_mul_i32 s0, s69, s68
    s_add_u32 s0, s0, s63
    buffer_load_dwordx4 v106, s[28:31], s0 offen lds
    buffer_load_dwordx4 v107, s[28:31], s0 offen offset:1024 lds
    s_waitcnt vmcnt(8)
    s_barrier
    s_add_u32 m0, s60, 0
    s_add_u32 s69, s57, 1
    s_and_b32 s69, s69, 7
    s_mul_i32 s0, s69, s68
    s_add_u32 s0, s0, s62
    buffer_load_dwordx4 v106, s[24:27], s0 offen lds
    buffer_load_dwordx4 v107, s[24:27], s0 offen offset:1024 lds
    s_add_u32 m0, s60, 8192
    s_add_u32 s69, s57, 1
    s_and_b32 s69, s69, 7
    s_mul_i32 s0, s69, s68
    s_add_u32 s0, s0, s63
    buffer_load_dwordx4 v106, s[28:31], s0 offen lds
    buffer_load_dwordx4 v107, s[28:31], s0 offen offset:1024 lds
    s_add_u32 m0, s60, 49152
    s_add_u32 s69, s57, 2
    s_and_b32 s69, s69, 7
    s_mul_i32 s0, s69, s68
    s_add_u32 s0, s0, s62
    buffer_load_dwordx4 v106, s[24:27], s0 offen lds
    buffer_load_dwordx4 v107, s[24:27], s0 offen offset:1024 lds
    s_add_u32 m0, s60, 57344
    s_add_u32 s69, s57, 2
    s_and_b32 s69, s69, 7
    s_mul_i32 s0, s69, s68
    s_add_u32 s0, s0, s63
    buffer_load_dwordx4 v106, s[28:31], s0 offen lds
    buffer_load_dwordx4 v107, s[28:31], s0 offen offset:1024 lds
    s_waitcnt vmcnt(12)
    s_barrier
    s_add_u32 m0, s60, 65536
    s_add_u32 s69, s57, 3
    s_and_b32 s69, s69, 7
    s_mul_i32 s0, s69, s68
    s_add_u32 s0, s0, s62
    buffer_load_dwordx4 v106, s[24:27], s0 offen lds
    buffer_load_dwordx4 v107, s[24:27], s0 offen offset:1024 lds
    s_add_u32 m0, s60, 73728
    s_add_u32 s69, s57, 3
    s_and_b32 s69, s69, 7
    s_mul_i32 s0, s69, s68
    s_add_u32 s0, s0, s63
    buffer_load_dwordx4 v106, s[28:31], s0 offen lds
    buffer_load_dwordx4 v107, s[28:31], s0 offen offset:1024 lds
    s_add_u32 m0, s60, 81920
    s_add_u32 s69, s57, 4
    s_and_b32 s69, s69, 7
    s_mul_i32 s0, s69, s68
    s_add_u32 s0, s0, s62
    buffer_load_dwordx4 v106, s[24:27], s0 offen lds
    buffer_load_dwordx4 v107, s[24:27], s0 offen offset:1024 lds
    s_add_u32 m0, s60, 90112
    s_add_u32 s69, s57, 4
    s_and_b32 s69, s69, 7
    s_mul_i32 s0, s69, s68
    s_add_u32 s0, s0, s63
    buffer_load_dwordx4 v106, s[28:31], s0 offen lds
    buffer_load_dwordx4 v107, s[28:31], s0 offen offset:1024 lds
    s_cmp_lg_u32 s2, 0
    s_cbranch_scc1 mk_nolead7
    s_cmp_lg_u32 s53, 0
    s_cbranch_scc1 mk_nolead7
    s_mov_b32 s1, 15761408
    buffer_load_dword v114, off, s[32:35], s1 sc1
mk_nolead7:
    s_waitcnt vmcnt(16)
    s_barrier
    s_add_u32 m0, s60, 98304
    s_add_u32 s69, s57, 5
    s_and_b32 s69, s69, 7
    s_mul_i32 s0, s69, s68
    s_add_u32 s0, s0, s62
    buffer_load_dwordx4 v106, s[24:27], s0 offen lds
    buffer_load_dwordx4 v107, s[24:27], s0 offen offset:1024 lds
    s_add_u32 m0, s60, 106496
    s_add_u32 s69, s57, 5
    s_and_b32 s69, s69, 7
    s_mul_i32 s0, s69, s68
    s_add_u32 s0, s0, s63
    buffer_load_dwordx4 v106, s[28:31], s0 offen lds
    buffer_load_dwordx4 v107, s[28:31], s0 offen offset:1024 lds
    s_setprio 0
    s_waitcnt vmcnt(16)
    s_barrier
    s_add_u32 m0, s60, 16384
    s_add_u32 s69, s57, 6
    s_and_b32 s69, s69, 7
    s_mul_i32 s0, s69, s68
    s_add_u32 s0, s0, s62
    buffer_load_dwordx4 v106, s[24:27], s0 offen lds
    buffer_load_dwordx4 v107, s[24:27], s0 offen offset:1024 lds
    s_add_u32 m0, s60, 24576
    s_add_u32 s69, s57, 6
    s_and_b32 s69, s69, 7
    s_mul_i32 s0, s69, s68
    s_add_u32 s0, s0, s63
    buffer_load_dwordx4 v106, s[28:31], s0 offen lds
    buffer_load_dwordx4 v107, s[28:31], s0 offen offset:1024 lds
    s_lshl_b32 s4, s2, 2
    s_add_u32 s4, s4, s53
    s_mul_i32 s0, s4, 1536
    s_mov_b64 exec, 16777215
    buffer_load_dword v14, v15, s[12:15], s0 offen
    s_mul_i32 s0, s4, 1792
    s_mov_b64 exec, 268435455
    buffer_load_dword v14, v15, s[16:19], s0 offen
    s_mul_i32 s0, s4, 1792
    s_mov_b64 exec, 268435455
    buffer_load_dword v14, v15, s[20:23], s0 offen
    s_mul_i32 s0, s4, 1792
    s_mov_b64 exec, 268435455
    buffer_load_dword v14, v15, s[36:39], s0 offen
    s_mul_i32 s0, s4, 512
    s_mov_b64 exec, 255
    buffer_load_dword v14, v15, s[40:43], s0 offen
    s_mov_b64 exec, -1
    s_waitcnt vmcnt(21)
    s_barrier
    s_add_u32 m0, s60, 32768
    s_add_u32 s69, s57, 7
    s_and_b32 s69, s69, 7
    s_mul_i32 s0, s69, s68
    s_add_u32 s0, s0, s62
    buffer_load_dwordx4 v106, s[24:27], s0 offen lds
    buffer_load_dwordx4 v107, s[24:27], s0 offen offset:1024 lds
    s_add_u32 m0, s60, 40960
    s_add_u32 s69, s57, 7
    s_and_b32 s69, s69, 7
    s_mul_i32 s0, s69, s68
    s_add_u32 s0, s0, s63
    buffer_load_dwordx4 v106, s[28:31], s0 offen lds
    buffer_load_dwordx4 v107, s[28:31], s0 offen offset:1024 lds
    s_cmp_lg_u32 s2, 0
    s_cbranch_scc1 mk_nolead10
    s_cmp_lg_u32 s53, 0
    s_cbranch_scc1 mk_nolead10
    s_mov_b32 s1, 15761408
    s_waitcnt vmcnt(17)
    v_add_u32 v114, 1, v114
    v_or_b32 v114, 0x80000000, v114
    s_mov_b64 exec, 1
    buffer_store_dword v114, off, s[48:51], 0 sc1
    buffer_store_dword v114, off, s[32:35], s1 sc1
    s_mov_b64 exec, -1
mk_nolead10:
    s_waitcnt vmcnt(21)
    s_barrier
    s_waitcnt vmcnt(17)
    s_barrier
    s_add_u32 m0, s60, 49152
    s_add_u32 s69, s57, 0
    s_and_b32 s69, s69, 7
    s_mul_i32 s0, s69, 196608
    s_add_u32 s0, s0, s64
    buffer_load_dwordx4 v108, s[12:15], s0 offen lds
    buffer_load_dwordx4 v109, s[12:15], s0 offen offset:1024 lds
    s_add_u32 m0, s60, 57344
    s_add_u32 s69, s57, 1
    s_and_b32 s69, s69, 7
    s_mul_i32 s0, s69, 196608
    s_add_u32 s0, s0, s64
    buffer_load_dwordx4 v108, s[12:15], s0 offen lds
    buffer_load_dwordx4 v109, s[12:15], s0 offen offset:1024 lds
    s_add_u32 m0, s60, 147456
    s_add_u32 s0, s73, 458752
    buffer_load_dwordx4 v112, s[40:43], s0 offen lds
    buffer_load_dwordx4 v113, s[40:43], s0 offen offset:1024 lds
    s_add_u32 m0, s60, 114688
    s_add_u32 s0, s73, 196608
    buffer_load_dwordx4 v112, s[40:43], s0 offen lds
    buffer_load_dwordx4 v113, s[40:43], s0 offen offset:1024 lds
    s_waitcnt vmcnt(21)
    s_barrier
    s_add_u32 m0, s60, 65536
    s_add_u32 s69, s57, 2
    s_and_b32 s69, s69, 7
    s_mul_i32 s0, s69, 196608
    s_add_u32 s0, s0, s64
    buffer_load_dwordx4 v108, s[12:15], s0 offen lds
    buffer_load_dwordx4 v109, s[12:15], s0 offen offset:1024 lds
    s_add_u32 m0, s60, 73728
    s_add_u32 s69, s57, 3
    s_and_b32 s69, s69, 7
    s_mul_i32 s0, s69, 196608
    s_add_u32 s0, s0, s64
    buffer_load_dwordx4 v108, s[12:15], s0 offen lds
    buffer_load_dwordx4 v109, s[12:15], s0 offen offset:1024 lds
    s_add_u32 m0, s60, 122880
    s_add_u32 s0, s73, 262144
    buffer_load_dwordx4 v112, s[40:43], s0 offen lds
    buffer_load_dwordx4 v113, s[40:43], s0 offen offset:1024 lds
    s_add_u32 m0, s60, 131072
    s_add_u32 s0, s73, 327680
    buffer_load_dwordx4 v112, s[40:43], s0 offen lds
    buffer_load_dwordx4 v113, s[40:43], s0 offen offset:1024 lds
    s_waitcnt vmcnt(25)
    s_barrier
    s_add_u32 m0, s60, 0
    s_add_u32 s69, s57, 4
    s_and_b32 s69, s69, 7
    s_mul_i32 s0, s69, 196608
    s_add_u32 s0, s0, s64
    buffer_load_dwordx4 v108, s[12:15], s0 offen lds
    buffer_load_dwordx4 v109, s[12:15], s0 offen offset:1024 lds
    s_add_u32 m0, s60, 8192
    s_add_u32 s69, s57, 5
    s_and_b32 s69, s69, 7
    s_mul_i32 s0, s69, 196608
    s_add_u32 s0, s0, s64
    buffer_load_dwordx4 v108, s[12:15], s0 offen lds
    buffer_load_dwordx4 v109, s[12:15], s0 offen offset:1024 lds
    s_add_u32 m0, s60, 139264
    s_add_u32 s0, s73, 393216
    buffer_load_dwordx4 v112, s[40:43], s0 offen lds
    buffer_load_dwordx4 v113, s[40:43], s0 offen offset:1024 lds
    s_add_u32 m0, s60, 90112
    s_add_u32 s0, s73, 0
    buffer_load_dwordx4 v112, s[40:43], s0 offen lds
    buffer_load_dwordx4 v113, s[40:43], s0 offen offset:1024 lds
    s_waitcnt vmcnt(24)
    s_barrier
    s_add_u32 m0, s60, 98304
    s_add_u32 s0, s73, 65536
    buffer_load_dwordx4 v112, s[40:43], s0 offen lds
    buffer_load_dwordx4 v113, s[40:43], s0 offen offset:1024 lds
    s_add_u32 m0, s60, 106496
    s_add_u32 s0, s73, 131072
    buffer_load_dwordx4 v112, s[40:43], s0 offen lds
    buffer_load_dwordx4 v113, s[40:43], s0 offen offset:1024 lds
    buffer_load_dword v115, off, s[48:51], 0 sc1
    s_waitcnt vmcnt(25)
    s_barrier
    s_add_u32 m0, s60, 16384
    s_add_u32 s69, s57, 6
    s_and_b32 s69, s69, 7
    s_mul_i32 s0, s69, 196608
    s_add_u32 s0, s0, s64
    buffer_load_dwordx4 v108, s[12:15], s0 offen lds
    buffer_load_dwordx4 v109, s[12:15], s0 offen offset:1024 lds
    s_add_u32 m0, s60, 24576
    s_add_u32 s69, s57, 7
    s_and_b32 s69, s69, 7
    s_mul_i32 s0, s69, 196608
    s_add_u32 s0, s0, s64
    buffer_load_dwordx4 v108, s[12:15], s0 offen lds
    buffer_load_dwordx4 v109, s[12:15], s0 offen offset:1024 lds
    s_waitcnt vmcnt(21)
    s_barrier
    s_add_u32 m0, s60, 32768
    s_add_u32 s69, s57, 0
    s_and_b32 s69, s69, 7
    s_mul_i32 s0, s69, 229376
    s_add_u32 s0, s0, s65
    buffer_load_dwordx4 v110, s[16:19], s0 offen lds
    buffer_load_dwordx4 v111, s[16:19], s0 offen offset:1024 lds
    s_add_u32 m0, s60, 40960
    s_add_u32 s69, s57, 0
    s_and_b32 s69, s69, 7
    s_mul_i32 s0, s69, 229376
    s_add_u32 s0, s0, s65
    buffer_load_dwordx4 v110, s[20:23], s0 offen lds
    buffer_load_dwordx4 v111, s[20:23], s0 offen offset:1024 lds
    s_waitcnt vmcnt(17)
    s_barrier
    s_add_u32 m0, s60, 49152
    s_add_u32 s69, s57, 1
    s_and_b32 s69, s69, 7
    s_mul_i32 s0, s69, 229376
    s_add_u32 s0, s0, s65
    buffer_load_dwordx4 v110, s[16:19], s0 offen lds
    buffer_load_dwordx4 v111, s[16:19], s0 offen offset:1024 lds
    s_add_u32 m0, s60, 57344
    s_add_u32 s69, s57, 1
    s_and_b32 s69, s69, 7
    s_mul_i32 s0, s69, 229376
    s_add_u32 s0, s0, s65
    buffer_load_dwordx4 v110, s[20:23], s0 offen lds
    buffer_load_dwordx4 v111, s[20:23], s0 offen offset:1024 lds
    s_waitcnt vmcnt(8)
    s_barrier
    s_add_u32 m0, s60, 65536
    s_add_u32 s69, s57, 2
    s_and_b32 s69, s69, 7
    s_mul_i32 s0, s69, 229376
    s_add_u32 s0, s0, s65
    buffer_load_dwordx4 v110, s[16:19], s0 offen lds
    buffer_load_dwordx4 v111, s[16:19], s0 offen offset:1024 lds
    s_add_u32 m0, s60, 73728
    s_add_u32 s69, s57, 2
    s_and_b32 s69, s69, 7
    s_mul_i32 s0, s69, 229376
    s_add_u32 s0, s0, s65
    buffer_load_dwordx4 v110, s[20:23], s0 offen lds
    buffer_load_dwordx4 v111, s[20:23], s0 offen offset:1024 lds
    s_lshl_b32 s67, s56, 1
    s_lshr_b32 s4, s55, 1
    s_add_u32 s67, s67, s4
    s_lshl_b32 s5, s54, 3
    s_and_b32 s4, s55, 1
    s_lshl_b32 s4, s4, 2
    s_add_u32 s70, s5, s4
    s_add_u32 s70, s70, s53
    s_lshl_b32 s4, s67, 1
    s_sub_i32 s72, 8, s4
    s_max_i32 s72, s72, 0
    v_bfe_u32 v20, v2, 2, 2
    v_min_u32 v20, 2, v20
    v_sub_u32 v20, s56, v20
    v_max_i32 v20, 0, v20
    s_lshl_b32 s4, s54, 4
    v_add_u32 v20, s4, v20
    v_and_b32 v21, 3, v2
    v_lshl_add_u32 v20, v20, 5, v21
    v_lshlrev_b32 v20, 2, v20
    v_add_u32 v116, 15728640, v20
    v_or_b32 v119, 12, v20
    v_add_u32 v119, 15736832, v119
    s_lshl_b32 s5, s70, 16
    v_add_u32 v98, s5, v122
    v_add_u32 v99, 2097152, v98
    v_lshrrev_b32 v20, 5, v2
    v_and_b32 v21, 15, v2
    v_lshl_add_u32 v21, v20, 4, v21
    v_bfe_u32 v22, v2, 4, 1
    v_lshl_add_u32 v21, v22, 5, v21
    s_add_u32 s5, s5, 4194304
    v_lshl_add_u32 v127, v21, 4, s5
    v_and_b32 v21, 31, v2
    v_lshlrev_b32 v20, 2, v20
    v_sub_u32 v23, v21, v20
    v_mov_b32 v96, 0xff800000
    s_and_b32 s4, s2, 7
    s_lshl_b32 s4, s4, 1
    s_lshr_b32 s5, s2, 7
    s_add_u32 s4, s4, s5
    s_lshl_b32 s5, s53, 4
    s_add_u32 s4, s4, s5
    s_lshl_b32 s4, s4, 5
    v_and_b32 v20, 3, v2
    v_add_lshl_u32 v20, v20, s4, 2
    v_add_u32 v117, 15736832, v20
    v_cmp_eq_u32 vcc, 0, v115
    s_cbranch_vccz mk_EB_ok
    s_mov_b32 s59, 4000
mk_EBs_loop:
    buffer_load_dword v115, off, s[48:51], 0 sc1
    s_waitcnt vmcnt(0)
    v_cmp_eq_u32 vcc, 0, v115
    s_cbranch_vccz mk_EBs_ok
    s_sleep 8
    s_sub_u32 s59, s59, 1
    s_cmp_lg_u32 s59, 0
    s_cbranch_scc1 mk_EBs_loop
mk_EBs_ok:
mk_EB_ok:
    v_readfirstlane_b32 s58, v115
    v_mov_b32 v20, 156168
    ds_write_b32 v20, v115
    s_waitcnt lgkmcnt(0)
    s_waitcnt vmcnt(8)
    s_barrier
    s_add_u32 m0, s60, 0
    s_add_u32 s69, s57, 3
    s_and_b32 s69, s69, 7
    s_mul_i32 s0, s69, 229376
    s_add_u32 s0, s0, s65
    buffer_load_dwordx4 v110, s[16:19], s0 offen lds
    buffer_load_dwordx4 v111, s[16:19], s0 offen offset:1024 lds
    s_add_u32 m0, s60, 8192
    s_add_u32 s69, s57, 3
    s_and_b32 s69, s69, 7
    s_mul_i32 s0, s69, 229376
    s_add_u32 s0, s0, s65
    buffer_load_dwordx4 v110, s[20:23], s0 offen lds
    buffer_load_dwordx4 v111, s[20:23], s0 offen offset:1024 lds
    v_cmp_le_i32 vcc, 0, v23
    s_nop 1
    v_cndmask_b32_e64 v48, v96, 0, vcc
    v_cndmask_b32 v64, 0, v96, vcc
    v_cmp_le_i32 vcc, 1, v23
    s_nop 1
    v_cndmask_b32_e64 v49, v96, 0, vcc
    v_cndmask_b32 v65, 0, v96, vcc
    v_cmp_le_i32 vcc, 2, v23
    s_nop 1
    v_cndmask_b32_e64 v50, v96, 0, vcc
    v_cndmask_b32 v66, 0, v96, vcc
    v_cmp_le_i32 vcc, 3, v23
    s_nop 1
    v_cndmask_b32_e64 v51, v96, 0, vcc
    v_cndmask_b32 v67, 0, v96, vcc
    v_cmp_le_i32 vcc, 8, v23
    s_nop 1
    v_cndmask_b32_e64 v52, v96, 0, vcc
    v_cndmask_b32 v68, 0, v96, vcc
    v_cmp_le_i32 vcc, 9, v23
    s_nop 1
    v_cndmask_b32_e64 v53, v96, 0, vcc
    v_cndmask_b32 v69, 0, v96, vcc
    v_cmp_le_i32 vcc, 10, v23
    s_nop 1
    v_cndmask_b32_e64 v54, v96, 0, vcc
    v_cndmask_b32 v70, 0, v96, vcc
    v_cmp_le_i32 vcc, 11, v23
    s_nop 1
    v_cndmask_b32_e64 v55, v96, 0, vcc
    v_cndmask_b32 v71, 0, v96, vcc
    v_cmp_le_i32 vcc, 16, v23
    s_nop 1
    v_cndmask_b32_e64 v56, v96, 0, vcc
    v_cndmask_b32 v72, 0, v96, vcc
    v_cmp_le_i32 vcc, 17, v23
    s_nop 1
    v_cndmask_b32_e64 v57, v96, 0, vcc
    v_cndmask_b32 v73, 0, v96, vcc
    v_cmp_le_i32 vcc, 18, v23
    s_nop 1
    v_cndmask_b32_e64 v58, v96, 0, vcc
    v_cndmask_b32 v74, 0, v96, vcc
    v_cmp_le_i32 vcc, 19, v23
    s_nop 1
    v_cndmask_b32_e64 v59, v96, 0, vcc
    v_cndmask_b32 v75, 0, v96, vcc
    v_cmp_le_i32 vcc, 24, v23
    s_nop 1
    v_cndmask_b32_e64 v60, v96, 0, vcc
    v_cndmask_b32 v76, 0, v96, vcc
    v_cmp_le_i32 vcc, 25, v23
    s_nop 1
    v_cndmask_b32_e64 v61, v96, 0, vcc
    v_cndmask_b32 v77, 0, v96, vcc
    v_cmp_le_i32 vcc, 26, v23
    s_nop 1
    v_cndmask_b32_e64 v62, v96, 0, vcc
    v_cndmask_b32 v78, 0, v96, vcc
    v_cmp_le_i32 vcc, 27, v23
    s_nop 1
    v_cndmask_b32_e64 v63, v96, 0, vcc
    v_cndmask_b32 v79, 0, v96, vcc
    s_waitcnt vmcnt(8)
    s_barrier
    s_add_u32 m0, s60, 16384
    s_add_u32 s69, s57, 4
    s_and_b32 s69, s69, 7
    s_mul_i32 s0, s69, 229376
    s_add_u32 s0, s0, s65
    buffer_load_dwordx4 v110, s[16:19], s0 offen lds
    buffer_load_dwordx4 v111, s[16:19], s0 offen offset:1024 lds
    s_add_u32 m0, s60, 24576
    s_add_u32 s69, s57, 4
    s_and_b32 s69, s69, 7
    s_mul_i32 s0, s69, 229376
    s_add_u32 s0, s0, s65
    buffer_load_dwordx4 v110, s[20:23], s0 offen lds
    buffer_load_dwordx4 v111, s[20:23], s0 offen offset:1024 lds
    v_mov_b32 v216, 0x3f803f80
    v_mov_b32 v217, 0x3f803f80
    v_mov_b32 v218, 0x3f803f80
    v_mov_b32 v219, 0x3f803f80
    v_mov_b32 v220, 0x3f803f80
    v_mov_b32 v221, 0x3f803f80
    v_mov_b32 v222, 0x3f803f80
    v_mov_b32 v223, 0x3f803f80
    v_mov_b32 v224, 0x3f803f80
    v_mov_b32 v225, 0x3f803f80
    v_mov_b32 v226, 0x3f803f80
    v_mov_b32 v227, 0x3f803f80
    v_mov_b32 v228, 0x3f803f80
    v_mov_b32 v229, 0x3f803f80
    v_mov_b32 v230, 0x3f803f80
    v_mov_b32 v231, 0x3f803f80
    v_mov_b32 v232, 0x3f803f80
    v_mov_b32 v233, 0x3f803f80
    v_mov_b32 v234, 0x3f803f80
    v_mov_b32 v235, 0x3f803f80
    v_mov_b32 v236, 0x3f803f80
    v_mov_b32 v237, 0x3f803f80
    v_mov_b32 v238, 0x3f803f80
    v_mov_b32 v239, 0x3f803f80
    v_mov_b32 v240, 0x3f803f80
    v_mov_b32 v241, 0x3f803f80
    v_mov_b32 v242, 0x3f803f80
    v_mov_b32 v243, 0x3f803f80
    v_mov_b32 v244, 0x3f803f80
    v_mov_b32 v245, 0x3f803f80
    v_mov_b32 v246, 0x3f803f80
    v_mov_b32 v247, 0x3f803f80
    v_mov_b32 v248, 0x3f803f80
    v_mov_b32 v249, 0x3f803f80
    v_mov_b32 v250, 0x3f803f80
    v_mov_b32 v251, 0x3f803f80
    v_mov_b32 v252, 0x3f803f80
    v_mov_b32 v253, 0x3f803f80
    v_mov_b32 v254, 0x3f803f80
    v_mov_b32 v255, 0x3f803f80
    s_waitcnt vmcnt(8)
    s_barrier
    s_cmp_lg_u32 s53, 0
    s_cbranch_scc1 mk_nof22
    s_mov_b64 exec, 1
    s_add_u32 s0, s66, 8192
    buffer_store_dword v115, off, s[32:35], s0 sc1
    s_mov_b64 exec, -1
mk_nof22:
    s_add_u32 m0, s60, 32768
    s_add_u32 s69, s57, 5
    s_and_b32 s69, s69, 7
    s_mul_i32 s0, s69, 229376
    s_add_u32 s0, s0, s65
    buffer_load_dwordx4 v110, s[16:19], s0 offen lds
    buffer_load_dwordx4 v111, s[16:19], s0 offen offset:1024 lds
    s_add_u32 m0, s60, 40960
    s_add_u32 s69, s57, 5
    s_and_b32 s69, s69, 7
    s_mul_i32 s0, s69, 229376
    s_add_u32 s0, s0, s65
    buffer_load_dwordx4 v110, s[20:23], s0 offen lds
    buffer_load_dwordx4 v111, s[20:23], s0 offen offset:1024 lds
    v_mov_b32 v32, 0
    v_mov_b32 v80, 0
    v_mov_b32 v33, 0
    v_mov_b32 v81, 0
    v_mov_b32 v34, 0
    v_mov_b32 v82, 0
    v_mov_b32 v35, 0
    v_mov_b32 v83, 0
    v_mov_b32 v36, 0
    v_mov_b32 v84, 0
    v_mov_b32 v37, 0
    v_mov_b32 v85, 0
    v_mov_b32 v38, 0
    v_mov_b32 v86, 0
    v_mov_b32 v39, 0
    v_mov_b32 v87, 0
    v_mov_b32 v40, 0
    v_mov_b32 v88, 0
    v_mov_b32 v41, 0
    v_mov_b32 v89, 0
    v_mov_b32 v42, 0
    v_mov_b32 v90, 0
    v_mov_b32 v43, 0
    v_mov_b32 v91, 0
    v_mov_b32 v44, 0
    v_mov_b32 v92, 0
    v_mov_b32 v45, 0
    v_mov_b32 v93, 0
    v_mov_b32 v46, 0
    v_mov_b32 v94, 0
    v_mov_b32 v47, 0
    v_mov_b32 v95, 0
    s_waitcnt vmcnt(8)
    s_barrier
    s_cmp_lg_u32 s53, 0
    s_cbranch_scc1 mk_nof23
    s_mov_b64 exec, 1
    buffer_store_dword v115, off, s[32:35], s66 sc1
    s_mov_b64 exec, -1
mk_nof23:
    s_add_u32 m0, s60, 49152
    s_add_u32 s69, s57, 6
    s_and_b32 s69, s69, 7
    s_mul_i32 s0, s69, 229376
    s_add_u32 s0, s0, s65
    buffer_load_dwordx4 v110, s[16:19], s0 offen lds
    buffer_load_dwordx4 v111, s[16:19], s0 offen offset:1024 lds
    s_add_u32 m0, s60, 57344
    s_add_u32 s69, s57, 6
    s_and_b32 s69, s69, 7
    s_mul_i32 s0, s69, 229376
    s_add_u32 s0, s0, s65
    buffer_load_dwordx4 v110, s[20:23], s0 offen lds
    buffer_load_dwordx4 v111, s[20:23], s0 offen offset:1024 lds
    s_waitcnt vmcnt(8)
    s_barrier
    s_add_u32 m0, s60, 65536
    s_add_u32 s69, s57, 7
    s_and_b32 s69, s69, 7
    s_mul_i32 s0, s69, 229376
    s_add_u32 s0, s0, s65
    buffer_load_dwordx4 v110, s[16:19], s0 offen lds
    buffer_load_dwordx4 v111, s[16:19], s0 offen offset:1024 lds
    s_add_u32 m0, s60, 73728
    s_add_u32 s69, s57, 7
    s_and_b32 s69, s69, 7
    s_mul_i32 s0, s69, 229376
    s_add_u32 s0, s0, s65
    buffer_load_dwordx4 v110, s[20:23], s0 offen lds
    buffer_load_dwordx4 v111, s[20:23], s0 offen offset:1024 lds
    s_lshl_b32 s4, s67, 11
    s_add_i32 s12, s4, -8192
    s_max_i32 s12, s12, 0
    s_add_i32 s13, s4, -7168
    s_max_i32 s13, s13, 0
    s_add_i32 s14, s4, -6144
    s_max_i32 s14, s14, 0
    s_add_i32 s15, s4, -5120
    s_max_i32 s15, s15, 0
    s_add_i32 s16, s4, -4096
    s_max_i32 s16, s16, 0
    s_add_i32 s17, s4, -3072
    s_max_i32 s17, s17, 0
    s_add_i32 s18, s4, -2048
    s_max_i32 s18, s18, 0
    s_add_i32 s19, s4, -1024
    s_max_i32 s19, s19, 0
    s_add_i32 s20, s4, 0
    s_max_i32 s20, s20, 0
    s_add_i32 s21, s4, 1024
    s_max_i32 s21, s21, 0
    buffer_load_dword v19, v119, s[32:35], 0 offen sc1
    s_waitcnt vmcnt(9)
    s_barrier
    s_waitcnt vmcnt(0)
    v_cmp_ne_u32 vcc, s58, v19
    s_cbranch_vccz mk_v_ok
    s_mov_b32 s59, 4000
mk_vs_loop:
    buffer_load_dword v19, v119, s[32:35], 0 offen sc1
    s_waitcnt vmcnt(0)
    v_cmp_ne_u32 vcc, s58, v19
    s_cbranch_vccz mk_vs_ok
    s_sleep 8
    s_sub_u32 s59, s59, 1
    s_cmp_lg_u32 s59, 0
    s_cbranch_scc1 mk_vs_loop
mk_vs_ok:
mk_v_ok:
    buffer_load_dword v118, v117, s[32:35], 0 offen sc1
    buffer_load_dword v114, v116, s[32:35], 0 offen sc1
    buffer_load_dwordx4 v[176:179], v127, s[32:35], s12 offen sc1
    buffer_load_dwordx4 v[180:183], v127, s[32:35], s13 offen sc1
    buffer_load_dwordx4 v[184:187], v127, s[32:35], s14 offen sc1
    buffer_load_dwordx4 v[188:191], v127, s[32:35], s15 offen sc1
    buffer_load_dwordx4 v[192:195], v127, s[32:35], s16 offen sc1
    buffer_load_dwordx4 v[196:199], v127, s[32:35], s17 offen sc1
    buffer_load_dwordx4 v[200:203], v127, s[32:35], s18 offen sc1
    buffer_load_dwordx4 v[204:207], v127, s[32:35], s19 offen sc1
    buffer_load_dwordx4 v[208:211], v127, s[32:35], s20 offen sc1
    buffer_load_dwordx4 v[212:215], v127, s[32:35], s21 offen sc1
    s_barrier
    s_setprio 1
    s_lshl_b32 s60, s53, 13
    s_mul_i32 s61, s53, 442368
    s_add_u32 s61, s61, s73
    s_add_u32 m0, s60, 0
    s_add_u32 s0, s61, 0
    buffer_load_dwordx4 v112, s[36:39], s0 offen lds
    buffer_load_dwordx4 v113, s[36:39], s0 offen offset:1024 lds
    s_add_u32 m0, s60, 2048
    s_add_u32 s0, s61, 16384
    buffer_load_dwordx4 v112, s[36:39], s0 offen lds
    buffer_load_dwordx4 v113, s[36:39], s0 offen offset:1024 lds
    s_add_u32 m0, s60, 4096
    s_add_u32 s0, s61, 32768
    buffer_load_dwordx4 v112, s[36:39], s0 offen lds
    buffer_load_dwordx4 v113, s[36:39], s0 offen offset:1024 lds
    s_add_u32 m0, s60, 6144
    s_add_u32 s0, s61, 49152
    buffer_load_dwordx4 v112, s[36:39], s0 offen lds
    buffer_load_dwordx4 v113, s[36:39], s0 offen offset:1024 lds
    s_waitcnt vmcnt(18)
    v_cmp_ne_u32 s[74:75], s58, v118
    v_cmp_ne_u32 vcc, s58, v114
    s_cbranch_vccz mk_q_ok
    s_mov_b32 s59, 4000
mk_qs_loop:
    buffer_load_dword v114, v116, s[32:35], 0 offen sc1
    s_waitcnt vmcnt(0)
    v_cmp_ne_u32 vcc, s58, v114
    s_cbranch_vccz mk_qs_ok
    s_sleep 8
    s_sub_u32 s59, s59, 1
    s_cmp_lg_u32 s59, 0
    s_cbranch_scc1 mk_qs_loop
mk_qs_ok:
mk_q_ok:
    buffer_load_dwordx4 v[128:131], v98, s[32:35], s20 offen sc1
    buffer_load_dwordx4 v[132:135], v98, s[32:35], s21 offen sc1
    buffer_load_dwordx4 v[136:139], v99, s[32:35], s12 offen sc1
    buffer_load_dwordx4 v[140:143], v99, s[32:35], s13 offen sc1
    buffer_load_dwordx4 v[144:147], v99, s[32:35], s14 offen sc1
    buffer_load_dwordx4 v[148:151], v99, s[32:35], s15 offen sc1
    buffer_load_dwordx4 v[152:155], v99, s[32:35], s16 offen sc1
    buffer_load_dwordx4 v[156:159], v99, s[32:35], s17 offen sc1
    buffer_load_dwordx4 v[160:163], v99, s[32:35], s18 offen sc1
    buffer_load_dwordx4 v[164:167], v99, s[32:35], s19 offen sc1
    buffer_load_dwordx4 v[168:171], v99, s[32:35], s20 offen sc1
    buffer_load_dwordx4 v[172:175], v99, s[32:35], s21 offen sc1
    s_waitcnt vmcnt(12)
    s_cmp_lg_u64 s[74:75], 0
    s_cbranch_scc1 mk_h_late
    s_lshl_b32 s0, s53, 2
    s_add_u32 s0, s0, 156176
    v_mov_b32 v20, s0
    ds_write_b32 v20, v115
mk_h_late:
    v_permlane16_swap_b32 v176, v216
    v_permlane16_swap_b32 v177, v217
    v_permlane16_swap_b32 v178, v218
    v_permlane16_swap_b32 v179, v219
    v_permlane16_swap_b32 v180, v220
    v_permlane16_swap_b32 v181, v221
    v_permlane16_swap_b32 v182, v222
    v_permlane16_swap_b32 v183, v223
    v_permlane16_swap_b32 v184, v224
    v_permlane16_swap_b32 v185, v225
    v_permlane16_swap_b32 v186, v226
    v_permlane16_swap_b32 v187, v227
    v_permlane16_swap_b32 v188, v228
    v_permlane16_swap_b32 v189, v229
    v_permlane16_swap_b32 v190, v230
    v_permlane16_swap_b32 v191, v231
    v_permlane16_swap_b32 v192, v232
    v_permlane16_swap_b32 v193, v233
    v_permlane16_swap_b32 v194, v234
    v_permlane16_swap_b32 v195, v235
    v_permlane16_swap_b32 v196, v236
    v_permlane16_swap_b32 v197, v237
    v_permlane16_swap_b32 v198, v238
    v_permlane16_swap_b32 v199, v239
    v_permlane16_swap_b32 v200, v240
    v_permlane16_swap_b32 v201, v241
    v_permlane16_swap_b32 v202, v242
    v_permlane16_swap_b32 v203, v243
    v_permlane16_swap_b32 v204, v244
    v_permlane16_swap_b32 v205, v245
    v_permlane16_swap_b32 v206, v246
    v_permlane16_swap_b32 v207, v247
    v_permlane16_swap_b32 v208, v248
    v_permlane16_swap_b32 v209, v249
    v_permlane16_swap_b32 v210, v250
    v_permlane16_swap_b32 v211, v251
    v_permlane16_swap_b32 v212, v252
    v_permlane16_swap_b32 v213, v253
    v_permlane16_swap_b32 v214, v254
    v_permlane16_swap_b32 v215, v255
    s_cmp_eq_u64 s[74:75], 0
    s_cbranch_scc1 mk_h_done
    s_mov_b32 s59, 4000
mk_hs_loop:
    buffer_load_dword v118, v117, s[32:35], 0 offen sc1
    s_waitcnt vmcnt(0)
    v_cmp_ne_u32 vcc, s58, v118
    s_cbranch_vccz mk_hs_ok
    s_sleep 8
    s_sub_u32 s59, s59, 1
    s_cmp_lg_u32 s59, 0
    s_cbranch_scc1 mk_hs_loop
mk_hs_ok:
    s_lshl_b32 s0, s53, 2
    s_add_u32 s0, s0, 156176
    v_mov_b32 v20, s0
    ds_write_b32 v20, v115
mk_h_done:
    s_cmp_eq_u32 s72, 2
    s_cbranch_scc1 mk_f0_e2
    s_cmp_eq_u32 s72, 4
    s_cbranch_scc1 mk_f0_e4
    s_cmp_eq_u32 s72, 6
    s_cbranch_scc1 mk_f0_e6
    s_cmp_eq_u32 s72, 8
    s_cbranch_scc1 mk_f0_e8
    s_waitcnt vmcnt(9)
    v_mfma_f32_32x32x16_bf16 v[0:15], v[136:139], v[128:131], v[64:79]
    s_nop 11
mk_f0_0:
    v_exp_f32 v0, v0
    v_exp_f32 v1, v1
    s_waitcnt vmcnt(8)
    v_mfma_f32_32x32x16_bf16 v[16:31], v[140:143], v[128:131], 0
    v_exp_f32 v2, v2
    v_exp_f32 v3, v3
    v_exp_f32 v4, v4
    v_exp_f32 v5, v5
    v_exp_f32 v6, v6
    v_exp_f32 v7, v7
    v_exp_f32 v8, v8
    v_cvt_pk_bf16_f32 v0, v0, v1
    v_exp_f32 v9, v9
    v_cvt_pk_bf16_f32 v1, v2, v3
    v_exp_f32 v10, v10
    v_cvt_pk_bf16_f32 v2, v4, v5
    v_exp_f32 v11, v11
    v_cvt_pk_bf16_f32 v3, v6, v7
    v_exp_f32 v12, v12
    v_exp_f32 v13, v13
    v_exp_f32 v14, v14
    v_exp_f32 v15, v15
    v_mfma_f32_32x32x16_bf16 v[32:47], v[176:179], v[0:3], v[32:47]
    v_cvt_pk_bf16_f32 v4, v8, v9
    v_cvt_pk_bf16_f32 v5, v10, v11
    v_cvt_pk_bf16_f32 v6, v12, v13
    v_cvt_pk_bf16_f32 v7, v14, v15
    v_exp_f32 v16, v16
    v_exp_f32 v17, v17
    v_mfma_f32_32x32x16_bf16 v[32:47], v[216:219], v[4:7], v[32:47]
mk_f0_1x:
    s_waitcnt vmcnt(7)
    v_mfma_f32_32x32x16_bf16 v[0:15], v[144:147], v[128:131], 0
    v_exp_f32 v18, v18
    v_exp_f32 v19, v19
    v_exp_f32 v20, v20
    v_exp_f32 v21, v21
    v_exp_f32 v22, v22
    v_exp_f32 v23, v23
    v_exp_f32 v24, v24
    v_cvt_pk_bf16_f32 v16, v16, v17
    v_exp_f32 v25, v25
    v_cvt_pk_bf16_f32 v17, v18, v19
    v_exp_f32 v26, v26
    v_cvt_pk_bf16_f32 v18, v20, v21
    v_exp_f32 v27, v27
    v_cvt_pk_bf16_f32 v19, v22, v23
    v_exp_f32 v28, v28
    v_exp_f32 v29, v29
    v_exp_f32 v30, v30
    v_exp_f32 v31, v31
    v_mfma_f32_32x32x16_bf16 v[32:47], v[180:183], v[16:19], v[32:47]
    v_cvt_pk_bf16_f32 v20, v24, v25
    v_cvt_pk_bf16_f32 v21, v26, v27
    v_cvt_pk_bf16_f32 v22, v28, v29
    v_cvt_pk_bf16_f32 v23, v30, v31
    v_exp_f32 v0, v0
    v_exp_f32 v1, v1
    v_mfma_f32_32x32x16_bf16 v[32:47], v[220:223], v[20:23], v[32:47]
mk_f0_2x:
    s_waitcnt vmcnt(6)
    v_mfma_f32_32x32x16_bf16 v[16:31], v[148:151], v[128:131], 0
    v_exp_f32 v2, v2
    v_exp_f32 v3, v3
    v_exp_f32 v4, v4
    v_exp_f32 v5, v5
    v_exp_f32 v6, v6
    v_exp_f32 v7, v7
    v_exp_f32 v8, v8
    v_cvt_pk_bf16_f32 v0, v0, v1
    v_exp_f32 v9, v9
    v_cvt_pk_bf16_f32 v1, v2, v3
    v_exp_f32 v10, v10
    v_cvt_pk_bf16_f32 v2, v4, v5
    v_exp_f32 v11, v11
    v_cvt_pk_bf16_f32 v3, v6, v7
    v_exp_f32 v12, v12
    v_exp_f32 v13, v13
    v_exp_f32 v14, v14
    v_exp_f32 v15, v15
    v_mfma_f32_32x32x16_bf16 v[32:47], v[184:187], v[0:3], v[32:47]
    v_cvt_pk_bf16_f32 v4, v8, v9
    v_cvt_pk_bf16_f32 v5, v10, v11
    v_cvt_pk_bf16_f32 v6, v12, v13
    v_cvt_pk_bf16_f32 v7, v14, v15
    v_exp_f32 v16, v16
    v_exp_f32 v17, v17
    v_mfma_f32_32x32x16_bf16 v[32:47], v[224:227], v[4:7], v[32:47]
mk_f0_3x:
    s_waitcnt vmcnt(5)
    v_mfma_f32_32x32x16_bf16 v[0:15], v[152:155], v[128:131], 0
    v_exp_f32 v18, v18
    v_exp_f32 v19, v19
    v_exp_f32 v20, v20
    v_exp_f32 v21, v21
    v_exp_f32 v22, v22
    v_exp_f32 v23, v23
    v_exp_f32 v24, v24
    v_cvt_pk_bf16_f32 v16, v16, v17
    v_exp_f32 v25, v25
    v_cvt_pk_bf16_f32 v17, v18, v19
    v_exp_f32 v26, v26
    v_cvt_pk_bf16_f32 v18, v20, v21
    v_exp_f32 v27, v27
    v_cvt_pk_bf16_f32 v19, v22, v23
    v_exp_f32 v28, v28
    v_exp_f32 v29, v29
    v_exp_f32 v30, v30
    v_exp_f32 v31, v31
    v_mfma_f32_32x32x16_bf16 v[32:47], v[188:191], v[16:19], v[32:47]
    v_cvt_pk_bf16_f32 v20, v24, v25
    v_cvt_pk_bf16_f32 v21, v26, v27
    v_cvt_pk_bf16_f32 v22, v28, v29
    v_cvt_pk_bf16_f32 v23, v30, v31
    v_exp_f32 v0, v0
    v_exp_f32 v1, v1
    v_mfma_f32_32x32x16_bf16 v[32:47], v[228:231], v[20:23], v[32:47]
mk_f0_4x:
    s_waitcnt vmcnt(4)
    v_mfma_f32_32x32x16_bf16 v[16:31], v[156:159], v[128:131], 0
    v_exp_f32 v2, v2
    v_exp_f32 v3, v3
    v_exp_f32 v4, v4
    v_exp_f32 v5, v5
    v_exp_f32 v6, v6
    v_exp_f32 v7, v7
    v_exp_f32 v8, v8
    v_cvt_pk_bf16_f32 v0, v0, v1
    v_exp_f32 v9, v9
    v_cvt_pk_bf16_f32 v1, v2, v3
    v_exp_f32 v10, v10
    v_cvt_pk_bf16_f32 v2, v4, v5
    v_exp_f32 v11, v11
    v_cvt_pk_bf16_f32 v3, v6, v7
    v_exp_f32 v12, v12
    v_exp_f32 v13, v13
    v_exp_f32 v14, v14
    v_exp_f32 v15, v15
    v_mfma_f32_32x32x16_bf16 v[32:47], v[192:195], v[0:3], v[32:47]
    v_cvt_pk_bf16_f32 v4, v8, v9
    v_cvt_pk_bf16_f32 v5, v10, v11
    v_cvt_pk_bf16_f32 v6, v12, v13
    v_cvt_pk_bf16_f32 v7, v14, v15
    v_exp_f32 v16, v16
    v_exp_f32 v17, v17
    v_mfma_f32_32x32x16_bf16 v[32:47], v[232:235], v[4:7], v[32:47]
mk_f0_5x:
    s_waitcnt vmcnt(3)
    v_mfma_f32_32x32x16_bf16 v[0:15], v[160:163], v[128:131], 0
    v_exp_f32 v18, v18
    v_exp_f32 v19, v19
    v_exp_f32 v20, v20
    v_exp_f32 v21, v21
    v_exp_f32 v22, v22
    v_exp_f32 v23, v23
    v_exp_f32 v24, v24
    v_cvt_pk_bf16_f32 v16, v16, v17
    v_exp_f32 v25, v25
    v_cvt_pk_bf16_f32 v17, v18, v19
    v_exp_f32 v26, v26
    v_cvt_pk_bf16_f32 v18, v20, v21
    v_exp_f32 v27, v27
    v_cvt_pk_bf16_f32 v19, v22, v23
    v_exp_f32 v28, v28
    v_exp_f32 v29, v29
    v_exp_f32 v30, v30
    v_exp_f32 v31, v31
    v_mfma_f32_32x32x16_bf16 v[32:47], v[196:199], v[16:19], v[32:47]
    v_cvt_pk_bf16_f32 v20, v24, v25
    v_cvt_pk_bf16_f32 v21, v26, v27
    v_cvt_pk_bf16_f32 v22, v28, v29
    v_cvt_pk_bf16_f32 v23, v30, v31
    v_exp_f32 v0, v0
    v_exp_f32 v1, v1
    v_mfma_f32_32x32x16_bf16 v[32:47], v[236:239], v[20:23], v[32:47]
mk_f0_6x:
    s_waitcnt vmcnt(2)
    v_mfma_f32_32x32x16_bf16 v[16:31], v[164:167], v[128:131], 0
    v_exp_f32 v2, v2
    v_exp_f32 v3, v3
    v_exp_f32 v4, v4
    v_exp_f32 v5, v5
    v_exp_f32 v6, v6
    v_exp_f32 v7, v7
    v_exp_f32 v8, v8
    v_cvt_pk_bf16_f32 v0, v0, v1
    v_exp_f32 v9, v9
    v_cvt_pk_bf16_f32 v1, v2, v3
    v_exp_f32 v10, v10
    v_cvt_pk_bf16_f32 v2, v4, v5
    v_exp_f32 v11, v11
    v_cvt_pk_bf16_f32 v3, v6, v7
    v_exp_f32 v12, v12
    v_exp_f32 v13, v13
    v_exp_f32 v14, v14
    v_exp_f32 v15, v15
    v_mfma_f32_32x32x16_bf16 v[32:47], v[200:203], v[0:3], v[32:47]
    v_cvt_pk_bf16_f32 v4, v8, v9
    v_cvt_pk_bf16_f32 v5, v10, v11
    v_cvt_pk_bf16_f32 v6, v12, v13
    v_cvt_pk_bf16_f32 v7, v14, v15
    v_exp_f32 v16, v16
    v_exp_f32 v17, v17
    v_mfma_f32_32x32x16_bf16 v[32:47], v[240:243], v[4:7], v[32:47]
mk_f0_7x:
    s_waitcnt vmcnt(1)
    v_mfma_f32_32x32x16_bf16 v[0:15], v[168:171], v[128:131], v[48:63]
    v_exp_f32 v18, v18
    v_exp_f32 v19, v19
    v_exp_f32 v20, v20
    v_exp_f32 v21, v21
    v_exp_f32 v22, v22
    v_exp_f32 v23, v23
    v_exp_f32 v24, v24
    v_cvt_pk_bf16_f32 v16, v16, v17
    v_exp_f32 v25, v25
    v_cvt_pk_bf16_f32 v17, v18, v19
    v_exp_f32 v26, v26
    v_cvt_pk_bf16_f32 v18, v20, v21
    v_exp_f32 v27, v27
    v_cvt_pk_bf16_f32 v19, v22, v23
    v_exp_f32 v28, v28
    v_exp_f32 v29, v29
    v_exp_f32 v30, v30
    v_exp_f32 v31, v31
    v_mfma_f32_32x32x16_bf16 v[32:47], v[204:207], v[16:19], v[32:47]
    v_cvt_pk_bf16_f32 v20, v24, v25
    v_cvt_pk_bf16_f32 v21, v26, v27
    v_cvt_pk_bf16_f32 v22, v28, v29
    v_cvt_pk_bf16_f32 v23, v30, v31
    v_exp_f32 v0, v0
    v_exp_f32 v1, v1
    v_mfma_f32_32x32x16_bf16 v[32:47], v[244:247], v[20:23], v[32:47]
mk_f0_8x:
    v_exp_f32 v2, v2
    v_exp_f32 v3, v3
    v_exp_f32 v4, v4
    v_exp_f32 v5, v5
    v_exp_f32 v6, v6
    v_exp_f32 v7, v7
    v_exp_f32 v8, v8
    v_cvt_pk_bf16_f32 v0, v0, v1
    v_exp_f32 v9, v9
    v_cvt_pk_bf16_f32 v1, v2, v3
    v_exp_f32 v10, v10
    v_cvt_pk_bf16_f32 v2, v4, v5
    v_exp_f32 v11, v11
    v_cvt_pk_bf16_f32 v3, v6, v7
    v_exp_f32 v12, v12
    v_exp_f32 v13, v13
    v_exp_f32 v14, v14
    v_exp_f32 v15, v15
    v_mfma_f32_32x32x16_bf16 v[32:47], v[208:211], v[0:3], v[32:47]
    v_cvt_pk_bf16_f32 v4, v8, v9
    v_cvt_pk_bf16_f32 v5, v10, v11
    v_cvt_pk_bf16_f32 v6, v12, v13
    v_cvt_pk_bf16_f32 v7, v14, v15
    s_waitcnt vmcnt(0)
    s_nop 1
    v_mfma_f32_32x32x16_bf16 v[32:47], v[248:251], v[4:7], v[32:47]
    s_branch mk_f0_chk
mk_f0_e2:
    s_waitcnt vmcnt(7)
    v_mfma_f32_32x32x16_bf16 v[0:15], v[144:147], v[128:131], 0
    s_nop 11
    v_exp_f32 v0, v0
    v_exp_f32 v1, v1
    s_branch mk_f0_2x
mk_f0_e4:
    s_waitcnt vmcnt(5)
    v_mfma_f32_32x32x16_bf16 v[0:15], v[152:155], v[128:131], 0
    s_nop 11
    v_exp_f32 v0, v0
    v_exp_f32 v1, v1
    s_branch mk_f0_4x
mk_f0_e6:
    s_waitcnt vmcnt(3)
    v_mfma_f32_32x32x16_bf16 v[0:15], v[160:163], v[128:131], 0
    s_nop 11
    v_exp_f32 v0, v0
    v_exp_f32 v1, v1
    s_branch mk_f0_6x
mk_f0_e8:
    s_waitcnt vmcnt(1)
    v_mfma_f32_32x32x16_bf16 v[0:15], v[168:171], v[128:131], v[48:63]
    s_nop 11
    v_exp_f32 v0, v0
    v_exp_f32 v1, v1
    s_branch mk_f0_8x
mk_f0_chk:
    s_mul_i32 s0, s20, 144
    s_lshl_b32 s1, s70, 10
    s_add_u32 s0, s0, s1
    s_add_u32 s0, s0, 6406144
    s_mov_b32 s4, 0x21800000
    s_mov_b32 s5, 0x5d800000
    s_nop 5
    v_max3_f32 v96, |v32|, |v33|, |v34|
    v_max3_f32 v97, |v35|, |v36|, |v37|
    v_max3_f32 v96, |v38|, |v39|, v96
    v_cmp_nle_f32 s[74:75], s4, v40
    v_max3_f32 v96, v96, v97, v40
    v_rcp_f32 v97, v40
    v_cmp_nge_f32 vcc, s5, v96
    s_nop 0
    s_or_b64 vcc, vcc, s[74:75]
    s_cbranch_vccnz mk_f0_slow
mk_f0_fin:
    v_mul_f32 v32, v97, v32
    v_mul_f32 v33, v97, v33
    v_mul_f32 v34, v97, v34
    v_mul_f32 v35, v97, v35
    v_mul_f32 v36, v97, v36
    v_mul_f32 v37, v97, v37
    v_mul_f32 v38, v97, v38
    v_mul_f32 v39, v97, v39
    v_cvt_pk_bf16_f32 v100, v32, v33
    v_cvt_pk_bf16_f32 v101, v34, v35
    v_cvt_pk_bf16_f32 v102, v36, v37
    v_cvt_pk_bf16_f32 v103, v38, v39
    buffer_store_dwordx4 v[100:103], v122, s[32:35], s0 offen sc1
    s_cmp_eq_u32 s72, 2
    s_cbranch_scc1 mk_f1_e1
    s_cmp_eq_u32 s72, 4
    s_cbranch_scc1 mk_f1_e3
    s_cmp_eq_u32 s72, 6
    s_cbranch_scc1 mk_f1_e5
    s_cmp_eq_u32 s72, 8
    s_cbranch_scc1 mk_f1_e7
    v_mfma_f32_32x32x16_bf16 v[0:15], v[140:143], v[132:135], v[64:79]
    s_nop 11
mk_f1_0:
    v_exp_f32 v0, v0
    v_exp_f32 v1, v1
    v_mfma_f32_32x32x16_bf16 v[16:31], v[144:147], v[132:135], 0
    v_exp_f32 v2, v2
    v_exp_f32 v3, v3
    v_exp_f32 v4, v4
    v_exp_f32 v5, v5
    v_exp_f32 v6, v6
    v_exp_f32 v7, v7
    v_exp_f32 v8, v8
    v_cvt_pk_bf16_f32 v0, v0, v1
    v_exp_f32 v9, v9
    v_cvt_pk_bf16_f32 v1, v2, v3
    v_exp_f32 v10, v10
    v_cvt_pk_bf16_f32 v2, v4, v5
    v_exp_f32 v11, v11
    v_cvt_pk_bf16_f32 v3, v6, v7
    v_exp_f32 v12, v12
    v_exp_f32 v13, v13
    v_exp_f32 v14, v14
    v_exp_f32 v15, v15
    v_mfma_f32_32x32x16_bf16 v[80:95], v[180:183], v[0:3], v[80:95]
    v_cvt_pk_bf16_f32 v4, v8, v9
    v_cvt_pk_bf16_f32 v5, v10, v11
    v_cvt_pk_bf16_f32 v6, v12, v13
    v_cvt_pk_bf16_f32 v7, v14, v15
    v_exp_f32 v16, v16
    v_exp_f32 v17, v17
    v_mfma_f32_32x32x16_bf16 v[80:95], v[220:223], v[4:7], v[80:95]
mk_f1_1x:
    v_mfma_f32_32x32x16_bf16 v[0:15], v[148:151], v[132:135], 0
    v_exp_f32 v18, v18
    v_exp_f32 v19, v19
    v_exp_f32 v20, v20
    v_exp_f32 v21, v21
    v_exp_f32 v22, v22
    v_exp_f32 v23, v23
    v_exp_f32 v24, v24
    v_cvt_pk_bf16_f32 v16, v16, v17
    v_exp_f32 v25, v25
    v_cvt_pk_bf16_f32 v17, v18, v19
    v_exp_f32 v26, v26
    v_cvt_pk_bf16_f32 v18, v20, v21
    v_exp_f32 v27, v27
    v_cvt_pk_bf16_f32 v19, v22, v23
    v_exp_f32 v28, v28
    v_exp_f32 v29, v29
    v_exp_f32 v30, v30
    v_exp_f32 v31, v31
    v_mfma_f32_32x32x16_bf16 v[80:95], v[184:187], v[16:19], v[80:95]
    v_cvt_pk_bf16_f32 v20, v24, v25
    v_cvt_pk_bf16_f32 v21, v26, v27
    v_cvt_pk_bf16_f32 v22, v28, v29
    v_cvt_pk_bf16_f32 v23, v30, v31
    v_exp_f32 v0, v0
    v_exp_f32 v1, v1
    v_mfma_f32_32x32x16_bf16 v[80:95], v[224:227], v[20:23], v[80:95]
mk_f1_2x:
    v_mfma_f32_32x32x16_bf16 v[16:31], v[152:155], v[132:135], 0
    v_exp_f32 v2, v2
    v_exp_f32 v3, v3
    v_exp_f32 v4, v4
    v_exp_f32 v5, v5
    v_exp_f32 v6, v6
    v_exp_f32 v7, v7
    v_exp_f32 v8, v8
    v_cvt_pk_bf16_f32 v0, v0, v1
    v_exp_f32 v9, v9
    v_cvt_pk_bf16_f32 v1, v2, v3
    v_exp_f32 v10, v10
    v_cvt_pk_bf16_f32 v2, v4, v5
    v_exp_f32 v11, v11
    v_cvt_pk_bf16_f32 v3, v6, v7
    v_exp_f32 v12, v12
    v_exp_f32 v13, v13
    v_exp_f32 v14, v14
    v_exp_f32 v15, v15
    v_mfma_f32_32x32x16_bf16 v[80:95], v[188:191], v[0:3], v[80:95]
    v_cvt_pk_bf16_f32 v4, v8, v9
    v_cvt_pk_bf16_f32 v5, v10, v11
    v_cvt_pk_bf16_f32 v6, v12, v13
    v_cvt_pk_bf16_f32 v7, v14, v15
    v_exp_f32 v16, v16
    v_exp_f32 v17, v17
    v_mfma_f32_32x32x16_bf16 v[80:95], v[228:231], v[4:7], v[80:95]
mk_f1_3x:
    v_mfma_f32_32x32x16_bf16 v[0:15], v[156:159], v[132:135], 0
    v_exp_f32 v18, v18
    v_exp_f32 v19, v19
    v_exp_f32 v20, v20
    v_exp_f32 v21, v21
    v_exp_f32 v22, v22
    v_exp_f32 v23, v23
    v_exp_f32 v24, v24
    v_cvt_pk_bf16_f32 v16, v16, v17
    v_exp_f32 v25, v25
    v_cvt_pk_bf16_f32 v17, v18, v19
    v_exp_f32 v26, v26
    v_cvt_pk_bf16_f32 v18, v20, v21
    v_exp_f32 v27, v27
    v_cvt_pk_bf16_f32 v19, v22, v23
    v_exp_f32 v28, v28
    v_exp_f32 v29, v29
    v_exp_f32 v30, v30
    v_exp_f32 v31, v31
    v_mfma_f32_32x32x16_bf16 v[80:95], v[192:195], v[16:19], v[80:95]
    v_cvt_pk_bf16_f32 v20, v24, v25
    v_cvt_pk_bf16_f32 v21, v26, v27
    v_cvt_pk_bf16_f32 v22, v28, v29
    v_cvt_pk_bf16_f32 v23, v30, v31
    v_exp_f32 v0, v0
    v_exp_f32 v1, v1
    v_mfma_f32_32x32x16_bf16 v[80:95], v[232:235], v[20:23], v[80:95]
mk_f1_4x:
    v_mfma_f32_32x32x16_bf16 v[16:31], v[160:163], v[132:135], 0
    v_exp_f32 v2, v2
    v_exp_f32 v3, v3
    v_exp_f32 v4, v4
    v_exp_f32 v5, v5
    v_exp_f32 v6, v6
    v_exp_f32 v7, v7
    v_exp_f32 v8, v8
    v_cvt_pk_bf16_f32 v0, v0, v1
    v_exp_f32 v9, v9
    v_cvt_pk_bf16_f32 v1, v2, v3
    v_exp_f32 v10, v10
    v_cvt_pk_bf16_f32 v2, v4, v5
    v_exp_f32 v11, v11
    v_cvt_pk_bf16_f32 v3, v6, v7
    v_exp_f32 v12, v12
    v_exp_f32 v13, v13
    v_exp_f32 v14, v14
    v_exp_f32 v15, v15
    v_mfma_f32_32x32x16_bf16 v[80:95], v[196:199], v[0:3], v[80:95]
    v_cvt_pk_bf16_f32 v4, v8, v9
    v_cvt_pk_bf16_f32 v5, v10, v11
    v_cvt_pk_bf16_f32 v6, v12, v13
    v_cvt_pk_bf16_f32 v7, v14, v15
    v_exp_f32 v16, v16
    v_exp_f32 v17, v17
    v_mfma_f32_32x32x16_bf16 v[80:95], v[236:239], v[4:7], v[80:95]
mk_f1_5x:
    v_mfma_f32_32x32x16_bf16 v[0:15], v[164:167], v[132:135], 0
    v_exp_f32 v18, v18
    v_exp_f32 v19, v19
    v_exp_f32 v20, v20
    v_exp_f32 v21, v21
    v_exp_f32 v22, v22
    v_exp_f32 v23, v23
    v_exp_f32 v24, v24
    v_cvt_pk_bf16_f32 v16, v16, v17
    v_exp_f32 v25, v25
    v_cvt_pk_bf16_f32 v17, v18, v19
    v_exp_f32 v26, v26
    v_cvt_pk_bf16_f32 v18, v20, v21
    v_exp_f32 v27, v27
    v_cvt_pk_bf16_f32 v19, v22, v23
    v_exp_f32 v28, v28
    v_exp_f32 v29, v29
    v_exp_f32 v30, v30
    v_exp_f32 v31, v31
    v_mfma_f32_32x32x16_bf16 v[80:95], v[200:203], v[16:19], v[80:95]
    v_cvt_pk_bf16_f32 v20, v24, v25
    v_cvt_pk_bf16_f32 v21, v26, v27
    v_cvt_pk_bf16_f32 v22, v28, v29
    v_cvt_pk_bf16_f32 v23, v30, v31
    v_exp_f32 v0, v0
    v_exp_f32 v1, v1
    v_mfma_f32_32x32x16_bf16 v[80:95], v[240:243], v[20:23], v[80:95]
mk_f1_6x:
    v_mfma_f32_32x32x16_bf16 v[16:31], v[168:171], v[132:135], 0
    v_exp_f32 v2, v2
    v_exp_f32 v3, v3
    v_exp_f32 v4, v4
    v_exp_f32 v5, v5
    v_exp_f32 v6, v6
    v_exp_f32 v7, v7
    v_exp_f32 v8, v8
    v_cvt_pk_bf16_f32 v0, v0, v1
    v_exp_f32 v9, v9
    v_cvt_pk_bf16_f32 v1, v2, v3
    v_exp_f32 v10, v10
    v_cvt_pk_bf16_f32 v2, v4, v5
    v_exp_f32 v11, v11
    v_cvt_pk_bf16_f32 v3, v6, v7
    v_exp_f32 v12, v12
    v_exp_f32 v13, v13
    v_exp_f32 v14, v14
    v_exp_f32 v15, v15
    v_mfma_f32_32x32x16_bf16 v[80:95], v[204:207], v[0:3], v[80:95]
    v_cvt_pk_bf16_f32 v4, v8, v9
    v_cvt_pk_bf16_f32 v5, v10, v11
    v_cvt_pk_bf16_f32 v6, v12, v13
    v_cvt_pk_bf16_f32 v7, v14, v15
    v_exp_f32 v16, v16
    v_exp_f32 v17, v17
    v_mfma_f32_32x32x16_bf16 v[80:95], v[244:247], v[4:7], v[80:95]
mk_f1_7x:
    v_mfma_f32_32x32x16_bf16 v[0:15], v[172:175], v[132:135], v[48:63]
    v_exp_f32 v18, v18
    v_exp_f32 v19, v19
    v_exp_f32 v20, v20
    v_exp_f32 v21, v21
    v_exp_f32 v22, v22
    v_exp_f32 v23, v23
    v_exp_f32 v24, v24
    v_cvt_pk_bf16_f32 v16, v16, v17
    v_exp_f32 v25, v25
    v_cvt_pk_bf16_f32 v17, v18, v19
    v_exp_f32 v26, v26
    v_cvt_pk_bf16_f32 v18, v20, v21
    v_exp_f32 v27, v27
    v_cvt_pk_bf16_f32 v19, v22, v23
    v_exp_f32 v28, v28
    v_exp_f32 v29, v29
    v_exp_f32 v30, v30
    v_exp_f32 v31, v31
    v_mfma_f32_32x32x16_bf16 v[80:95], v[208:211], v[16:19], v[80:95]
    v_cvt_pk_bf16_f32 v20, v24, v25
    v_cvt_pk_bf16_f32 v21, v26, v27
    v_cvt_pk_bf16_f32 v22, v28, v29
    v_cvt_pk_bf16_f32 v23, v30, v31
    v_exp_f32 v0, v0
    v_exp_f32 v1, v1
    v_mfma_f32_32x32x16_bf16 v[80:95], v[248:251], v[20:23], v[80:95]
mk_f1_8x:
    v_exp_f32 v2, v2
    v_exp_f32 v3, v3
    v_exp_f32 v4, v4
    v_exp_f32 v5, v5
    v_exp_f32 v6, v6
    v_exp_f32 v7, v7
    v_exp_f32 v8, v8
    v_cvt_pk_bf16_f32 v0, v0, v1
    v_exp_f32 v9, v9
    v_cvt_pk_bf16_f32 v1, v2, v3
    v_exp_f32 v10, v10
    v_cvt_pk_bf16_f32 v2, v4, v5
    v_exp_f32 v11, v11
    v_cvt_pk_bf16_f32 v3, v6, v7
    v_exp_f32 v12, v12
    v_exp_f32 v13, v13
    v_exp_f32 v14, v14
    v_exp_f32 v15, v15
    v_mfma_f32_32x32x16_bf16 v[80:95], v[212:215], v[0:3], v[80:95]
    v_cvt_pk_bf16_f32 v4, v8, v9
    v_cvt_pk_bf16_f32 v5, v10, v11
    v_cvt_pk_bf16_f32 v6, v12, v13
    v_cvt_pk_bf16_f32 v7, v14, v15
    s_nop 1
    v_mfma_f32_32x32x16_bf16 v[80:95], v[252:255], v[4:7], v[80:95]
    s_branch mk_f1_chk
mk_f1_e1:
    v_mfma_f32_32x32x16_bf16 v[16:31], v[144:147], v[132:135], 0
    s_nop 11
    v_exp_f32 v16, v16
    v_exp_f32 v17, v17
    s_branch mk_f1_1x
mk_f1_e3:
    v_mfma_f32_32x32x16_bf16 v[16:31], v[152:155], v[132:135], 0
    s_nop 11
    v_exp_f32 v16, v16
    v_exp_f32 v17, v17
    s_branch mk_f1_3x
mk_f1_e5:
    v_mfma_f32_32x32x16_bf16 v[16:31], v[160:163], v[132:135], 0
    s_nop 11
    v_exp_f32 v16, v16
    v_exp_f32 v17, v17
    s_branch mk_f1_5x
mk_f1_e7:
    v_mfma_f32_32x32x16_bf16 v[16:31], v[168:171], v[132:135], 0
    s_nop 11
    v_exp_f32 v16, v16
    v_exp_f32 v17, v17
    s_branch mk_f1_7x
mk_f1_chk:
    s_mul_i32 s0, s21, 144
    s_lshl_b32 s1, s70, 10
    s_add_u32 s0, s0, s1
    s_add_u32 s0, s0, 6406144
    s_mov_b32 s4, 0x21800000
    s_mov_b32 s5, 0x5d800000
    s_nop 5
    v_max3_f32 v96, |v80|, |v81|, |v82|
    v_max3_f32 v97, |v83|, |v84|, |v85|
    v_max3_f32 v96, |v86|, |v87|, v96
    v_cmp_nle_f32 s[74:75], s4, v88
    v_max3_f32 v96, v96, v97, v88
    v_rcp_f32 v97, v88
    v_cmp_nge_f32 vcc, s5, v96
    s_nop 0
    s_or_b64 vcc, vcc, s[74:75]
    s_cbranch_vccnz mk_f1_slow
mk_f1_fin:
    v_mul_f32 v80, v97, v80
    v_mul_f32 v81, v97, v81
    v_mul_f32 v82, v97, v82
    v_mul_f32 v83, v97, v83
    v_mul_f32 v84, v97, v84
    v_mul_f32 v85, v97, v85
    v_mul_f32 v86, v97, v86
    v_mul_f32 v87, v97, v87
    v_cvt_pk_bf16_f32 v100, v80, v81
    v_cvt_pk_bf16_f32 v101, v82, v83
    v_cvt_pk_bf16_f32 v102, v84, v85
    v_cvt_pk_bf16_f32 v103, v86, v87
    buffer_store_dwordx4 v[100:103], v122, s[32:35], s0 offen sc1
    s_lshl_b32 s0, s67, 5
    s_lshr_b32 s1, s70, 2
    s_add_u32 s0, s0, s1
    s_lshl_b32 s0, s0, 2
    s_add_u32 s0, s0, 15753216
    s_and_b32 s1, s2, 7
    s_lshr_b32 s4, s2, 6
    s_lshl_b32 s67, s1, 2
    s_add_u32 s67, s67, s4
    s_lshr_b32 s5, s53, 1
    s_and_b32 s6, s53, 1
    s_lshl_b32 s1, s67, 5
    s_lshl_b32 s4, s5, 4
    s_lshl_b32 s7, s5, 2
    s_add_u32 s1, s1, s7
    v_lshrrev_b32 v2, 4, v122
    v_and_b32 v116, 3, v2
    v_add_lshl_u32 v116, v116, s1, 2
    v_add_u32 v116, 15753216, v116
    s_lshl_b32 s1, s67, 1
    s_add_u32 s1, s1, s6
    s_mul_i32 s1, s1, 147456
    s_lshl_b32 s4, s4, 10
    s_add_u32 s1, s1, s4
    s_add_u32 s7, s1, 6406144
    v_lshrrev_b32 v4, 5, v2
    v_bfe_u32 v13, v2, 2, 2
    v_lshl_add_u32 v13, v4, 2, v13
    v_lshlrev_b32 v13, 7, v13
    v_bfe_u32 v14, v2, 4, 1
    v_lshl_add_u32 v13, v14, 5, v13
    v_and_b32 v15, 3, v2
    v_lshl_add_u32 v13, v15, 3, v13
    v_bfe_u32 v15, v2, 3, 1
    v_lshl_add_u32 v120, v15, 6, v13
    s_lshl_b32 s4, s5, 15
    s_add_u32 s4, s4, 90112
    v_add_u32 v120, s4, v120
    v_xor_b32 v121, 64, v120
    v_mov_b32 v20, 156164
    v_mov_b32 v21, 1
    s_waitcnt vmcnt(0)
    s_mov_b64 exec, 1
    ds_add_rtn_u32 v21, v20, v21
    s_waitcnt lgkmcnt(0)
    v_cmp_eq_u32 vcc, 3, v21
    s_cbranch_vccz mk_notlast
    buffer_store_dword v115, off, s[32:35], s0 sc1
mk_notlast:
    s_mov_b64 exec, -1
    v_lshrrev_b32 v64, 7, v122
    s_lshl_b32 s4, s52, 3
    v_add_u32 v64, s4, v64
    v_bfe_u32 v65, v122, 4, 3
    v_lshrrev_b32 v66, 5, v64
    v_lshl_add_u32 v66, v66, 3, v65
    v_cmp_gt_u32 vcc, 7, v66
    v_mul_u32_u24 v66, 1088, v66
    v_and_b32 v67, 31, v64
    v_lshl_add_u32 v66, v67, 4, v66
    s_lshl_b32 s5, s67, 6
    v_add_u32 v64, s5, v64
    v_lshlrev_b32 v64, 10, v64
    v_lshl_add_u32 v64, v65, 4, v64
    s_bfe_u32 s5, s2, 0x30003
    s_lshl_b32 s5, s5, 7
    v_add_u32 v64, s5, v64
    buffer_load_dwordx4 v[72:75], v64, s[8:11], 0 offen
    v_add_u32 v65, 90112, v66
    v_add_u32 v67, 25152, v66
    v_cndmask_b32 v68, v67, v66, vcc
    v_mov_b32 v66, 9792
    v_mov_b32 v67, 8192
    v_cndmask_b32 v66, v66, v67, vcc
    v_add_u32 v69, v68, v66
    v_add_u32 v70, v69, v66
    v_add_u32 v71, v70, v66
    ds_read_b64_tr_b16 v[32:33], v120 offset:0
    ds_read_b64_tr_b16 v[34:35], v120 offset:1024
    ds_read_b64_tr_b16 v[36:37], v121 offset:0
    ds_read_b64_tr_b16 v[38:39], v121 offset:1024
    ds_read_b64_tr_b16 v[40:41], v120 offset:2048
    ds_read_b64_tr_b16 v[42:43], v120 offset:3072
    ds_read_b64_tr_b16 v[44:45], v121 offset:2048
    ds_read_b64_tr_b16 v[46:47], v121 offset:3072
    s_lshl_b32 s0, s53, 2
    s_add_u32 s0, s0, 156192
    v_mov_b32 v20, s0
    s_mov_b32 s59, 32000
mk_go1:
    ds_read_b32 v21, v20
    s_waitcnt lgkmcnt(0)
    v_cmp_eq_u32 vcc, 0, v21
    s_cbranch_vccz mk_go1_ok
    s_sleep 2
    s_sub_u32 s59, s59, 1
    s_cmp_lg_u32 s59, 0
    s_cbranch_scc1 mk_go1
mk_go1_ok:
    s_mov_b32 s59, 4000
mk_os_loop:
    buffer_load_dword v114, v116, s[32:35], 0 offen sc1
    s_waitcnt vmcnt(0)
    v_cmp_ne_u32 vcc, s58, v114
    s_cbranch_vccz mk_os_ok
    s_sleep 16
    s_sub_u32 s59, s59, 1
    s_cmp_lg_u32 s59, 0
    s_cbranch_scc1 mk_os_loop
mk_os_ok:
    s_nop 0
    s_mov_b32 s59, 32000
mk_go2:
    ds_read_b32 v21, v20
    s_waitcnt lgkmcnt(0)
    v_cmp_ne_u32 vcc, 2, v21
    s_cbranch_vccz mk_go2_ok
    s_sleep 1
    s_sub_u32 s59, s59, 1
    s_cmp_lg_u32 s59, 0
    s_cbranch_scc1 mk_go2
mk_go2_ok:
    buffer_load_dwordx4 v[128:131], v122, s[32:35], s7 offen offset:0 sc1
    buffer_load_dwordx4 v[132:135], v122, s[32:35], s7 offen offset:1024 sc1
    buffer_load_dwordx4 v[136:139], v122, s[32:35], s7 offen offset:2048 sc1
    buffer_load_dwordx4 v[140:143], v122, s[32:35], s7 offen offset:3072 sc1
    s_add_u32 s7, s7, 4096
    buffer_load_dwordx4 v[144:147], v122, s[32:35], s7 offen offset:0 sc1
    buffer_load_dwordx4 v[148:151], v122, s[32:35], s7 offen offset:1024 sc1
    buffer_load_dwordx4 v[152:155], v122, s[32:35], s7 offen offset:2048 sc1
    buffer_load_dwordx4 v[156:159], v122, s[32:35], s7 offen offset:3072 sc1
    s_add_u32 s7, s7, 4096
    buffer_load_dwordx4 v[160:163], v122, s[32:35], s7 offen offset:0 sc1
    buffer_load_dwordx4 v[164:167], v122, s[32:35], s7 offen offset:1024 sc1
    buffer_load_dwordx4 v[168:171], v122, s[32:35], s7 offen offset:2048 sc1
    buffer_load_dwordx4 v[172:175], v122, s[32:35], s7 offen offset:3072 sc1
    s_add_u32 s7, s7, 4096
    buffer_load_dwordx4 v[176:179], v122, s[32:35], s7 offen offset:0 sc1
    buffer_load_dwordx4 v[180:183], v122, s[32:35], s7 offen offset:1024 sc1
    buffer_load_dwordx4 v[184:187], v122, s[32:35], s7 offen offset:2048 sc1
    buffer_load_dwordx4 v[188:191], v122, s[32:35], s7 offen offset:3072 sc1
    s_lshr_b32 s5, s53, 1
    s_lshl_b32 s0, s5, 15
    s_mul_i32 s1, s6, 8704
    s_add_u32 s0, s0, s1
    s_add_u32 s0, s0, 90112
    v_add_u32 v62, s0, v122
    s_lshl_b32 s5, s5, 2
    s_add_u32 s5, s5, 156224
    v_mov_b32 v60, s5
    v_mov_b32 v61, 1
    ds_read_b64_tr_b16 v[48:49], v120 offset:4096
    ds_read_b64_tr_b16 v[50:51], v120 offset:5120
    ds_read_b64_tr_b16 v[52:53], v121 offset:4096
    ds_read_b64_tr_b16 v[54:55], v121 offset:5120
    s_waitcnt vmcnt(15) lgkmcnt(8)
    v_mfma_f32_32x32x16_bf16 v[0:15], v[32:35], v[128:131], 0
    v_mfma_f32_32x32x16_bf16 v[16:31], v[36:39], v[128:131], 0
    ds_read_b64_tr_b16 v[32:33], v120 offset:6144
    ds_read_b64_tr_b16 v[34:35], v120 offset:7168
    ds_read_b64_tr_b16 v[36:37], v121 offset:6144
    ds_read_b64_tr_b16 v[38:39], v121 offset:7168
    s_waitcnt vmcnt(14) lgkmcnt(8)
    v_mfma_f32_32x32x16_bf16 v[0:15], v[40:43], v[132:135], v[0:15]
    v_mfma_f32_32x32x16_bf16 v[16:31], v[44:47], v[132:135], v[16:31]
    ds_read_b64_tr_b16 v[40:41], v120 offset:8192
    ds_read_b64_tr_b16 v[42:43], v120 offset:9216
    ds_read_b64_tr_b16 v[44:45], v121 offset:8192
    ds_read_b64_tr_b16 v[46:47], v121 offset:9216
    s_waitcnt vmcnt(13) lgkmcnt(8)
    v_mfma_f32_32x32x16_bf16 v[0:15], v[48:51], v[136:139], v[0:15]
    v_mfma_f32_32x32x16_bf16 v[16:31], v[52:55], v[136:139], v[16:31]
    ds_read_b64_tr_b16 v[48:49], v120 offset:10240
    ds_read_b64_tr_b16 v[50:51], v120 offset:11264
    ds_read_b64_tr_b16 v[52:53], v121 offset:10240
    ds_read_b64_tr_b16 v[54:55], v121 offset:11264
    s_waitcnt vmcnt(12) lgkmcnt(8)
    v_mfma_f32_32x32x16_bf16 v[0:15], v[32:35], v[140:143], v[0:15]
    v_mfma_f32_32x32x16_bf16 v[16:31], v[36:39], v[140:143], v[16:31]
    ds_read_b64_tr_b16 v[32:33], v120 offset:12288
    ds_read_b64_tr_b16 v[34:35], v120 offset:13312
    ds_read_b64_tr_b16 v[36:37], v121 offset:12288
    ds_read_b64_tr_b16 v[38:39], v121 offset:13312
    s_waitcnt vmcnt(11) lgkmcnt(8)
    v_mfma_f32_32x32x16_bf16 v[0:15], v[40:43], v[144:147], v[0:15]
    v_mfma_f32_32x32x16_bf16 v[16:31], v[44:47], v[144:147], v[16:31]
    ds_read_b64_tr_b16 v[40:41], v120 offset:14336
    ds_read_b64_tr_b16 v[42:43], v120 offset:15360
    ds_read_b64_tr_b16 v[44:45], v121 offset:14336
    ds_read_b64_tr_b16 v[46:47], v121 offset:15360
    s_waitcnt vmcnt(10) lgkmcnt(8)
    v_mfma_f32_32x32x16_bf16 v[0:15], v[48:51], v[148:151], v[0:15]
    v_mfma_f32_32x32x16_bf16 v[16:31], v[52:55], v[148:151], v[16:31]
    ds_read_b64_tr_b16 v[48:49], v120 offset:16384
    ds_read_b64_tr_b16 v[50:51], v120 offset:17408
    ds_read_b64_tr_b16 v[52:53], v121 offset:16384
    ds_read_b64_tr_b16 v[54:55], v121 offset:17408
    s_waitcnt vmcnt(9) lgkmcnt(8)
    v_mfma_f32_32x32x16_bf16 v[0:15], v[32:35], v[152:155], v[0:15]
    v_mfma_f32_32x32x16_bf16 v[16:31], v[36:39], v[152:155], v[16:31]
    ds_read_b64_tr_b16 v[32:33], v120 offset:18432
    ds_read_b64_tr_b16 v[34:35], v120 offset:19456
    ds_read_b64_tr_b16 v[36:37], v121 offset:18432
    ds_read_b64_tr_b16 v[38:39], v121 offset:19456
    s_waitcnt vmcnt(8) lgkmcnt(8)
    v_mfma_f32_32x32x16_bf16 v[0:15], v[40:43], v[156:159], v[0:15]
    v_mfma_f32_32x32x16_bf16 v[16:31], v[44:47], v[156:159], v[16:31]
    ds_read_b64_tr_b16 v[40:41], v120 offset:20480
    ds_read_b64_tr_b16 v[42:43], v120 offset:21504
    ds_read_b64_tr_b16 v[44:45], v121 offset:20480
    ds_read_b64_tr_b16 v[46:47], v121 offset:21504
    s_waitcnt vmcnt(7) lgkmcnt(8)
    v_mfma_f32_32x32x16_bf16 v[0:15], v[48:51], v[160:163], v[0:15]
    v_mfma_f32_32x32x16_bf16 v[16:31], v[52:55], v[160:163], v[16:31]
    ds_read_b64_tr_b16 v[48:49], v120 offset:22528
    ds_read_b64_tr_b16 v[50:51], v120 offset:23552
    ds_read_b64_tr_b16 v[52:53], v121 offset:22528
    ds_read_b64_tr_b16 v[54:55], v121 offset:23552
    s_waitcnt vmcnt(6) lgkmcnt(8)
    v_mfma_f32_32x32x16_bf16 v[0:15], v[32:35], v[164:167], v[0:15]
    v_mfma_f32_32x32x16_bf16 v[16:31], v[36:39], v[164:167], v[16:31]
    ds_read_b64_tr_b16 v[32:33], v120 offset:24576
    ds_read_b64_tr_b16 v[34:35], v120 offset:25600
    ds_read_b64_tr_b16 v[36:37], v121 offset:24576
    ds_read_b64_tr_b16 v[38:39], v121 offset:25600
    s_waitcnt vmcnt(5) lgkmcnt(8)
    v_mfma_f32_32x32x16_bf16 v[0:15], v[40:43], v[168:171], v[0:15]
    v_mfma_f32_32x32x16_bf16 v[16:31], v[44:47], v[168:171], v[16:31]
    ds_read_b64_tr_b16 v[40:41], v120 offset:26624
    ds_read_b64_tr_b16 v[42:43], v120 offset:27648
    ds_read_b64_tr_b16 v[44:45], v121 offset:26624
    ds_read_b64_tr_b16 v[46:47], v121 offset:27648
    s_waitcnt vmcnt(4) lgkmcnt(8)
    v_mfma_f32_32x32x16_bf16 v[0:15], v[48:51], v[172:175], v[0:15]
    v_mfma_f32_32x32x16_bf16 v[16:31], v[52:55], v[172:175], v[16:31]
    ds_read_b64_tr_b16 v[48:49], v120 offset:28672
    ds_read_b64_tr_b16 v[50:51], v120 offset:29696
    ds_read_b64_tr_b16 v[52:53], v121 offset:28672
    ds_read_b64_tr_b16 v[54:55], v121 offset:29696
    s_waitcnt vmcnt(3) lgkmcnt(8)
    s_mov_b64 exec, 1
    ds_add_u32 v60, v61
    s_mov_b64 exec, -1
    s_nop 2
    v_mfma_f32_32x32x16_bf16 v[0:15], v[32:35], v[176:179], v[0:15]
    v_mfma_f32_32x32x16_bf16 v[16:31], v[36:39], v[176:179], v[16:31]
    ds_read_b64_tr_b16 v[32:33], v120 offset:30720
    ds_read_b64_tr_b16 v[34:35], v120 offset:31744
    ds_read_b64_tr_b16 v[36:37], v121 offset:30720
    ds_read_b64_tr_b16 v[38:39], v121 offset:31744
    s_waitcnt vmcnt(2) lgkmcnt(9)
    v_mfma_f32_32x32x16_bf16 v[0:15], v[40:43], v[180:183], v[0:15]
    v_mfma_f32_32x32x16_bf16 v[16:31], v[44:47], v[180:183], v[16:31]
    ds_read_b32 v61, v60
    s_waitcnt vmcnt(1) lgkmcnt(5)
    v_mfma_f32_32x32x16_bf16 v[0:15], v[48:51], v[184:187], v[0:15]
    v_mfma_f32_32x32x16_bf16 v[16:31], v[52:55], v[184:187], v[16:31]
    s_waitcnt vmcnt(0) lgkmcnt(0)
    v_mfma_f32_32x32x16_bf16 v[0:15], v[32:35], v[188:191], v[0:15]
    v_mfma_f32_32x32x16_bf16 v[16:31], v[36:39], v[188:191], v[16:31]
    v_cmp_ne_u32 vcc, 2, v61
    s_cbranch_vccz mk_ss_ok
    s_nop 0
    s_mov_b32 s59, 32000
mk_ss:
    ds_read_b32 v61, v60
    s_waitcnt lgkmcnt(0)
    v_cmp_ne_u32 vcc, 2, v61
    s_cbranch_vccz mk_ss_ok
    s_sleep 0
    s_sub_u32 s59, s59, 1
    s_cmp_lg_u32 s59, 0
    s_cbranch_scc1 mk_ss
mk_ss_ok:
    s_nop 8
    ds_write_b128 v62, v[0:3] offset:0
    ds_write_b128 v62, v[4:7] offset:1088
    ds_write_b128 v62, v[8:11] offset:2176
    ds_write_b128 v62, v[12:15] offset:3264
    ds_write_b128 v62, v[16:19] offset:4352
    ds_write_b128 v62, v[20:23] offset:5440
    ds_write_b128 v62, v[24:27] offset:6528
    ds_write_b128 v62, v[28:31] offset:7616
    s_waitcnt lgkmcnt(0)
    s_barrier
    ds_read_b128 v[128:131], v68 offset:0
    ds_read_b128 v[132:135], v68 offset:512
    ds_read_b128 v[136:139], v69 offset:0
    ds_read_b128 v[140:143], v69 offset:512
    ds_read_b128 v[144:147], v70 offset:0
    ds_read_b128 v[148:151], v70 offset:512
    ds_read_b128 v[152:155], v71 offset:0
    ds_read_b128 v[156:159], v71 offset:512
    ds_read_b128 v[160:163], v65 offset:0
    ds_read_b128 v[164:167], v65 offset:512
    ds_read_b128 v[168:171], v65 offset:32768
    ds_read_b128 v[172:175], v65 offset:33280
    s_waitcnt lgkmcnt(8)
    v_pk_add_f32 v[128:129], v[128:129], v[136:137]
    v_pk_add_f32 v[130:131], v[130:131], v[138:139]
    v_pk_add_f32 v[132:133], v[132:133], v[140:141]
    v_pk_add_f32 v[134:135], v[134:135], v[142:143]
    s_waitcnt lgkmcnt(4)
    v_pk_add_f32 v[144:145], v[144:145], v[152:153]
    v_pk_add_f32 v[146:147], v[146:147], v[154:155]
    v_pk_add_f32 v[148:149], v[148:149], v[156:157]
    v_pk_add_f32 v[150:151], v[150:151], v[158:159]
    v_pk_add_f32 v[128:129], v[128:129], v[144:145]
    v_pk_add_f32 v[130:131], v[130:131], v[146:147]
    v_pk_add_f32 v[132:133], v[132:133], v[148:149]
    v_pk_add_f32 v[134:135], v[134:135], v[150:151]
    v_mul_f32 v136, 0xbfb8aa3b, v128
    v_mul_f32 v137, 0xbfb8aa3b, v129
    v_mul_f32 v138, 0xbfb8aa3b, v130
    v_mul_f32 v139, 0xbfb8aa3b, v131
    v_mul_f32 v140, 0xbfb8aa3b, v132
    v_mul_f32 v141, 0xbfb8aa3b, v133
    v_mul_f32 v142, 0xbfb8aa3b, v134
    v_mul_f32 v143, 0xbfb8aa3b, v135
    v_exp_f32 v136, v136
    v_exp_f32 v137, v137
    v_exp_f32 v138, v138
    v_exp_f32 v139, v139
    v_exp_f32 v140, v140
    v_exp_f32 v141, v141
    v_exp_f32 v142, v142
    v_exp_f32 v143, v143
    s_waitcnt vmcnt(0) lgkmcnt(0)
    v_pk_add_f32 v[160:161], v[160:161], v[168:169]
    v_pk_add_f32 v[162:163], v[162:163], v[170:171]
    v_pk_add_f32 v[164:165], v[164:165], v[172:173]
    v_pk_add_f32 v[166:167], v[166:167], v[174:175]
    v_add_f32 v136, 1.0, v136
    v_add_f32 v137, 1.0, v137
    v_add_f32 v138, 1.0, v138
    v_add_f32 v139, 1.0, v139
    v_add_f32 v140, 1.0, v140
    v_add_f32 v141, 1.0, v141
    v_add_f32 v142, 1.0, v142
    v_add_f32 v143, 1.0, v143
    v_rcp_f32 v136, v136
    v_rcp_f32 v137, v137
    v_rcp_f32 v138, v138
    v_rcp_f32 v139, v139
    v_rcp_f32 v140, v140
    v_rcp_f32 v141, v141
    v_rcp_f32 v142, v142
    v_rcp_f32 v143, v143
    v_mul_f32 v128, v128, v160
    v_mul_f32 v129, v129, v161
    v_mul_f32 v130, v130, v162
    v_mul_f32 v131, v131, v163
    v_mul_f32 v132, v132, v164
    v_mul_f32 v133, v133, v165
    v_mul_f32 v134, v134, v166
    v_mul_f32 v135, v135, v167
    v_lshlrev_b32 v144, 16, v72
    v_and_b32 v145, 0xffff0000, v72
    v_lshlrev_b32 v146, 16, v73
    v_and_b32 v147, 0xffff0000, v73
    v_lshlrev_b32 v148, 16, v74
    v_and_b32 v149, 0xffff0000, v74
    v_lshlrev_b32 v150, 16, v75
    v_and_b32 v151, 0xffff0000, v75
    v_fma_f32 v128, v128, v136, v144
    v_fma_f32 v129, v129, v137, v145
    v_fma_f32 v130, v130, v138, v146
    v_fma_f32 v131, v131, v139, v147
    v_fma_f32 v132, v132, v140, v148
    v_fma_f32 v133, v133, v141, v149
    v_fma_f32 v134, v134, v142, v150
    v_fma_f32 v135, v135, v143, v151
    v_cvt_pk_bf16_f32 v136, v128, v129
    v_cvt_pk_bf16_f32 v137, v130, v131
    v_cvt_pk_bf16_f32 v138, v132, v133
    v_cvt_pk_bf16_f32 v139, v134, v135
    buffer_store_dwordx4 v[136:139], v64, s[44:47], 0 offen
    s_endpgm
mk_f0_slow:
    v_mov_b32 v96, 0xff800000
    v_mov_b32 v97, 0xff800000
    s_nop 7
    s_cmp_eq_u32 s72, 2
    s_cbranch_scc1 mk_f0_p1e2
    s_cmp_eq_u32 s72, 4
    s_cbranch_scc1 mk_f0_p1e4
    s_cmp_eq_u32 s72, 6
    s_cbranch_scc1 mk_f0_p1e6
    s_cmp_eq_u32 s72, 8
    s_cbranch_scc1 mk_f0_p1e8
    v_mfma_f32_32x32x16_bf16 v[0:15], v[136:139], v[128:131], v[64:79]
    v_mfma_f32_32x32x16_bf16 v[16:31], v[140:143], v[128:131], 0
    s_nop 9
mk_f0_p1_0:
    v_mfma_f32_32x32x16_bf16 v[32:47], v[144:147], v[128:131], 0
    v_max3_f32 v96, v0, v1, v96
    v_max3_f32 v97, v2, v3, v97
    v_max3_f32 v96, v4, v5, v96
    v_max3_f32 v97, v6, v7, v97
    v_max3_f32 v96, v8, v9, v96
    v_max3_f32 v97, v10, v11, v97
    v_max3_f32 v96, v12, v13, v96
    v_max3_f32 v97, v14, v15, v97
mk_f0_p1_1:
    v_mfma_f32_32x32x16_bf16 v[0:15], v[148:151], v[128:131], 0
    v_max3_f32 v96, v16, v17, v96
    v_max3_f32 v97, v18, v19, v97
    v_max3_f32 v96, v20, v21, v96
    v_max3_f32 v97, v22, v23, v97
    v_max3_f32 v96, v24, v25, v96
    v_max3_f32 v97, v26, v27, v97
    v_max3_f32 v96, v28, v29, v96
    v_max3_f32 v97, v30, v31, v97
mk_f0_p1_2:
    v_mfma_f32_32x32x16_bf16 v[16:31], v[152:155], v[128:131], 0
    v_max3_f32 v96, v32, v33, v96
    v_max3_f32 v97, v34, v35, v97
    v_max3_f32 v96, v36, v37, v96
    v_max3_f32 v97, v38, v39, v97
    v_max3_f32 v96, v40, v41, v96
    v_max3_f32 v97, v42, v43, v97
    v_max3_f32 v96, v44, v45, v96
    v_max3_f32 v97, v46, v47, v97
mk_f0_p1_3:
    v_mfma_f32_32x32x16_bf16 v[32:47], v[156:159], v[128:131], 0
    v_max3_f32 v96, v0, v1, v96
    v_max3_f32 v97, v2, v3, v97
    v_max3_f32 v96, v4, v5, v96
    v_max3_f32 v97, v6, v7, v97
    v_max3_f32 v96, v8, v9, v96
    v_max3_f32 v97, v10, v11, v97
    v_max3_f32 v96, v12, v13, v96
    v_max3_f32 v97, v14, v15, v97
mk_f0_p1_4:
    v_mfma_f32_32x32x16_bf16 v[0:15], v[160:163], v[128:131], 0
    v_max3_f32 v96, v16, v17, v96
    v_max3_f32 v97, v18, v19, v97
    v_max3_f32 v96, v20, v21, v96
    v_max3_f32 v97, v22, v23, v97
    v_max3_f32 v96, v24, v25, v96
    v_max3_f32 v97, v26, v27, v97
    v_max3_f32 v96, v28, v29, v96
    v_max3_f32 v97, v30, v31, v97
mk_f0_p1_5:
    v_mfma_f32_32x32x16_bf16 v[16:31], v[164:167], v[128:131], 0
    v_max3_f32 v96, v32, v33, v96
    v_max3_f32 v97, v34, v35, v97
    v_max3_f32 v96, v36, v37, v96
    v_max3_f32 v97, v38, v39, v97
    v_max3_f32 v96, v40, v41, v96
    v_max3_f32 v97, v42, v43, v97
    v_max3_f32 v96, v44, v45, v96
    v_max3_f32 v97, v46, v47, v97
mk_f0_p1_6:
    v_mfma_f32_32x32x16_bf16 v[32:47], v[168:171], v[128:131], v[48:63]
    v_max3_f32 v96, v0, v1, v96
    v_max3_f32 v97, v2, v3, v97
    v_max3_f32 v96, v4, v5, v96
    v_max3_f32 v97, v6, v7, v97
    v_max3_f32 v96, v8, v9, v96
    v_max3_f32 v97, v10, v11, v97
    v_max3_f32 v96, v12, v13, v96
    v_max3_f32 v97, v14, v15, v97
mk_f0_p1_7:
    s_nop 3
    v_max3_f32 v96, v16, v17, v96
    v_max3_f32 v97, v18, v19, v97
    v_max3_f32 v96, v20, v21, v96
    v_max3_f32 v97, v22, v23, v97
    v_max3_f32 v96, v24, v25, v96
    v_max3_f32 v97, v26, v27, v97
    v_max3_f32 v96, v28, v29, v96
    v_max3_f32 v97, v30, v31, v97
mk_f0_p1_8:
    s_nop 3
    v_max3_f32 v96, v32, v33, v96
    v_max3_f32 v97, v34, v35, v97
    v_max3_f32 v96, v36, v37, v96
    v_max3_f32 v97, v38, v39, v97
    v_max3_f32 v96, v40, v41, v96
    v_max3_f32 v97, v42, v43, v97
    v_max3_f32 v96, v44, v45, v96
    v_max3_f32 v97, v46, v47, v97
    v_max_f32 v96, v96, v97
    v_mov_b32 v97, v96
    s_nop 1
    v_permlane32_swap_b32 v96, v97
    v_max_f32 v96, v96, v97
    v_sub_f32 v80, 0, v96
    v_sub_f32 v81, 0, v96
    v_sub_f32 v82, 0, v96
    v_sub_f32 v83, 0, v96
    v_sub_f32 v84, 0, v96
    v_sub_f32 v85, 0, v96
    v_sub_f32 v86, 0, v96
    v_sub_f32 v87, 0, v96
    v_sub_f32 v88, 0, v96
    v_sub_f32 v89, 0, v96
    v_sub_f32 v90, 0, v96
    v_sub_f32 v91, 0, v96
    v_sub_f32 v92, 0, v96
    v_sub_f32 v93, 0, v96
    v_sub_f32 v94, 0, v96
    v_sub_f32 v95, 0, v96
    v_mov_b32 v32, 0
    v_mov_b32 v33, 0
    v_mov_b32 v34, 0
    v_mov_b32 v35, 0
    v_mov_b32 v36, 0
    v_mov_b32 v37, 0
    v_mov_b32 v38, 0
    v_mov_b32 v39, 0
    v_mov_b32 v40, 0
    v_mov_b32 v41, 0
    v_mov_b32 v42, 0
    v_mov_b32 v43, 0
    v_mov_b32 v44, 0
    v_mov_b32 v45, 0
    v_mov_b32 v46, 0
    v_mov_b32 v47, 0
    s_cmp_eq_u32 s72, 2
    s_cbranch_scc1 mk_f0_p2_e2
    s_cmp_eq_u32 s72, 4
    s_cbranch_scc1 mk_f0_p2_e4
    s_cmp_eq_u32 s72, 6
    s_cbranch_scc1 mk_f0_p2_e6
    s_cmp_eq_u32 s72, 8
    s_cbranch_scc1 mk_f0_p2_e8
    v_sub_f32 v0, v64, v96
    v_sub_f32 v1, v65, v96
    v_sub_f32 v2, v66, v96
    v_sub_f32 v3, v67, v96
    v_sub_f32 v4, v68, v96
    v_sub_f32 v5, v69, v96
    v_sub_f32 v6, v70, v96
    v_sub_f32 v7, v71, v96
    v_sub_f32 v8, v72, v96
    v_sub_f32 v9, v73, v96
    v_sub_f32 v10, v74, v96
    v_sub_f32 v11, v75, v96
    v_sub_f32 v12, v76, v96
    v_sub_f32 v13, v77, v96
    v_sub_f32 v14, v78, v96
    v_sub_f32 v15, v79, v96
    s_nop 1
    v_mfma_f32_32x32x16_bf16 v[0:15], v[136:139], v[128:131], v[0:15]
    s_nop 11
mk_f0_p2_0:
    v_exp_f32 v0, v0
    v_exp_f32 v1, v1
    v_mfma_f32_32x32x16_bf16 v[16:31], v[140:143], v[128:131], v[80:95]
    v_exp_f32 v2, v2
    v_exp_f32 v3, v3
    v_exp_f32 v4, v4
    v_exp_f32 v5, v5
    v_exp_f32 v6, v6
    v_exp_f32 v7, v7
    v_exp_f32 v8, v8
    v_cvt_pk_bf16_f32 v0, v0, v1
    v_exp_f32 v9, v9
    v_cvt_pk_bf16_f32 v1, v2, v3
    v_exp_f32 v10, v10
    v_cvt_pk_bf16_f32 v2, v4, v5
    v_exp_f32 v11, v11
    v_cvt_pk_bf16_f32 v3, v6, v7
    v_exp_f32 v12, v12
    v_exp_f32 v13, v13
    v_exp_f32 v14, v14
    v_exp_f32 v15, v15
    v_mfma_f32_32x32x16_bf16 v[32:47], v[176:179], v[0:3], v[32:47]
    v_cvt_pk_bf16_f32 v4, v8, v9
    v_cvt_pk_bf16_f32 v5, v10, v11
    v_cvt_pk_bf16_f32 v6, v12, v13
    v_cvt_pk_bf16_f32 v7, v14, v15
    v_exp_f32 v16, v16
    v_exp_f32 v17, v17
    v_mfma_f32_32x32x16_bf16 v[32:47], v[216:219], v[4:7], v[32:47]
mk_f0_p2_1x:
    v_mfma_f32_32x32x16_bf16 v[0:15], v[144:147], v[128:131], v[80:95]
    v_exp_f32 v18, v18
    v_exp_f32 v19, v19
    v_exp_f32 v20, v20
    v_exp_f32 v21, v21
    v_exp_f32 v22, v22
    v_exp_f32 v23, v23
    v_exp_f32 v24, v24
    v_cvt_pk_bf16_f32 v16, v16, v17
    v_exp_f32 v25, v25
    v_cvt_pk_bf16_f32 v17, v18, v19
    v_exp_f32 v26, v26
    v_cvt_pk_bf16_f32 v18, v20, v21
    v_exp_f32 v27, v27
    v_cvt_pk_bf16_f32 v19, v22, v23
    v_exp_f32 v28, v28
    v_exp_f32 v29, v29
    v_exp_f32 v30, v30
    v_exp_f32 v31, v31
    v_mfma_f32_32x32x16_bf16 v[32:47], v[180:183], v[16:19], v[32:47]
    v_cvt_pk_bf16_f32 v20, v24, v25
    v_cvt_pk_bf16_f32 v21, v26, v27
    v_cvt_pk_bf16_f32 v22, v28, v29
    v_cvt_pk_bf16_f32 v23, v30, v31
    v_exp_f32 v0, v0
    v_exp_f32 v1, v1
    v_mfma_f32_32x32x16_bf16 v[32:47], v[220:223], v[20:23], v[32:47]
mk_f0_p2_2x:
    v_mfma_f32_32x32x16_bf16 v[16:31], v[148:151], v[128:131], v[80:95]
    v_exp_f32 v2, v2
    v_exp_f32 v3, v3
    v_exp_f32 v4, v4
    v_exp_f32 v5, v5
    v_exp_f32 v6, v6
    v_exp_f32 v7, v7
    v_exp_f32 v8, v8
    v_cvt_pk_bf16_f32 v0, v0, v1
    v_exp_f32 v9, v9
    v_cvt_pk_bf16_f32 v1, v2, v3
    v_exp_f32 v10, v10
    v_cvt_pk_bf16_f32 v2, v4, v5
    v_exp_f32 v11, v11
    v_cvt_pk_bf16_f32 v3, v6, v7
    v_exp_f32 v12, v12
    v_exp_f32 v13, v13
    v_exp_f32 v14, v14
    v_exp_f32 v15, v15
    v_mfma_f32_32x32x16_bf16 v[32:47], v[184:187], v[0:3], v[32:47]
    v_cvt_pk_bf16_f32 v4, v8, v9
    v_cvt_pk_bf16_f32 v5, v10, v11
    v_cvt_pk_bf16_f32 v6, v12, v13
    v_cvt_pk_bf16_f32 v7, v14, v15
    v_exp_f32 v16, v16
    v_exp_f32 v17, v17
    v_mfma_f32_32x32x16_bf16 v[32:47], v[224:227], v[4:7], v[32:47]
mk_f0_p2_3x:
    v_mfma_f32_32x32x16_bf16 v[0:15], v[152:155], v[128:131], v[80:95]
    v_exp_f32 v18, v18
    v_exp_f32 v19, v19
    v_exp_f32 v20, v20
    v_exp_f32 v21, v21
    v_exp_f32 v22, v22
    v_exp_f32 v23, v23
    v_exp_f32 v24, v24
    v_cvt_pk_bf16_f32 v16, v16, v17
    v_exp_f32 v25, v25
    v_cvt_pk_bf16_f32 v17, v18, v19
    v_exp_f32 v26, v26
    v_cvt_pk_bf16_f32 v18, v20, v21
    v_exp_f32 v27, v27
    v_cvt_pk_bf16_f32 v19, v22, v23
    v_exp_f32 v28, v28
    v_exp_f32 v29, v29
    v_exp_f32 v30, v30
    v_exp_f32 v31, v31
    v_mfma_f32_32x32x16_bf16 v[32:47], v[188:191], v[16:19], v[32:47]
    v_cvt_pk_bf16_f32 v20, v24, v25
    v_cvt_pk_bf16_f32 v21, v26, v27
    v_cvt_pk_bf16_f32 v22, v28, v29
    v_cvt_pk_bf16_f32 v23, v30, v31
    v_exp_f32 v0, v0
    v_exp_f32 v1, v1
    v_mfma_f32_32x32x16_bf16 v[32:47], v[228:231], v[20:23], v[32:47]
mk_f0_p2_4x:
    v_mfma_f32_32x32x16_bf16 v[16:31], v[156:159], v[128:131], v[80:95]
    v_exp_f32 v2, v2
    v_exp_f32 v3, v3
    v_exp_f32 v4, v4
    v_exp_f32 v5, v5
    v_exp_f32 v6, v6
    v_exp_f32 v7, v7
    v_exp_f32 v8, v8
    v_cvt_pk_bf16_f32 v0, v0, v1
    v_exp_f32 v9, v9
    v_cvt_pk_bf16_f32 v1, v2, v3
    v_exp_f32 v10, v10
    v_cvt_pk_bf16_f32 v2, v4, v5
    v_exp_f32 v11, v11
    v_cvt_pk_bf16_f32 v3, v6, v7
    v_exp_f32 v12, v12
    v_exp_f32 v13, v13
    v_exp_f32 v14, v14
    v_exp_f32 v15, v15
    v_mfma_f32_32x32x16_bf16 v[32:47], v[192:195], v[0:3], v[32:47]
    v_cvt_pk_bf16_f32 v4, v8, v9
    v_cvt_pk_bf16_f32 v5, v10, v11
    v_cvt_pk_bf16_f32 v6, v12, v13
    v_cvt_pk_bf16_f32 v7, v14, v15
    v_exp_f32 v16, v16
    v_exp_f32 v17, v17
    v_mfma_f32_32x32x16_bf16 v[32:47], v[232:235], v[4:7], v[32:47]
mk_f0_p2_5x:
    v_mfma_f32_32x32x16_bf16 v[0:15], v[160:163], v[128:131], v[80:95]
    v_exp_f32 v18, v18
    v_exp_f32 v19, v19
    v_exp_f32 v20, v20
    v_exp_f32 v21, v21
    v_exp_f32 v22, v22
    v_exp_f32 v23, v23
    v_exp_f32 v24, v24
    v_cvt_pk_bf16_f32 v16, v16, v17
    v_exp_f32 v25, v25
    v_cvt_pk_bf16_f32 v17, v18, v19
    v_exp_f32 v26, v26
    v_cvt_pk_bf16_f32 v18, v20, v21
    v_exp_f32 v27, v27
    v_cvt_pk_bf16_f32 v19, v22, v23
    v_exp_f32 v28, v28
    v_exp_f32 v29, v29
    v_exp_f32 v30, v30
    v_exp_f32 v31, v31
    v_mfma_f32_32x32x16_bf16 v[32:47], v[196:199], v[16:19], v[32:47]
    v_cvt_pk_bf16_f32 v20, v24, v25
    v_cvt_pk_bf16_f32 v21, v26, v27
    v_cvt_pk_bf16_f32 v22, v28, v29
    v_cvt_pk_bf16_f32 v23, v30, v31
    v_exp_f32 v0, v0
    v_exp_f32 v1, v1
    v_mfma_f32_32x32x16_bf16 v[32:47], v[236:239], v[20:23], v[32:47]
mk_f0_p2_6x:
    v_mfma_f32_32x32x16_bf16 v[16:31], v[164:167], v[128:131], v[80:95]
    v_exp_f32 v2, v2
    v_exp_f32 v3, v3
    v_exp_f32 v4, v4
    v_exp_f32 v5, v5
    v_exp_f32 v6, v6
    v_exp_f32 v7, v7
    v_exp_f32 v8, v8
    v_cvt_pk_bf16_f32 v0, v0, v1
    v_exp_f32 v9, v9
    v_cvt_pk_bf16_f32 v1, v2, v3
    v_exp_f32 v10, v10
    v_cvt_pk_bf16_f32 v2, v4, v5
    v_exp_f32 v11, v11
    v_cvt_pk_bf16_f32 v3, v6, v7
    v_exp_f32 v12, v12
    v_exp_f32 v13, v13
    v_exp_f32 v14, v14
    v_exp_f32 v15, v15
    v_mfma_f32_32x32x16_bf16 v[32:47], v[200:203], v[0:3], v[32:47]
    v_cvt_pk_bf16_f32 v4, v8, v9
    v_cvt_pk_bf16_f32 v5, v10, v11
    v_cvt_pk_bf16_f32 v6, v12, v13
    v_cvt_pk_bf16_f32 v7, v14, v15
    v_exp_f32 v16, v16
    v_exp_f32 v17, v17
    v_mfma_f32_32x32x16_bf16 v[32:47], v[240:243], v[4:7], v[32:47]
mk_f0_p2_7x:
    v_sub_f32 v0, v48, v96
    v_sub_f32 v1, v49, v96
    v_sub_f32 v2, v50, v96
    v_sub_f32 v3, v51, v96
    v_sub_f32 v4, v52, v96
    v_sub_f32 v5, v53, v96
    v_sub_f32 v6, v54, v96
    v_sub_f32 v7, v55, v96
    v_sub_f32 v8, v56, v96
    v_sub_f32 v9, v57, v96
    v_sub_f32 v10, v58, v96
    v_sub_f32 v11, v59, v96
    v_sub_f32 v12, v60, v96
    v_sub_f32 v13, v61, v96
    v_sub_f32 v14, v62, v96
    v_sub_f32 v15, v63, v96
    s_nop 1
    v_mfma_f32_32x32x16_bf16 v[0:15], v[168:171], v[128:131], v[0:15]
    v_exp_f32 v18, v18
    v_exp_f32 v19, v19
    v_exp_f32 v20, v20
    v_exp_f32 v21, v21
    v_exp_f32 v22, v22
    v_exp_f32 v23, v23
    v_exp_f32 v24, v24
    v_cvt_pk_bf16_f32 v16, v16, v17
    v_exp_f32 v25, v25
    v_cvt_pk_bf16_f32 v17, v18, v19
    v_exp_f32 v26, v26
    v_cvt_pk_bf16_f32 v18, v20, v21
    v_exp_f32 v27, v27
    v_cvt_pk_bf16_f32 v19, v22, v23
    v_exp_f32 v28, v28
    v_exp_f32 v29, v29
    v_exp_f32 v30, v30
    v_exp_f32 v31, v31
    v_mfma_f32_32x32x16_bf16 v[32:47], v[204:207], v[16:19], v[32:47]
    v_cvt_pk_bf16_f32 v20, v24, v25
    v_cvt_pk_bf16_f32 v21, v26, v27
    v_cvt_pk_bf16_f32 v22, v28, v29
    v_cvt_pk_bf16_f32 v23, v30, v31
    v_exp_f32 v0, v0
    v_exp_f32 v1, v1
    v_mfma_f32_32x32x16_bf16 v[32:47], v[244:247], v[20:23], v[32:47]
mk_f0_p2_8x:
    v_exp_f32 v2, v2
    v_exp_f32 v3, v3
    v_exp_f32 v4, v4
    v_exp_f32 v5, v5
    v_exp_f32 v6, v6
    v_exp_f32 v7, v7
    v_exp_f32 v8, v8
    v_cvt_pk_bf16_f32 v0, v0, v1
    v_exp_f32 v9, v9
    v_cvt_pk_bf16_f32 v1, v2, v3
    v_exp_f32 v10, v10
    v_cvt_pk_bf16_f32 v2, v4, v5
    v_exp_f32 v11, v11
    v_cvt_pk_bf16_f32 v3, v6, v7
    v_exp_f32 v12, v12
    v_exp_f32 v13, v13
    v_exp_f32 v14, v14
    v_exp_f32 v15, v15
    v_mfma_f32_32x32x16_bf16 v[32:47], v[208:211], v[0:3], v[32:47]
    v_cvt_pk_bf16_f32 v4, v8, v9
    v_cvt_pk_bf16_f32 v5, v10, v11
    v_cvt_pk_bf16_f32 v6, v12, v13
    v_cvt_pk_bf16_f32 v7, v14, v15
    s_nop 1
    v_mfma_f32_32x32x16_bf16 v[32:47], v[248:251], v[4:7], v[32:47]
    s_branch mk_f0_p2t
mk_f0_p2_e2:
    v_mfma_f32_32x32x16_bf16 v[0:15], v[144:147], v[128:131], v[80:95]
    s_nop 11
    v_exp_f32 v0, v0
    v_exp_f32 v1, v1
    s_branch mk_f0_p2_2x
mk_f0_p2_e4:
    v_mfma_f32_32x32x16_bf16 v[0:15], v[152:155], v[128:131], v[80:95]
    s_nop 11
    v_exp_f32 v0, v0
    v_exp_f32 v1, v1
    s_branch mk_f0_p2_4x
mk_f0_p2_e6:
    v_mfma_f32_32x32x16_bf16 v[0:15], v[160:163], v[128:131], v[80:95]
    s_nop 11
    v_exp_f32 v0, v0
    v_exp_f32 v1, v1
    s_branch mk_f0_p2_6x
mk_f0_p2_e8:
    v_sub_f32 v0, v48, v96
    v_sub_f32 v1, v49, v96
    v_sub_f32 v2, v50, v96
    v_sub_f32 v3, v51, v96
    v_sub_f32 v4, v52, v96
    v_sub_f32 v5, v53, v96
    v_sub_f32 v6, v54, v96
    v_sub_f32 v7, v55, v96
    v_sub_f32 v8, v56, v96
    v_sub_f32 v9, v57, v96
    v_sub_f32 v10, v58, v96
    v_sub_f32 v11, v59, v96
    v_sub_f32 v12, v60, v96
    v_sub_f32 v13, v61, v96
    v_sub_f32 v14, v62, v96
    v_sub_f32 v15, v63, v96
    s_nop 1
    v_mfma_f32_32x32x16_bf16 v[0:15], v[168:171], v[128:131], v[0:15]
    s_nop 11
    v_exp_f32 v0, v0
    v_exp_f32 v1, v1
    s_branch mk_f0_p2_8x
mk_f0_p1e2:
    v_mfma_f32_32x32x16_bf16 v[32:47], v[144:147], v[128:131], 0
    v_mfma_f32_32x32x16_bf16 v[0:15], v[148:151], v[128:131], 0
    s_nop 10
    s_branch mk_f0_p1_2
mk_f0_p1e4:
    v_mfma_f32_32x32x16_bf16 v[16:31], v[152:155], v[128:131], 0
    v_mfma_f32_32x32x16_bf16 v[32:47], v[156:159], v[128:131], 0
    s_nop 10
    s_branch mk_f0_p1_4
mk_f0_p1e6:
    v_mfma_f32_32x32x16_bf16 v[0:15], v[160:163], v[128:131], 0
    v_mfma_f32_32x32x16_bf16 v[16:31], v[164:167], v[128:131], 0
    s_nop 10
    s_branch mk_f0_p1_6
mk_f0_p1e8:
    v_mfma_f32_32x32x16_bf16 v[32:47], v[168:171], v[128:131], v[48:63]
    s_nop 10
    s_branch mk_f0_p1_8
mk_f0_p2t:
    s_nop 11
    v_rcp_f32 v97, v40
    v_mov_b32 v80, 0
    v_mov_b32 v81, 0
    v_mov_b32 v82, 0
    v_mov_b32 v83, 0
    v_mov_b32 v84, 0
    v_mov_b32 v85, 0
    v_mov_b32 v86, 0
    v_mov_b32 v87, 0
    v_mov_b32 v88, 0
    v_mov_b32 v89, 0
    v_mov_b32 v90, 0
    v_mov_b32 v91, 0
    v_mov_b32 v92, 0
    v_mov_b32 v93, 0
    v_mov_b32 v94, 0
    v_mov_b32 v95, 0
    s_branch mk_f0_fin
mk_f1_slow:
    v_mov_b32 v96, 0xff800000
    v_mov_b32 v97, 0xff800000
    s_nop 7
    s_cmp_eq_u32 s72, 2
    s_cbranch_scc1 mk_f1_p1e1
    s_cmp_eq_u32 s72, 4
    s_cbranch_scc1 mk_f1_p1e3
    s_cmp_eq_u32 s72, 6
    s_cbranch_scc1 mk_f1_p1e5
    s_cmp_eq_u32 s72, 8
    s_cbranch_scc1 mk_f1_p1e7
    v_mfma_f32_32x32x16_bf16 v[0:15], v[140:143], v[132:135], v[64:79]
    v_mfma_f32_32x32x16_bf16 v[16:31], v[144:147], v[132:135], 0
    s_nop 9
mk_f1_p1_0:
    v_mfma_f32_32x32x16_bf16 v[80:95], v[148:151], v[132:135], 0
    v_max3_f32 v96, v0, v1, v96
    v_max3_f32 v97, v2, v3, v97
    v_max3_f32 v96, v4, v5, v96
    v_max3_f32 v97, v6, v7, v97
    v_max3_f32 v96, v8, v9, v96
    v_max3_f32 v97, v10, v11, v97
    v_max3_f32 v96, v12, v13, v96
    v_max3_f32 v97, v14, v15, v97
mk_f1_p1_1:
    v_mfma_f32_32x32x16_bf16 v[0:15], v[152:155], v[132:135], 0
    v_max3_f32 v96, v16, v17, v96
    v_max3_f32 v97, v18, v19, v97
    v_max3_f32 v96, v20, v21, v96
    v_max3_f32 v97, v22, v23, v97
    v_max3_f32 v96, v24, v25, v96
    v_max3_f32 v97, v26, v27, v97
    v_max3_f32 v96, v28, v29, v96
    v_max3_f32 v97, v30, v31, v97
mk_f1_p1_2:
    v_mfma_f32_32x32x16_bf16 v[16:31], v[156:159], v[132:135], 0
    v_max3_f32 v96, v80, v81, v96
    v_max3_f32 v97, v82, v83, v97
    v_max3_f32 v96, v84, v85, v96
    v_max3_f32 v97, v86, v87, v97
    v_max3_f32 v96, v88, v89, v96
    v_max3_f32 v97, v90, v91, v97
    v_max3_f32 v96, v92, v93, v96
    v_max3_f32 v97, v94, v95, v97
mk_f1_p1_3:
    v_mfma_f32_32x32x16_bf16 v[80:95], v[160:163], v[132:135], 0
    v_max3_f32 v96, v0, v1, v96
    v_max3_f32 v97, v2, v3, v97
    v_max3_f32 v96, v4, v5, v96
    v_max3_f32 v97, v6, v7, v97
    v_max3_f32 v96, v8, v9, v96
    v_max3_f32 v97, v10, v11, v97
    v_max3_f32 v96, v12, v13, v96
    v_max3_f32 v97, v14, v15, v97
mk_f1_p1_4:
    v_mfma_f32_32x32x16_bf16 v[0:15], v[164:167], v[132:135], 0
    v_max3_f32 v96, v16, v17, v96
    v_max3_f32 v97, v18, v19, v97
    v_max3_f32 v96, v20, v21, v96
    v_max3_f32 v97, v22, v23, v97
    v_max3_f32 v96, v24, v25, v96
    v_max3_f32 v97, v26, v27, v97
    v_max3_f32 v96, v28, v29, v96
    v_max3_f32 v97, v30, v31, v97
mk_f1_p1_5:
    v_mfma_f32_32x32x16_bf16 v[16:31], v[168:171], v[132:135], 0
    v_max3_f32 v96, v80, v81, v96
    v_max3_f32 v97, v82, v83, v97
    v_max3_f32 v96, v84, v85, v96
    v_max3_f32 v97, v86, v87, v97
    v_max3_f32 v96, v88, v89, v96
    v_max3_f32 v97, v90, v91, v97
    v_max3_f32 v96, v92, v93, v96
    v_max3_f32 v97, v94, v95, v97
mk_f1_p1_6:
    v_mfma_f32_32x32x16_bf16 v[80:95], v[172:175], v[132:135], v[48:63]
    v_max3_f32 v96, v0, v1, v96
    v_max3_f32 v97, v2, v3, v97
    v_max3_f32 v96, v4, v5, v96
    v_max3_f32 v97, v6, v7, v97
    v_max3_f32 v96, v8, v9, v96
    v_max3_f32 v97, v10, v11, v97
    v_max3_f32 v96, v12, v13, v96
    v_max3_f32 v97, v14, v15, v97
mk_f1_p1_7:
    s_nop 3
    v_max3_f32 v96, v16, v17, v96
    v_max3_f32 v97, v18, v19, v97
    v_max3_f32 v96, v20, v21, v96
    v_max3_f32 v97, v22, v23, v97
    v_max3_f32 v96, v24, v25, v96
    v_max3_f32 v97, v26, v27, v97
    v_max3_f32 v96, v28, v29, v96
    v_max3_f32 v97, v30, v31, v97
mk_f1_p1_8:
    s_nop 3
    v_max3_f32 v96, v80, v81, v96
    v_max3_f32 v97, v82, v83, v97
    v_max3_f32 v96, v84, v85, v96
    v_max3_f32 v97, v86, v87, v97
    v_max3_f32 v96, v88, v89, v96
    v_max3_f32 v97, v90, v91, v97
    v_max3_f32 v96, v92, v93, v96
    v_max3_f32 v97, v94, v95, v97
    v_max_f32 v96, v96, v97
    v_mov_b32 v97, v96
    s_nop 1
    v_permlane32_swap_b32 v96, v97
    v_max_f32 v96, v96, v97
    v_sub_f32 v32, 0, v96
    v_sub_f32 v33, 0, v96
    v_sub_f32 v34, 0, v96
    v_sub_f32 v35, 0, v96
    v_sub_f32 v36, 0, v96
    v_sub_f32 v37, 0, v96
    v_sub_f32 v38, 0, v96
    v_sub_f32 v39, 0, v96
    v_sub_f32 v40, 0, v96
    v_sub_f32 v41, 0, v96
    v_sub_f32 v42, 0, v96
    v_sub_f32 v43, 0, v96
    v_sub_f32 v44, 0, v96
    v_sub_f32 v45, 0, v96
    v_sub_f32 v46, 0, v96
    v_sub_f32 v47, 0, v96
    v_mov_b32 v80, 0
    v_mov_b32 v81, 0
    v_mov_b32 v82, 0
    v_mov_b32 v83, 0
    v_mov_b32 v84, 0
    v_mov_b32 v85, 0
    v_mov_b32 v86, 0
    v_mov_b32 v87, 0
    v_mov_b32 v88, 0
    v_mov_b32 v89, 0
    v_mov_b32 v90, 0
    v_mov_b32 v91, 0
    v_mov_b32 v92, 0
    v_mov_b32 v93, 0
    v_mov_b32 v94, 0
    v_mov_b32 v95, 0
    s_cmp_eq_u32 s72, 2
    s_cbranch_scc1 mk_f1_p2_e1
    s_cmp_eq_u32 s72, 4
    s_cbranch_scc1 mk_f1_p2_e3
    s_cmp_eq_u32 s72, 6
    s_cbranch_scc1 mk_f1_p2_e5
    s_cmp_eq_u32 s72, 8
    s_cbranch_scc1 mk_f1_p2_e7
    v_sub_f32 v0, v64, v96
    v_sub_f32 v1, v65, v96
    v_sub_f32 v2, v66, v96
    v_sub_f32 v3, v67, v96
    v_sub_f32 v4, v68, v96
    v_sub_f32 v5, v69, v96
    v_sub_f32 v6, v70, v96
    v_sub_f32 v7, v71, v96
    v_sub_f32 v8, v72, v96
    v_sub_f32 v9, v73, v96
    v_sub_f32 v10, v74, v96
    v_sub_f32 v11, v75, v96
    v_sub_f32 v12, v76, v96
    v_sub_f32 v13, v77, v96
    v_sub_f32 v14, v78, v96
    v_sub_f32 v15, v79, v96
    s_nop 1
    v_mfma_f32_32x32x16_bf16 v[0:15], v[140:143], v[132:135], v[0:15]
    s_nop 11
mk_f1_p2_0:
    v_exp_f32 v0, v0
    v_exp_f32 v1, v1
    v_mfma_f32_32x32x16_bf16 v[16:31], v[144:147], v[132:135], v[32:47]
    v_exp_f32 v2, v2
    v_exp_f32 v3, v3
    v_exp_f32 v4, v4
    v_exp_f32 v5, v5
    v_exp_f32 v6, v6
    v_exp_f32 v7, v7
    v_exp_f32 v8, v8
    v_cvt_pk_bf16_f32 v0, v0, v1
    v_exp_f32 v9, v9
    v_cvt_pk_bf16_f32 v1, v2, v3
    v_exp_f32 v10, v10
    v_cvt_pk_bf16_f32 v2, v4, v5
    v_exp_f32 v11, v11
    v_cvt_pk_bf16_f32 v3, v6, v7
    v_exp_f32 v12, v12
    v_exp_f32 v13, v13
    v_exp_f32 v14, v14
    v_exp_f32 v15, v15
    v_mfma_f32_32x32x16_bf16 v[80:95], v[180:183], v[0:3], v[80:95]
    v_cvt_pk_bf16_f32 v4, v8, v9
    v_cvt_pk_bf16_f32 v5, v10, v11
    v_cvt_pk_bf16_f32 v6, v12, v13
    v_cvt_pk_bf16_f32 v7, v14, v15
    v_exp_f32 v16, v16
    v_exp_f32 v17, v17
    v_mfma_f32_32x32x16_bf16 v[80:95], v[220:223], v[4:7], v[80:95]
mk_f1_p2_1x:
    v_mfma_f32_32x32x16_bf16 v[0:15], v[148:151], v[132:135], v[32:47]
    v_exp_f32 v18, v18
    v_exp_f32 v19, v19
    v_exp_f32 v20, v20
    v_exp_f32 v21, v21
    v_exp_f32 v22, v22
    v_exp_f32 v23, v23
    v_exp_f32 v24, v24
    v_cvt_pk_bf16_f32 v16, v16, v17
    v_exp_f32 v25, v25
    v_cvt_pk_bf16_f32 v17, v18, v19
    v_exp_f32 v26, v26
    v_cvt_pk_bf16_f32 v18, v20, v21
    v_exp_f32 v27, v27
    v_cvt_pk_bf16_f32 v19, v22, v23
    v_exp_f32 v28, v28
    v_exp_f32 v29, v29
    v_exp_f32 v30, v30
    v_exp_f32 v31, v31
    v_mfma_f32_32x32x16_bf16 v[80:95], v[184:187], v[16:19], v[80:95]
    v_cvt_pk_bf16_f32 v20, v24, v25
    v_cvt_pk_bf16_f32 v21, v26, v27
    v_cvt_pk_bf16_f32 v22, v28, v29
    v_cvt_pk_bf16_f32 v23, v30, v31
    v_exp_f32 v0, v0
    v_exp_f32 v1, v1
    v_mfma_f32_32x32x16_bf16 v[80:95], v[224:227], v[20:23], v[80:95]
mk_f1_p2_2x:
    v_mfma_f32_32x32x16_bf16 v[16:31], v[152:155], v[132:135], v[32:47]
    v_exp_f32 v2, v2
    v_exp_f32 v3, v3
    v_exp_f32 v4, v4
    v_exp_f32 v5, v5
    v_exp_f32 v6, v6
    v_exp_f32 v7, v7
    v_exp_f32 v8, v8
    v_cvt_pk_bf16_f32 v0, v0, v1
    v_exp_f32 v9, v9
    v_cvt_pk_bf16_f32 v1, v2, v3
    v_exp_f32 v10, v10
    v_cvt_pk_bf16_f32 v2, v4, v5
    v_exp_f32 v11, v11
    v_cvt_pk_bf16_f32 v3, v6, v7
    v_exp_f32 v12, v12
    v_exp_f32 v13, v13
    v_exp_f32 v14, v14
    v_exp_f32 v15, v15
    v_mfma_f32_32x32x16_bf16 v[80:95], v[188:191], v[0:3], v[80:95]
    v_cvt_pk_bf16_f32 v4, v8, v9
    v_cvt_pk_bf16_f32 v5, v10, v11
    v_cvt_pk_bf16_f32 v6, v12, v13
    v_cvt_pk_bf16_f32 v7, v14, v15
    v_exp_f32 v16, v16
    v_exp_f32 v17, v17
    v_mfma_f32_32x32x16_bf16 v[80:95], v[228:231], v[4:7], v[80:95]
mk_f1_p2_3x:
    v_mfma_f32_32x32x16_bf16 v[0:15], v[156:159], v[132:135], v[32:47]
    v_exp_f32 v18, v18
    v_exp_f32 v19, v19
    v_exp_f32 v20, v20
    v_exp_f32 v21, v21
    v_exp_f32 v22, v22
    v_exp_f32 v23, v23
    v_exp_f32 v24, v24
    v_cvt_pk_bf16_f32 v16, v16, v17
    v_exp_f32 v25, v25
    v_cvt_pk_bf16_f32 v17, v18, v19
    v_exp_f32 v26, v26
    v_cvt_pk_bf16_f32 v18, v20, v21
    v_exp_f32 v27, v27
    v_cvt_pk_bf16_f32 v19, v22, v23
    v_exp_f32 v28, v28
    v_exp_f32 v29, v29
    v_exp_f32 v30, v30
    v_exp_f32 v31, v31
    v_mfma_f32_32x32x16_bf16 v[80:95], v[192:195], v[16:19], v[80:95]
    v_cvt_pk_bf16_f32 v20, v24, v25
    v_cvt_pk_bf16_f32 v21, v26, v27
    v_cvt_pk_bf16_f32 v22, v28, v29
    v_cvt_pk_bf16_f32 v23, v30, v31
    v_exp_f32 v0, v0
    v_exp_f32 v1, v1
    v_mfma_f32_32x32x16_bf16 v[80:95], v[232:235], v[20:23], v[80:95]
mk_f1_p2_4x:
    v_mfma_f32_32x32x16_bf16 v[16:31], v[160:163], v[132:135], v[32:47]
    v_exp_f32 v2, v2
    v_exp_f32 v3, v3
    v_exp_f32 v4, v4
    v_exp_f32 v5, v5
    v_exp_f32 v6, v6
    v_exp_f32 v7, v7
    v_exp_f32 v8, v8
    v_cvt_pk_bf16_f32 v0, v0, v1
    v_exp_f32 v9, v9
    v_cvt_pk_bf16_f32 v1, v2, v3
    v_exp_f32 v10, v10
    v_cvt_pk_bf16_f32 v2, v4, v5
    v_exp_f32 v11, v11
    v_cvt_pk_bf16_f32 v3, v6, v7
    v_exp_f32 v12, v12
    v_exp_f32 v13, v13
    v_exp_f32 v14, v14
    v_exp_f32 v15, v15
    v_mfma_f32_32x32x16_bf16 v[80:95], v[196:199], v[0:3], v[80:95]
    v_cvt_pk_bf16_f32 v4, v8, v9
    v_cvt_pk_bf16_f32 v5, v10, v11
    v_cvt_pk_bf16_f32 v6, v12, v13
    v_cvt_pk_bf16_f32 v7, v14, v15
    v_exp_f32 v16, v16
    v_exp_f32 v17, v17
    v_mfma_f32_32x32x16_bf16 v[80:95], v[236:239], v[4:7], v[80:95]
mk_f1_p2_5x:
    v_mfma_f32_32x32x16_bf16 v[0:15], v[164:167], v[132:135], v[32:47]
    v_exp_f32 v18, v18
    v_exp_f32 v19, v19
    v_exp_f32 v20, v20
    v_exp_f32 v21, v21
    v_exp_f32 v22, v22
    v_exp_f32 v23, v23
    v_exp_f32 v24, v24
    v_cvt_pk_bf16_f32 v16, v16, v17
    v_exp_f32 v25, v25
    v_cvt_pk_bf16_f32 v17, v18, v19
    v_exp_f32 v26, v26
    v_cvt_pk_bf16_f32 v18, v20, v21
    v_exp_f32 v27, v27
    v_cvt_pk_bf16_f32 v19, v22, v23
    v_exp_f32 v28, v28
    v_exp_f32 v29, v29
    v_exp_f32 v30, v30
    v_exp_f32 v31, v31
    v_mfma_f32_32x32x16_bf16 v[80:95], v[200:203], v[16:19], v[80:95]
    v_cvt_pk_bf16_f32 v20, v24, v25
    v_cvt_pk_bf16_f32 v21, v26, v27
    v_cvt_pk_bf16_f32 v22, v28, v29
    v_cvt_pk_bf16_f32 v23, v30, v31
    v_exp_f32 v0, v0
    v_exp_f32 v1, v1
    v_mfma_f32_32x32x16_bf16 v[80:95], v[240:243], v[20:23], v[80:95]
mk_f1_p2_6x:
    v_mfma_f32_32x32x16_bf16 v[16:31], v[168:171], v[132:135], v[32:47]
    v_exp_f32 v2, v2
    v_exp_f32 v3, v3
    v_exp_f32 v4, v4
    v_exp_f32 v5, v5
    v_exp_f32 v6, v6
    v_exp_f32 v7, v7
    v_exp_f32 v8, v8
    v_cvt_pk_bf16_f32 v0, v0, v1
    v_exp_f32 v9, v9
    v_cvt_pk_bf16_f32 v1, v2, v3
    v_exp_f32 v10, v10
    v_cvt_pk_bf16_f32 v2, v4, v5
    v_exp_f32 v11, v11
    v_cvt_pk_bf16_f32 v3, v6, v7
    v_exp_f32 v12, v12
    v_exp_f32 v13, v13
    v_exp_f32 v14, v14
    v_exp_f32 v15, v15
    v_mfma_f32_32x32x16_bf16 v[80:95], v[204:207], v[0:3], v[80:95]
    v_cvt_pk_bf16_f32 v4, v8, v9
    v_cvt_pk_bf16_f32 v5, v10, v11
    v_cvt_pk_bf16_f32 v6, v12, v13
    v_cvt_pk_bf16_f32 v7, v14, v15
    v_exp_f32 v16, v16
    v_exp_f32 v17, v17
    v_mfma_f32_32x32x16_bf16 v[80:95], v[244:247], v[4:7], v[80:95]
mk_f1_p2_7x:
    v_sub_f32 v0, v48, v96
    v_sub_f32 v1, v49, v96
    v_sub_f32 v2, v50, v96
    v_sub_f32 v3, v51, v96
    v_sub_f32 v4, v52, v96
    v_sub_f32 v5, v53, v96
    v_sub_f32 v6, v54, v96
    v_sub_f32 v7, v55, v96
    v_sub_f32 v8, v56, v96
    v_sub_f32 v9, v57, v96
    v_sub_f32 v10, v58, v96
    v_sub_f32 v11, v59, v96
    v_sub_f32 v12, v60, v96
    v_sub_f32 v13, v61, v96
    v_sub_f32 v14, v62, v96
    v_sub_f32 v15, v63, v96
    s_nop 1
    v_mfma_f32_32x32x16_bf16 v[0:15], v[172:175], v[132:135], v[0:15]
    v_exp_f32 v18, v18
    v_exp_f32 v19, v19
    v_exp_f32 v20, v20
    v_exp_f32 v21, v21
    v_exp_f32 v22, v22
    v_exp_f32 v23, v23
    v_exp_f32 v24, v24
    v_cvt_pk_bf16_f32 v16, v16, v17
    v_exp_f32 v25, v25
    v_cvt_pk_bf16_f32 v17, v18, v19
    v_exp_f32 v26, v26
    v_cvt_pk_bf16_f32 v18, v20, v21
    v_exp_f32 v27, v27
    v_cvt_pk_bf16_f32 v19, v22, v23
    v_exp_f32 v28, v28
    v_exp_f32 v29, v29
    v_exp_f32 v30, v30
    v_exp_f32 v31, v31
    v_mfma_f32_32x32x16_bf16 v[80:95], v[208:211], v[16:19], v[80:95]
    v_cvt_pk_bf16_f32 v20, v24, v25
    v_cvt_pk_bf16_f32 v21, v26, v27
    v_cvt_pk_bf16_f32 v22, v28, v29
    v_cvt_pk_bf16_f32 v23, v30, v31
    v_exp_f32 v0, v0
    v_exp_f32 v1, v1
    v_mfma_f32_32x32x16_bf16 v[80:95], v[248:251], v[20:23], v[80:95]
mk_f1_p2_8x:
    v_exp_f32 v2, v2
    v_exp_f32 v3, v3
    v_exp_f32 v4, v4
    v_exp_f32 v5, v5
    v_exp_f32 v6, v6
    v_exp_f32 v7, v7
    v_exp_f32 v8, v8
    v_cvt_pk_bf16_f32 v0, v0, v1
    v_exp_f32 v9, v9
    v_cvt_pk_bf16_f32 v1, v2, v3
    v_exp_f32 v10, v10
    v_cvt_pk_bf16_f32 v2, v4, v5
    v_exp_f32 v11, v11
    v_cvt_pk_bf16_f32 v3, v6, v7
    v_exp_f32 v12, v12
    v_exp_f32 v13, v13
    v_exp_f32 v14, v14
    v_exp_f32 v15, v15
    v_mfma_f32_32x32x16_bf16 v[80:95], v[212:215], v[0:3], v[80:95]
    v_cvt_pk_bf16_f32 v4, v8, v9
    v_cvt_pk_bf16_f32 v5, v10, v11
    v_cvt_pk_bf16_f32 v6, v12, v13
    v_cvt_pk_bf16_f32 v7, v14, v15
    s_nop 1
    v_mfma_f32_32x32x16_bf16 v[80:95], v[252:255], v[4:7], v[80:95]
    s_branch mk_f1_p2t
mk_f1_p2_e1:
    v_mfma_f32_32x32x16_bf16 v[16:31], v[144:147], v[132:135], v[32:47]
    s_nop 11
    v_exp_f32 v16, v16
    v_exp_f32 v17, v17
    s_branch mk_f1_p2_1x
mk_f1_p2_e3:
    v_mfma_f32_32x32x16_bf16 v[16:31], v[152:155], v[132:135], v[32:47]
    s_nop 11
    v_exp_f32 v16, v16
    v_exp_f32 v17, v17
    s_branch mk_f1_p2_3x
mk_f1_p2_e5:
    v_mfma_f32_32x32x16_bf16 v[16:31], v[160:163], v[132:135], v[32:47]
    s_nop 11
    v_exp_f32 v16, v16
    v_exp_f32 v17, v17
    s_branch mk_f1_p2_5x
mk_f1_p2_e7:
    v_mfma_f32_32x32x16_bf16 v[16:31], v[168:171], v[132:135], v[32:47]
    s_nop 11
    v_exp_f32 v16, v16
    v_exp_f32 v17, v17
    s_branch mk_f1_p2_7x
mk_f1_p1e1:
    v_mfma_f32_32x32x16_bf16 v[16:31], v[144:147], v[132:135], 0
    v_mfma_f32_32x32x16_bf16 v[80:95], v[148:151], v[132:135], 0
    s_nop 10
    s_branch mk_f1_p1_1
mk_f1_p1e3:
    v_mfma_f32_32x32x16_bf16 v[0:15], v[152:155], v[132:135], 0
    v_mfma_f32_32x32x16_bf16 v[16:31], v[156:159], v[132:135], 0
    s_nop 10
    s_branch mk_f1_p1_3
mk_f1_p1e5:
    v_mfma_f32_32x32x16_bf16 v[80:95], v[160:163], v[132:135], 0
    v_mfma_f32_32x32x16_bf16 v[0:15], v[164:167], v[132:135], 0
    s_nop 10
    s_branch mk_f1_p1_5
mk_f1_p1e7:
    v_mfma_f32_32x32x16_bf16 v[16:31], v[168:171], v[132:135], 0
    v_mfma_f32_32x32x16_bf16 v[80:95], v[172:175], v[132:135], v[48:63]
    s_nop 10
    s_branch mk_f1_p1_7
mk_f1_p2t:
    s_nop 11
    v_rcp_f32 v97, v88
    s_branch mk_f1_fin
mk_code_end:
.section .rodata,"a"
.p2align 6
.amdhsa_kernel recurrent_scan__sliding_block__glu_gated_glu__prompt_kernel
  .amdhsa_next_free_vgpr 256
  .amdhsa_next_free_sgpr 102
  .amdhsa_accum_offset 256
  .amdhsa_group_segment_fixed_size 0
  .amdhsa_kernarg_size 80
  .amdhsa_user_sgpr_count 2
  .amdhsa_user_sgpr_kernarg_segment_ptr 1
  .amdhsa_system_sgpr_workgroup_id_x 1
.end_amdhsa_kernel
```
